```python
import torch

def _softmax(x, axis=-1):
    return torch.softmax(x, dim=axis)
def _gelu(x):
    return torch.nn.functional.gelu(x, approximate="tanh")
def _silu(x):
    return torch.nn.functional.silu(x)
def _sigmoid(x):
    return torch.sigmoid(x)
def _layernorm(x, axis=-1, eps=1e-5):
    m = x.mean(dim=axis, keepdim=True)
    v = x.var(dim=axis, keepdim=True, unbiased=False)
    return (x - m) / torch.sqrt(v + eps)
def _scatter_add(tgt, idx, src, axis=0):
    return tgt.clone().index_add_(axis, idx, src)
def _segment_sum(src, seg, n):
    out = torch.zeros((n,) + src.shape[1:], dtype=src.dtype)
    return out.index_add_(0, seg, src)
def _pad(x, pw):
    flat = tuple(v for pair in reversed(pw) for v in pair)
    return torch.nn.functional.pad(x, flat)

kernel_name = 'sequential_preLN__linear_kernel_hedgehog__glu_gated_swiglu__prompt'

def setup_inputs():

    _w = (lambda a: (lambda t: t.to(torch.bfloat16) if t.is_floating_point() else t)(torch.as_tensor(a)))
    def _A_setup():
        B, S, D, H = 1, 2048, 576, 32
        Dh = D // H
        return {
            "x": _w((lambda *s: torch.randn(*s, dtype=torch.bfloat16) * 0.05)(B, S, D)),
            "wqkv": _w((lambda *s: torch.randn(*s, dtype=torch.bfloat16) * 0.2)(D, 3 * D)),
            "w_phi": _w((lambda *s: torch.randn(*s, dtype=torch.bfloat16) * 0.2)(H, Dh, Dh) * (Dh ** -0.5)),
            "wo": _w((lambda *s: torch.randn(*s, dtype=torch.bfloat16) * 0.05)(D, D)),
        }
    _A_in = _A_setup()

    def _B_setup():
        B, S, D, F = 1, 2048, 576, 4608
        return {
            "x": _w((lambda *s: torch.randn(*s, dtype=torch.bfloat16) * 0.05)(B, S, D)),
            "w1": _w((lambda *s: torch.randn(*s, dtype=torch.bfloat16) * 0.4)(D, F) * (2.0 / D) ** 0.5),
            "w3": _w((lambda *s: torch.randn(*s, dtype=torch.bfloat16) * 0.4)(D, F) * (2.0 / D) ** 0.5),
            "w2": _w((lambda *s: torch.randn(*s, dtype=torch.bfloat16) * 0.4)(F, D) * (2.0 / F) ** 0.5),
        }
    _B_in = _B_setup()

    return {
        "A_x": _A_in["x"],
        "A_wqkv": _A_in["wqkv"],
        "A_w_phi": _A_in["w_phi"],
        "A_wo": _A_in["wo"],
        "B_x": _B_in["x"],
        "B_w1": _B_in["w1"],
        "B_w3": _B_in["w3"],
        "B_w2": _B_in["w2"],
    }

def reference(A_x, A_wqkv, A_w_phi, A_wo, B_x, B_w1, B_w3, B_w2):
    def _A_ref(x, wqkv, w_phi, wo):
        B, S, D = x.shape
        H = 32; Dh = D // H
        qkv = (lambda x, *d: x.permute(*d))((x @ wqkv).reshape(B, S, 3, H, Dh), 2, 0, 3, 1, 4)
        q, k, v = qkv[0], qkv[1], qkv[2]
        pq = torch.einsum("bhsd,hdf->bhsf", q, w_phi)
        pk = torch.einsum("bhsd,hdf->bhsf", k, w_phi)
        phi_q = torch.concatenate([_softmax(pq, axis=-1), _softmax(-pq, axis=-1)], axis=-1)
        phi_k = torch.concatenate([_softmax(pk, axis=-1), _softmax(-pk, axis=-1)], axis=-1)
        kv = torch.einsum("bhsf,bhsd->bhfd", phi_k, v)
        z  = torch.einsum("bhsf->bhf", phi_k)
        num = torch.einsum("bhqf,bhfd->bhqd", phi_q, kv)
        den = torch.einsum("bhqf,bhf->bhq", phi_q, z)[..., None] + 1e-6
        o = num / den
        return (lambda x, *d: x.permute(*d))(o, 0, 2, 1, 3).reshape(B, S, D) @ wo

    def _B_ref(x, w1, w3, w2):
        gate = torch.einsum("bsd,df->bsf", x, w1)
        up = torch.einsum("bsd,df->bsf", x, w3)
        h = _silu(gate) * up
        out = torch.einsum("bsf,fd->bsd", h, w2)
        return out

    x = A_x
    h = x + _A_ref(_layernorm(x, axis=-1), A_wqkv, A_w_phi, A_wo)
    h2 = h + _B_ref(_layernorm(h, axis=-1), B_w1, B_w3, B_w2)
    return h2
```

```asm
; @launch kernel=prep_kernel grid=(256,1,1) block=(256,1,1) lds=62224
; @launch kernel=attn_kernel grid=(256,1,1) block=(512,1,1) lds=159744
; @launch kernel=ffn_kernel grid=(256,1,1) block=(256,1,1) lds=163840
; @launch kernel=red_kernel grid=(256,1,1) block=(576,1,1) lds=0
.amdgcn_target "amdgcn-amd-amdhsa--gfx950"
.text
.globl prep_kernel
.p2align 8
.type prep_kernel,@function
prep_kernel:
  s_cmp_ge_u32 s2, 256
  s_cbranch_scc1 prep_end
  s_load_dwordx8 s[4:11], s[0:1], 0
  s_load_dwordx2 s[12:13], s[0:1], 80
  s_getpc_b64 s[40:41]
  v_lshlrev_b32 v250, 5, v0
  v_min_u32 v250, prep_kernel_codeend-prep_kernel-64, v250
  global_load_dword v252, v250, s[40:41]
  v_and_b32 v1, 63, v0
  v_lshrrev_b32 v2, 6, v0
  s_nop 0
  v_readfirstlane_b32 s3, v2
  v_and_b32 v3, 15, v1
  v_lshrrev_b32 v4, 4, v1
  v_lshlrev_b32 v5, 4, v1
  v_mov_b32 v6, 0x40000000
  s_getpc_b64 s[66:67]
prep_kernel_pc_attn_kernel:
  s_add_u32 s66, s66, attn_kernel-prep_kernel_pc_attn_kernel
  s_addc_u32 s67, s67, 0
  s_bfe_u32 s68, s2, 0x50003
  s_mul_i32 s68, s68, 384
  v_min_u32 v248, 2, v0
  v_lshlrev_b32 v248, 7, v248
  v_add_u32 v248, s68, v248
  v_min_u32 v248, attn_kernel_codeend-attn_kernel-4, v248
  global_load_dword v249, v248, s[66:67]
  s_cmp_ge_u32 s2, 96
  s_cbranch_scc1 prep_notw
  s_lshr_b32 s29, s2, 4
  s_bfe_u32 s28, s2, 0x10003
  s_and_b32 s30, s2, 3
  s_lshl_b32 s30, s30, 1
  s_add_u32 s28, s28, s30
  s_and_b32 s30, s2, 4
  s_lshl_b32 s30, s30, 1
  s_add_u32 s28, s28, s30
  v_mul_u32_u24 v7, 13108, v1
  v_lshrrev_b32 v7, 16, v7
  v_mul_u32_u24 v8, 5, v7
  v_sub_u32 v8, v1, v8
  v_mul_u32_u24 v9, 21846, v7
  v_lshrrev_b32 v9, 16, v9
  v_mul_u32_u24 v10, 3, v9
  v_sub_u32 v10, v7, v10
  v_mul_u32_u24 v9, 3456, v9
  v_mul_u32_u24 v10, 1152, v10
  v_lshlrev_b32 v8, 4, v8
  v_add3_u32 v7, v9, v10, v8
  s_mul_i32 s30, s28, 72
  s_and_b32 s30, s30, 0xfffffff0
  s_mul_i32 s31, s29, 331776
  s_add_u32 s30, s30, s31
  s_mul_i32 s31, s3, 13824
  s_add_u32 s30, s30, s31
  s_mul_i32 s32, s3, 1056
  s_add_u32 s32, s32, 36864
  v_lshlrev_b32 v8, 2, v0
  s_mul_i32 s33, s28, 1296
  v_mov_b32 v20, 0
  v_mov_b32 v21, 0
  v_mov_b32 v22, 0
  v_mov_b32 v23, 0
  v_lshlrev_b32 v9, 4, v0
  ds_write_b128 v9, v[20:23] offset:0
  ds_write_b128 v9, v[20:23] offset:4096
  ds_write_b128 v9, v[20:23] offset:8192
  ds_write_b128 v9, v[20:23] offset:12288
  ds_write_b128 v9, v[20:23] offset:16384
  ds_write_b128 v9, v[20:23] offset:20480
  ds_write_b128 v9, v[20:23] offset:24576
  ds_write_b128 v9, v[20:23] offset:28672
  ds_write_b128 v9, v[20:23] offset:32768
  s_waitcnt lgkmcnt(0)
  s_mov_b32 s24, s8
  s_mov_b32 s25, s9
  s_mov_b32 s26, 20736
  s_mov_b32 s27, 0x20000
  s_mov_b32 s20, s6
  s_mov_b32 s21, s7
  s_mov_b32 s22, 1990656
  s_mov_b32 s23, 0x20000
  buffer_load_dword v16, v8, s[24:27], s33 offen
  buffer_load_dword v17, v8, s[24:27], s33 offen offset:1024
  s_add_u32 m0, s32, 0
  s_nop 0
  buffer_load_dwordx4 v7, s[20:23], s30 offen lds
  s_add_u32 s30, s30, 55296
  s_add_u32 m0, s32, 4224
  s_nop 0
  buffer_load_dwordx4 v7, s[20:23], s30 offen lds
  s_add_u32 s30, s30, 55296
  s_add_u32 m0, s32, 8448
  s_nop 0
  buffer_load_dwordx4 v7, s[20:23], s30 offen lds
  s_add_u32 s30, s30, 55296
  s_add_u32 m0, s32, 12672
  s_nop 0
  buffer_load_dwordx4 v7, s[20:23], s30 offen lds
  s_add_u32 s30, s30, 55296
  s_add_u32 m0, s32, 16896
  s_nop 0
  buffer_load_dwordx4 v7, s[20:23], s30 offen lds
  s_add_u32 s30, s30, 55296
  s_add_u32 m0, s32, 21120
  s_nop 0
  buffer_load_dwordx4 v7, s[20:23], s30 offen lds
  s_add_u32 s30, s30, 55296
  s_mov_b32 s16, s12
  s_mov_b32 s17, s13
  s_mov_b32 s18, 268435456
  s_mov_b32 s19, 0x20000
  s_and_b32 s34, s28, 1
  s_lshl_b32 s34, s34, 2
  v_mov_b32 v24, 62208
  v_cmp_lt_u32 vcc, 161, v0
  s_nop 1
  v_cndmask_b32_e64 v10, 0, 1, vcc
  v_mul_u32_u24 v11, 162, v10
  v_sub_u32 v11, v0, v11
  v_mul_u32_u24 v12, 7282, v11
  v_lshrrev_b32 v12, 16, v12
  v_mul_u32_u24 v13, 9, v12
  v_sub_u32 v13, v11, v13
  v_mul_u32_u24 v14, 18, v10
  v_add3_u32 v14, v14, v12, s34
  v_lshrrev_b32 v15, 1, v13
  v_lshlrev_b32 v15, 5, v15
  v_and_b32 v13, 1, v13
  v_lshl_add_u32 v15, v13, 2, v15
  v_lshl_add_u32 v15, v10, 3, v15
  v_mul_u32_u24 v14, 288, v14
  v_add_u32 v26, v14, v15
  v_add_u32 v28, 11536, v26
  v_add_u32 v25, 256, v0
  v_cmp_lt_u32 vcc, 161, v25
  s_nop 1
  v_cndmask_b32_e64 v10, 0, 1, vcc
  v_mul_u32_u24 v11, 162, v10
  v_sub_u32 v11, v25, v11
  v_mul_u32_u24 v12, 7282, v11
  v_lshrrev_b32 v12, 16, v12
  v_mul_u32_u24 v13, 9, v12
  v_sub_u32 v13, v11, v13
  v_mul_u32_u24 v14, 18, v10
  v_add3_u32 v14, v14, v12, s34
  v_lshrrev_b32 v15, 1, v13
  v_lshlrev_b32 v15, 5, v15
  v_and_b32 v13, 1, v13
  v_lshl_add_u32 v15, v13, 2, v15
  v_lshl_add_u32 v15, v10, 3, v15
  v_mul_u32_u24 v14, 288, v14
  v_add_u32 v27, v14, v15
  v_add_u32 v29, 11536, v27
  v_cmp_gt_u32 vcc, 324, v25
  s_nop 1
  v_cndmask_b32 v27, v24, v27, vcc
  v_cndmask_b32 v29, v24, v29, vcc
  v_cmp_lt_u32 vcc, 17, v0
  s_nop 1
  v_cndmask_b32_e64 v10, 0, 1, vcc
  v_mul_u32_u24 v11, 18, v10
  v_sub_u32 v11, v0, v11
  v_lshl_add_u32 v12, v10, 4, v11
  v_add_u32 v12, 80, v12
  v_lshl_add_u32 v13, v10, 2, v11
  v_add_u32 v13, 50, v13
  v_cmp_gt_u32 vcc, 16, v11
  s_nop 1
  v_cndmask_b32 v12, v13, v12, vcc
  v_add_u32 v13, s34, v0
  v_add_u32 v13, 80, v13
  v_mul_u32_u24 v13, 288, v13
  v_lshl_add_u32 v30, v12, 1, v13
  v_cmp_gt_u32 vcc, 36, v0
  s_nop 1
  v_cndmask_b32 v30, v24, v30, vcc
  v_mov_b32 v31, 0x3f80
  s_barrier
  ds_write_b16 v30, v31
  s_waitcnt vmcnt(7)
  ds_write_b32 v26, v16
  ds_write_b32 v28, v16
  s_waitcnt vmcnt(6)
  ds_write_b32 v27, v17
  ds_write_b32 v29, v17
  v_lshrrev_b32 v10, 2, v3
  v_and_b32 v11, 3, v3
  v_lshl_add_u32 v12, v4, 3, v10
  v_mul_u32_u24 v12, 288, v12
  v_lshl_add_u32 v12, v11, 3, v12
  s_lshl_b32 s35, s3, 5
  v_add_u32 v12, s35, v12
  v_mul_u32_u24 v13, 240, v11
  v_mul_u32_u24 v14, 2112, v10
  v_lshl_add_u32 v13, v4, 4, v13
  v_add_u32 v13, v13, v14
  v_add_u32 v13, 36864, v13
  s_mul_i32 s36, s28, 18
  s_mul_i32 s37, s29, 3
  s_add_u32 s36, s36, s37
  s_mul_i32 s36, s36, 7
  s_add_u32 s36, s36, s3
  s_lshl_b32 s36, s36, 10
  s_add_u32 s36, s36, 2359296
  s_add_u32 s37, s36, 4096
  s_cmp_lt_u32 s3, 3
  s_cselect_b32 s37, s37, 1073741824
  s_waitcnt vmcnt(0) lgkmcnt(0)
  s_barrier
  ds_read_b64_tr_b16 v[32:33], v12 offset:0
  ds_read_b64_tr_b16 v[34:35], v12 offset:1152
  ds_read_b64_tr_b16 v[48:49], v12 offset:128
  ds_read_b64_tr_b16 v[50:51], v12 offset:1280
  ds_read_b128 v[64:67], v13 offset:0
  ds_read_b128 v[80:83], v13 offset:1056
  ds_read_b64_tr_b16 v[36:37], v12 offset:9216
  ds_read_b64_tr_b16 v[38:39], v12 offset:10368
  ds_read_b64_tr_b16 v[52:53], v12 offset:9344
  ds_read_b64_tr_b16 v[54:55], v12 offset:10496
  ds_read_b128 v[68:71], v13 offset:64
  ds_read_b128 v[84:87], v13 offset:1120
  ds_read_b64_tr_b16 v[40:41], v12 offset:18432
  ds_read_b64_tr_b16 v[42:43], v12 offset:19584
  ds_read_b64_tr_b16 v[56:57], v12 offset:18560
  ds_read_b64_tr_b16 v[58:59], v12 offset:19712
  ds_read_b128 v[72:75], v13 offset:128
  ds_read_b128 v[88:91], v13 offset:1184
  ds_read_b64_tr_b16 v[44:45], v12 offset:27648
  ds_read_b64_tr_b16 v[46:47], v12 offset:28800
  ds_read_b64_tr_b16 v[60:61], v12 offset:27776
  ds_read_b64_tr_b16 v[62:63], v12 offset:28928
  ds_read_b128 v[76:79], v13 offset:192
  ds_read_b128 v[92:95], v13 offset:1248
  ds_read_b128 v[96:99], v13 offset:8448
  ds_read_b128 v[112:115], v13 offset:9504
  ds_read_b128 v[100:103], v13 offset:8512
  ds_read_b128 v[116:119], v13 offset:9568
  ds_read_b128 v[104:107], v13 offset:8576
  ds_read_b128 v[120:123], v13 offset:9632
  ds_read_b128 v[108:111], v13 offset:8640
  ds_read_b128 v[124:127], v13 offset:9696
  ds_read_b128 v[128:131], v13 offset:16896
  ds_read_b128 v[144:147], v13 offset:17952
  ds_read_b128 v[132:135], v13 offset:16960
  ds_read_b128 v[148:151], v13 offset:18016
  ds_read_b128 v[136:139], v13 offset:17024
  ds_read_b128 v[152:155], v13 offset:18080
  ds_read_b128 v[140:143], v13 offset:17088
  ds_read_b128 v[156:159], v13 offset:18144
  s_mov_b32 s65, s2
  s_mul_i32 s64, s65, 12288
  s_add_u32 s64, s64, 0
  v_lshlrev_b32 v243, 4, v0
  s_add_u32 s60, s12, 6324224
  s_addc_u32 s61, s13, 0
  s_mov_b32 s62, 3178496
  s_mov_b32 s63, 0x20000
  v_mov_b32 v244, -1
  v_mov_b32 v245, -1
  v_mov_b32 v246, -1
  v_mov_b32 v247, -1
  buffer_store_dwordx4 v[244:247], v243, s[60:63], s64 offen sc1
  s_add_u32 s64, s64, 4096
  buffer_store_dwordx4 v[244:247], v243, s[60:63], s64 offen sc1
  s_add_u32 s64, s64, 4096
  buffer_store_dwordx4 v[244:247], v243, s[60:63], s64 offen sc1
  s_add_u32 s64, s64, 4096
  s_waitcnt lgkmcnt(15)
  v_mfma_f32_16x16x32_bf16 v[160:163], v[64:67], v[32:35], 0
  v_mfma_f32_16x16x32_bf16 v[168:171], v[64:67], v[48:51], 0
  s_waitcnt lgkmcnt(15)
  v_mfma_f32_16x16x32_bf16 v[164:167], v[80:83], v[32:35], 0
  v_mfma_f32_16x16x32_bf16 v[172:175], v[80:83], v[48:51], 0
  s_waitcnt lgkmcnt(15)
  v_mfma_f32_16x16x32_bf16 v[160:163], v[68:71], v[36:39], v[160:163]
  v_mfma_f32_16x16x32_bf16 v[168:171], v[68:71], v[52:55], v[168:171]
  s_waitcnt lgkmcnt(15)
  v_mfma_f32_16x16x32_bf16 v[164:167], v[84:87], v[36:39], v[164:167]
  v_mfma_f32_16x16x32_bf16 v[172:175], v[84:87], v[52:55], v[172:175]
  s_waitcnt lgkmcnt(15)
  v_mfma_f32_16x16x32_bf16 v[160:163], v[72:75], v[40:43], v[160:163]
  v_mfma_f32_16x16x32_bf16 v[168:171], v[72:75], v[56:59], v[168:171]
  s_waitcnt lgkmcnt(15)
  v_mfma_f32_16x16x32_bf16 v[164:167], v[88:91], v[40:43], v[164:167]
  v_mfma_f32_16x16x32_bf16 v[172:175], v[88:91], v[56:59], v[172:175]
  s_waitcnt lgkmcnt(15)
  v_mfma_f32_16x16x32_bf16 v[160:163], v[76:79], v[44:47], v[160:163]
  v_mfma_f32_16x16x32_bf16 v[168:171], v[76:79], v[60:63], v[168:171]
  s_waitcnt lgkmcnt(15)
  v_mfma_f32_16x16x32_bf16 v[164:167], v[92:95], v[44:47], v[164:167]
  v_mfma_f32_16x16x32_bf16 v[172:175], v[92:95], v[60:63], v[172:175]
  s_waitcnt lgkmcnt(15)
  v_mfma_f32_16x16x32_bf16 v[176:179], v[96:99], v[32:35], 0
  v_mfma_f32_16x16x32_bf16 v[184:187], v[96:99], v[48:51], 0
  s_waitcnt lgkmcnt(14)
  v_mfma_f32_16x16x32_bf16 v[180:183], v[112:115], v[32:35], 0
  v_mfma_f32_16x16x32_bf16 v[188:191], v[112:115], v[48:51], 0
  s_waitcnt lgkmcnt(13)
  v_mfma_f32_16x16x32_bf16 v[176:179], v[100:103], v[36:39], v[176:179]
  v_mfma_f32_16x16x32_bf16 v[184:187], v[100:103], v[52:55], v[184:187]
  s_waitcnt lgkmcnt(12)
  v_mfma_f32_16x16x32_bf16 v[180:183], v[116:119], v[36:39], v[180:183]
  v_mfma_f32_16x16x32_bf16 v[188:191], v[116:119], v[52:55], v[188:191]
  s_waitcnt lgkmcnt(11)
  v_mfma_f32_16x16x32_bf16 v[176:179], v[104:107], v[40:43], v[176:179]
  v_mfma_f32_16x16x32_bf16 v[184:187], v[104:107], v[56:59], v[184:187]
  s_waitcnt lgkmcnt(10)
  v_mfma_f32_16x16x32_bf16 v[180:183], v[120:123], v[40:43], v[180:183]
  v_mfma_f32_16x16x32_bf16 v[188:191], v[120:123], v[56:59], v[188:191]
  s_waitcnt lgkmcnt(9)
  v_mfma_f32_16x16x32_bf16 v[176:179], v[108:111], v[44:47], v[176:179]
  v_mfma_f32_16x16x32_bf16 v[184:187], v[108:111], v[60:63], v[184:187]
  s_waitcnt lgkmcnt(8)
  v_mfma_f32_16x16x32_bf16 v[180:183], v[124:127], v[44:47], v[180:183]
  v_mfma_f32_16x16x32_bf16 v[188:191], v[124:127], v[60:63], v[188:191]
  v_cvt_pk_bf16_f32 v208, v160, v161
  v_cvt_pk_bf16_f32 v209, v162, v163
  v_cvt_pk_bf16_f32 v210, v164, v165
  v_cvt_pk_bf16_f32 v211, v166, v167
  buffer_store_dwordx4 v[208:211], v5, s[16:19], s36 offen
  v_cvt_pk_bf16_f32 v212, v168, v169
  v_cvt_pk_bf16_f32 v213, v170, v171
  v_cvt_pk_bf16_f32 v214, v172, v173
  v_cvt_pk_bf16_f32 v215, v174, v175
  buffer_store_dwordx4 v[212:215], v5, s[16:19], s37 offen
  s_add_u32 s36, s36, 7168
  s_add_u32 s37, s37, 7168
  s_waitcnt lgkmcnt(7)
  v_mfma_f32_16x16x32_bf16 v[192:195], v[128:131], v[32:35], 0
  v_mfma_f32_16x16x32_bf16 v[200:203], v[128:131], v[48:51], 0
  s_waitcnt lgkmcnt(6)
  v_mfma_f32_16x16x32_bf16 v[196:199], v[144:147], v[32:35], 0
  v_mfma_f32_16x16x32_bf16 v[204:207], v[144:147], v[48:51], 0
  s_waitcnt lgkmcnt(5)
  v_mfma_f32_16x16x32_bf16 v[192:195], v[132:135], v[36:39], v[192:195]
  v_mfma_f32_16x16x32_bf16 v[200:203], v[132:135], v[52:55], v[200:203]
  s_waitcnt lgkmcnt(4)
  v_mfma_f32_16x16x32_bf16 v[196:199], v[148:151], v[36:39], v[196:199]
  v_mfma_f32_16x16x32_bf16 v[204:207], v[148:151], v[52:55], v[204:207]
  s_waitcnt lgkmcnt(3)
  v_mfma_f32_16x16x32_bf16 v[192:195], v[136:139], v[40:43], v[192:195]
  v_mfma_f32_16x16x32_bf16 v[200:203], v[136:139], v[56:59], v[200:203]
  s_waitcnt lgkmcnt(2)
  v_mfma_f32_16x16x32_bf16 v[196:199], v[152:155], v[40:43], v[196:199]
  v_mfma_f32_16x16x32_bf16 v[204:207], v[152:155], v[56:59], v[204:207]
  s_waitcnt lgkmcnt(1)
  v_mfma_f32_16x16x32_bf16 v[192:195], v[140:143], v[44:47], v[192:195]
  v_mfma_f32_16x16x32_bf16 v[200:203], v[140:143], v[60:63], v[200:203]
  s_waitcnt lgkmcnt(0)
  v_mfma_f32_16x16x32_bf16 v[196:199], v[156:159], v[44:47], v[196:199]
  v_mfma_f32_16x16x32_bf16 v[204:207], v[156:159], v[60:63], v[204:207]
  v_cvt_pk_bf16_f32 v216, v176, v177
  v_cvt_pk_bf16_f32 v217, v178, v179
  v_cvt_pk_bf16_f32 v218, v180, v181
  v_cvt_pk_bf16_f32 v219, v182, v183
  buffer_store_dwordx4 v[216:219], v5, s[16:19], s36 offen
  v_cvt_pk_bf16_f32 v220, v184, v185
  v_cvt_pk_bf16_f32 v221, v186, v187
  v_cvt_pk_bf16_f32 v222, v188, v189
  v_cvt_pk_bf16_f32 v223, v190, v191
  buffer_store_dwordx4 v[220:223], v5, s[16:19], s37 offen
  s_add_u32 s36, s36, 7168
  s_add_u32 s37, s37, 7168
  v_cvt_pk_bf16_f32 v224, v192, v193
  v_cvt_pk_bf16_f32 v225, v194, v195
  v_cvt_pk_bf16_f32 v226, v196, v197
  v_cvt_pk_bf16_f32 v227, v198, v199
  buffer_store_dwordx4 v[224:227], v5, s[16:19], s36 offen
  v_cvt_pk_bf16_f32 v228, v200, v201
  v_cvt_pk_bf16_f32 v229, v202, v203
  v_cvt_pk_bf16_f32 v230, v204, v205
  v_cvt_pk_bf16_f32 v231, v206, v207
  buffer_store_dwordx4 v[228:231], v5, s[16:19], s37 offen
  s_endpgm
prep_notw:
  s_cmp_lt_u32 s2, 120
  s_cbranch_scc1 prep_wo
  s_cmp_ge_u32 s2, 248
  s_cbranch_scc1 prep_fill
  s_sub_u32 s35, s2, 120
  s_lshr_b32 s36, s35, 3
  s_and_b32 s37, s35, 3
  s_lshl_b32 s37, s37, 1
  s_bfe_u32 s38, s35, 0x10002
  s_add_u32 s37, s37, s38
  s_lshl_b32 s37, s37, 4
  s_add_u32 s37, s37, s36
  v_lshrrev_b32 v7, 4, v0
  v_mul_u32_u24 v8, 1152, v7
  v_lshl_add_u32 v8, v3, 4, v8
  v_add_u32 v9, 1024, v8
  v_cmp_gt_u32 vcc, 8, v3
  s_nop 1
  v_cndmask_b32 v9, v6, v9, vcc
  s_mul_i32 s28, s37, 18432
  s_waitcnt lgkmcnt(0)
  s_mov_b32 s20, s4
  s_mov_b32 s21, s5
  s_mov_b32 s22, 2359296
  s_mov_b32 s23, 0x20000
  buffer_load_dwordx4 v[16:19], v8, s[20:23], s28 offen offset:0
  buffer_load_dwordx4 v[20:23], v8, s[20:23], s28 offen offset:256
  buffer_load_dwordx4 v[24:27], v8, s[20:23], s28 offen offset:512
  buffer_load_dwordx4 v[28:31], v8, s[20:23], s28 offen offset:768
  buffer_load_dwordx4 v[32:35], v9, s[20:23], s28 offen
  s_mov_b32 s16, s12
  s_mov_b32 s17, s13
  s_mov_b32 s18, 268435456
  s_mov_b32 s19, 0x20000
  s_mov_b32 s65, s2
  s_mul_i32 s64, s65, 12288
  s_add_u32 s64, s64, 155648
  v_lshlrev_b32 v243, 4, v0
  s_add_u32 s60, s12, 6324224
  s_addc_u32 s61, s13, 0
  s_mov_b32 s62, 3178496
  s_mov_b32 s63, 0x20000
  v_mov_b32 v244, -1
  v_mov_b32 v245, -1
  v_mov_b32 v246, -1
  v_mov_b32 v247, -1
  buffer_store_dwordx4 v[244:247], v243, s[60:63], s64 offen sc1
  s_add_u32 s64, s64, 4096
  buffer_store_dwordx4 v[244:247], v243, s[60:63], s64 offen sc1
  s_add_u32 s64, s64, 4096
  buffer_store_dwordx4 v[244:247], v243, s[60:63], s64 offen sc1
  s_add_u32 s64, s64, 4096
  v_xor_b32 v10, v7, v3
  v_lshlrev_b32 v10, 4, v10
  v_lshl_add_u32 v10, v3, 8, v10
  s_lshl_b32 s29, s3, 2
  v_add_u32 v11, s29, v4
  v_xor_b32 v12, v3, v11
  v_lshlrev_b32 v12, 4, v12
  v_lshl_add_u32 v11, v11, 8, v12
  s_mov_b32 s30, 0xffff0000
  s_load_dwordx4 s[44:47], s[0:1], 40
  v_mul_u32_u24 v84, 10923, v0
  v_lshrrev_b32 v84, 16, v84
  v_mul_u32_u24 v85, 6, v84
  v_sub_u32 v85, v0, v85
  v_lshlrev_b32 v85, 2, v85
  v_mov_b32 v86, 7496976
  v_lshrrev_b32 v85, v85, v86
  v_and_b32 v85, 15, v85
  v_mul_u32_u24 v84, 9216, v84
  v_lshl_add_u32 v84, v85, 7, v84
  v_cmp_gt_u32 vcc, 216, v0
  s_nop 1
  v_cndmask_b32 v84, v6, v84, vcc
  s_and_b32 s52, s2, 7
  s_mul_i32 s52, s52, 1152
  s_mul_i32 s53, s36, 331776
  s_add_u32 s52, s52, s53
  s_waitcnt lgkmcnt(0)
  s_mov_b32 s48, s46
  s_mov_b32 s49, s47
  s_mov_b32 s46, 5308416
  s_mov_b32 s47, 0x20000
  s_mov_b32 s50, 5308416
  s_mov_b32 s51, 0x20000
  s_lshl_b32 s33, s3, 10
  s_add_u32 s33, s33, s28
  s_add_u32 s34, s33, 16384
  s_cmp_lt_u32 s3, 2
  s_cselect_b32 s34, s34, 1073741824
  s_lshl_b32 s32, s37, 6
  s_add_u32 s32, s32, 5242880
  v_lshlrev_b32 v13, 2, v7
  v_cmp_eq_u32 vcc, 0, v3
  s_nop 1
  v_cndmask_b32 v13, v6, v13, vcc
  s_mov_b32 s31, 0x3ae38e39
  s_waitcnt vmcnt(7)
  v_lshlrev_b32 v40, 16, v16
  v_and_b32 v41, s30, v16
  v_lshlrev_b32 v42, 16, v17
  v_and_b32 v43, s30, v17
  v_add_f32 v80, v40, v41
  v_mul_f32 v82, v40, v40
  v_mul_f32 v83, v41, v41
  v_add_f32 v81, v42, v43
  v_fmac_f32 v82, v42, v42
  v_fmac_f32 v83, v43, v43
  v_lshlrev_b32 v44, 16, v18
  v_and_b32 v45, s30, v18
  v_add_f32 v80, v80, v44
  v_fmac_f32 v82, v44, v44
  v_add_f32 v81, v81, v45
  v_fmac_f32 v83, v45, v45
  v_lshlrev_b32 v46, 16, v19
  v_and_b32 v47, s30, v19
  v_add_f32 v81, v81, v46
  v_fmac_f32 v82, v46, v46
  v_add_f32 v80, v80, v47
  v_fmac_f32 v83, v47, v47
  s_waitcnt vmcnt(6)
  v_lshlrev_b32 v48, 16, v20
  v_and_b32 v49, s30, v20
  v_add_f32 v80, v80, v48
  v_fmac_f32 v82, v48, v48
  v_add_f32 v81, v81, v49
  v_fmac_f32 v83, v49, v49
  v_lshlrev_b32 v50, 16, v21
  v_and_b32 v51, s30, v21
  v_add_f32 v81, v81, v50
  v_fmac_f32 v82, v50, v50
  v_add_f32 v80, v80, v51
  v_fmac_f32 v83, v51, v51
  v_lshlrev_b32 v52, 16, v22
  v_and_b32 v53, s30, v22
  v_add_f32 v80, v80, v52
  v_fmac_f32 v82, v52, v52
  v_add_f32 v81, v81, v53
  v_fmac_f32 v83, v53, v53
  v_lshlrev_b32 v54, 16, v23
  v_and_b32 v55, s30, v23
  v_add_f32 v81, v81, v54
  v_fmac_f32 v82, v54, v54
  v_add_f32 v80, v80, v55
  v_fmac_f32 v83, v55, v55
  s_waitcnt vmcnt(5)
  v_lshlrev_b32 v56, 16, v24
  v_and_b32 v57, s30, v24
  v_add_f32 v80, v80, v56
  v_fmac_f32 v82, v56, v56
  v_add_f32 v81, v81, v57
  v_fmac_f32 v83, v57, v57
  v_lshlrev_b32 v58, 16, v25
  v_and_b32 v59, s30, v25
  v_add_f32 v81, v81, v58
  v_fmac_f32 v82, v58, v58
  v_add_f32 v80, v80, v59
  v_fmac_f32 v83, v59, v59
  v_lshlrev_b32 v60, 16, v26
  v_and_b32 v61, s30, v26
  v_add_f32 v80, v80, v60
  v_fmac_f32 v82, v60, v60
  v_add_f32 v81, v81, v61
  v_fmac_f32 v83, v61, v61
  v_lshlrev_b32 v62, 16, v27
  v_and_b32 v63, s30, v27
  v_add_f32 v81, v81, v62
  v_fmac_f32 v82, v62, v62
  v_add_f32 v80, v80, v63
  v_fmac_f32 v83, v63, v63
  s_waitcnt vmcnt(4)
  v_lshlrev_b32 v64, 16, v28
  v_and_b32 v65, s30, v28
  v_add_f32 v80, v80, v64
  v_fmac_f32 v82, v64, v64
  v_add_f32 v81, v81, v65
  v_fmac_f32 v83, v65, v65
  v_lshlrev_b32 v66, 16, v29
  v_and_b32 v67, s30, v29
  v_add_f32 v81, v81, v66
  v_fmac_f32 v82, v66, v66
  v_add_f32 v80, v80, v67
  v_fmac_f32 v83, v67, v67
  v_lshlrev_b32 v68, 16, v30
  v_and_b32 v69, s30, v30
  v_add_f32 v80, v80, v68
  v_fmac_f32 v82, v68, v68
  v_add_f32 v81, v81, v69
  v_fmac_f32 v83, v69, v69
  v_lshlrev_b32 v70, 16, v31
  v_and_b32 v71, s30, v31
  v_add_f32 v81, v81, v70
  v_fmac_f32 v82, v70, v70
  v_add_f32 v80, v80, v71
  v_fmac_f32 v83, v71, v71
  s_waitcnt vmcnt(3)
  v_lshlrev_b32 v72, 16, v32
  v_and_b32 v73, s30, v32
  v_add_f32 v80, v80, v72
  v_fmac_f32 v82, v72, v72
  v_add_f32 v81, v81, v73
  v_fmac_f32 v83, v73, v73
  v_lshlrev_b32 v74, 16, v33
  v_and_b32 v75, s30, v33
  v_add_f32 v81, v81, v74
  v_fmac_f32 v82, v74, v74
  v_add_f32 v80, v80, v75
  v_fmac_f32 v83, v75, v75
  v_lshlrev_b32 v76, 16, v34
  v_and_b32 v77, s30, v34
  v_add_f32 v80, v80, v76
  v_fmac_f32 v82, v76, v76
  v_add_f32 v81, v81, v77
  v_fmac_f32 v83, v77, v77
  v_lshlrev_b32 v78, 16, v35
  v_and_b32 v79, s30, v35
  v_add_f32 v81, v81, v78
  v_fmac_f32 v82, v78, v78
  v_add_f32 v80, v80, v79
  v_fmac_f32 v83, v79, v79
  v_add_f32 v80, v80, v81
  v_add_f32 v82, v82, v83
  s_nop 0
  v_add_f32_dpp v80, v80, v80 row_ror:8 row_mask:0xf bank_mask:0xf
  v_add_f32_dpp v82, v82, v82 row_ror:8 row_mask:0xf bank_mask:0xf
  s_nop 0
  v_add_f32_dpp v80, v80, v80 row_ror:4 row_mask:0xf bank_mask:0xf
  v_add_f32_dpp v82, v82, v82 row_ror:4 row_mask:0xf bank_mask:0xf
  s_nop 0
  v_add_f32_dpp v80, v80, v80 row_ror:2 row_mask:0xf bank_mask:0xf
  v_add_f32_dpp v82, v82, v82 row_ror:2 row_mask:0xf bank_mask:0xf
  s_nop 0
  v_add_f32_dpp v80, v80, v80 row_ror:1 row_mask:0xf bank_mask:0xf
  v_add_f32_dpp v82, v82, v82 row_ror:1 row_mask:0xf bank_mask:0xf
  v_mul_f32 v80, s31, v80
  v_mul_f32 v82, s31, v82
  v_fma_f32 v82, -v80, v80, v82
  v_max_f32 v82, 0, v82
  buffer_load_dword v87, v84, s[44:47], s52 offen
  buffer_load_dword v88, v84, s[48:51], s52 offen
  v_cvt_pk_bf16_f32 v81, v80, v80
  v_lshlrev_b32 v81, 16, v81
  v_cvt_pk_bf16_f32 v82, v82, v82
  v_lshlrev_b32 v82, 16, v82
  v_add_f32 v82, 0x3727c5ac, v82
  v_cvt_pk_bf16_f32 v82, v82, v82
  v_lshlrev_b32 v82, 16, v82
  v_sqrt_f32 v82, v82
  s_nop 0
  v_cvt_pk_bf16_f32 v82, v82, v82
  v_lshlrev_b32 v82, 16, v82
  v_rcp_f32 v82, v82
  s_nop 0
  v_mul_f32 v81, v81, v82
  v_fma_f32 v40, v40, v82, -v81
  v_fma_f32 v41, v41, v82, -v81
  v_cvt_pk_bf16_f32 v16, v40, v41
  v_fma_f32 v42, v42, v82, -v81
  v_fma_f32 v43, v43, v82, -v81
  v_cvt_pk_bf16_f32 v17, v42, v43
  v_fma_f32 v44, v44, v82, -v81
  v_fma_f32 v45, v45, v82, -v81
  v_cvt_pk_bf16_f32 v18, v44, v45
  v_fma_f32 v46, v46, v82, -v81
  v_fma_f32 v47, v47, v82, -v81
  v_cvt_pk_bf16_f32 v19, v46, v47
  ds_write_b128 v10, v[16:19] offset:0
  v_fma_f32 v48, v48, v82, -v81
  v_fma_f32 v49, v49, v82, -v81
  v_cvt_pk_bf16_f32 v20, v48, v49
  v_fma_f32 v50, v50, v82, -v81
  v_fma_f32 v51, v51, v82, -v81
  v_cvt_pk_bf16_f32 v21, v50, v51
  v_fma_f32 v52, v52, v82, -v81
  v_fma_f32 v53, v53, v82, -v81
  v_cvt_pk_bf16_f32 v22, v52, v53
  v_fma_f32 v54, v54, v82, -v81
  v_fma_f32 v55, v55, v82, -v81
  v_cvt_pk_bf16_f32 v23, v54, v55
  ds_write_b128 v10, v[20:23] offset:4096
  v_fma_f32 v56, v56, v82, -v81
  v_fma_f32 v57, v57, v82, -v81
  v_cvt_pk_bf16_f32 v24, v56, v57
  v_fma_f32 v58, v58, v82, -v81
  v_fma_f32 v59, v59, v82, -v81
  v_cvt_pk_bf16_f32 v25, v58, v59
  v_fma_f32 v60, v60, v82, -v81
  v_fma_f32 v61, v61, v82, -v81
  v_cvt_pk_bf16_f32 v26, v60, v61
  v_fma_f32 v62, v62, v82, -v81
  v_fma_f32 v63, v63, v82, -v81
  v_cvt_pk_bf16_f32 v27, v62, v63
  ds_write_b128 v10, v[24:27] offset:8192
  v_fma_f32 v64, v64, v82, -v81
  v_fma_f32 v65, v65, v82, -v81
  v_cvt_pk_bf16_f32 v28, v64, v65
  v_fma_f32 v66, v66, v82, -v81
  v_fma_f32 v67, v67, v82, -v81
  v_cvt_pk_bf16_f32 v29, v66, v67
  v_fma_f32 v68, v68, v82, -v81
  v_fma_f32 v69, v69, v82, -v81
  v_cvt_pk_bf16_f32 v30, v68, v69
  v_fma_f32 v70, v70, v82, -v81
  v_fma_f32 v71, v71, v82, -v81
  v_cvt_pk_bf16_f32 v31, v70, v71
  ds_write_b128 v10, v[28:31] offset:12288
  v_fma_f32 v72, v72, v82, -v81
  v_fma_f32 v73, v73, v82, -v81
  v_cvt_pk_bf16_f32 v32, v72, v73
  v_fma_f32 v74, v74, v82, -v81
  v_fma_f32 v75, v75, v82, -v81
  v_cvt_pk_bf16_f32 v33, v74, v75
  v_fma_f32 v76, v76, v82, -v81
  v_fma_f32 v77, v77, v82, -v81
  v_cvt_pk_bf16_f32 v34, v76, v77
  v_fma_f32 v78, v78, v82, -v81
  v_fma_f32 v79, v79, v82, -v81
  v_cvt_pk_bf16_f32 v35, v78, v79
  ds_write_b128 v10, v[32:35] offset:16384
  buffer_store_dword v80, v13, s[16:19], s32 offen
  s_waitcnt lgkmcnt(0)
  s_barrier
  ds_read_b128 v[16:19], v11 offset:0
  ds_read_b128 v[20:23], v11 offset:4096
  ds_read_b128 v[24:27], v11 offset:8192
  ds_read_b128 v[28:31], v11 offset:12288
  ds_read_b128 v[32:35], v11 offset:16384
  s_waitcnt lgkmcnt(4)
  buffer_store_dwordx4 v[16:19], v5, s[16:19], s33 offen
  s_add_u32 s33, s33, 4096
  s_waitcnt lgkmcnt(3)
  buffer_store_dwordx4 v[20:23], v5, s[16:19], s33 offen
  s_add_u32 s33, s33, 4096
  s_waitcnt lgkmcnt(2)
  buffer_store_dwordx4 v[24:27], v5, s[16:19], s33 offen
  s_add_u32 s33, s33, 4096
  s_waitcnt lgkmcnt(1)
  buffer_store_dwordx4 v[28:31], v5, s[16:19], s33 offen
  s_add_u32 s33, s33, 4096
  s_waitcnt lgkmcnt(0)
  buffer_store_dwordx4 v[32:35], v5, s[16:19], s34 offen
  s_endpgm
prep_wo:
  s_cmp_ge_u32 s2, 114
  s_cbranch_scc1 prep_zero
  s_sub_u32 s28, s2, 96
  s_mul_i32 s29, s28, 36
  s_sub_u32 s30, s28, 16
  s_mul_i32 s30, s30, 288
  s_add_u32 s30, s30, 16
  s_cmp_lt_u32 s28, 16
  s_cselect_b32 s29, s29, s30
  s_cselect_b32 s30, 18, 36
  s_cselect_b32 s31, 4, 72
  s_cselect_b32 s32, 2, 18
  s_lshr_b32 s33, s3, 1
  s_mul_i32 s33, s33, s30
  s_add_u32 s29, s29, s33
  s_and_b32 s33, s3, 1
  s_mul_i32 s33, s33, s31
  s_lshl_b32 s33, s33, 1
  s_add_u32 s29, s29, s33
  s_mul_i32 s29, s29, 1152
  s_mul_i32 s31, s31, 1152
  s_mul_i32 s32, s32, 1152
  s_mul_i32 s34, s3, 8448
  s_waitcnt lgkmcnt(0)
  s_mov_b32 s20, s10
  s_mov_b32 s21, s11
  s_mov_b32 s22, 663552
  s_mov_b32 s23, 0x20000
  s_mov_b32 s35, s29
  s_add_u32 m0, s34, 0
  s_nop 0
  buffer_load_dwordx4 v5, s[20:23], s35 offen lds
  s_mov_b32 s35, s29
  s_add_u32 s35, s35, 1152
  s_add_u32 m0, s34, 1056
  s_nop 0
  buffer_load_dwordx4 v5, s[20:23], s35 offen lds
  s_mov_b32 s35, s29
  s_add_u32 s35, s35, s32
  s_add_u32 m0, s34, 2112
  s_nop 0
  buffer_load_dwordx4 v5, s[20:23], s35 offen lds
  s_mov_b32 s35, s29
  s_add_u32 s35, s35, s32
  s_add_u32 s35, s35, 1152
  s_add_u32 m0, s34, 3168
  s_nop 0
  buffer_load_dwordx4 v5, s[20:23], s35 offen lds
  s_mov_b32 s35, s29
  s_add_u32 s35, s35, s31
  s_add_u32 m0, s34, 4224
  s_nop 0
  buffer_load_dwordx4 v5, s[20:23], s35 offen lds
  s_mov_b32 s35, s29
  s_add_u32 s35, s35, s31
  s_add_u32 s35, s35, 1152
  s_add_u32 m0, s34, 5280
  s_nop 0
  buffer_load_dwordx4 v5, s[20:23], s35 offen lds
  s_mov_b32 s35, s29
  s_add_u32 s35, s35, s31
  s_add_u32 s35, s35, s32
  s_add_u32 m0, s34, 6336
  s_nop 0
  buffer_load_dwordx4 v5, s[20:23], s35 offen lds
  s_mov_b32 s35, s29
  s_add_u32 s35, s35, s31
  s_add_u32 s35, s35, s32
  s_add_u32 s35, s35, 1152
  s_add_u32 m0, s34, 7392
  s_nop 0
  buffer_load_dwordx4 v5, s[20:23], s35 offen lds
  v_lshrrev_b32 v7, 5, v1
  v_mul_lo_u32 v7, v7, s31
  v_bfe_u32 v8, v1, 4, 1
  v_mul_lo_u32 v8, v8, s32
  v_bfe_u32 v9, v1, 3, 1
  v_mul_u32_u24 v9, 1152, v9
  v_add3_u32 v7, v7, v8, v9
  v_and_b32 v8, 7, v1
  v_lshl_add_u32 v7, v8, 4, v7
  s_lshl_b32 s34, s3, 10
  s_add_u32 m0, s34, 32768
  s_nop 0
  buffer_load_dwordx4 v7, s[20:23], s29 offen offset:1024 lds
  s_mov_b32 s16, s12
  s_mov_b32 s17, s13
  s_mov_b32 s18, 268435456
  s_mov_b32 s19, 0x20000
  v_lshrrev_b32 v10, 2, v3
  v_and_b32 v11, 3, v3
  v_lshl_add_u32 v12, v4, 2, v10
  s_lshl_b32 s35, s3, 5
  v_lshlrev_b32 v13, 3, v11
  v_add_u32 v13, s35, v13
  v_mul_u32_u24 v14, 1056, v12
  v_add_u32 v14, v14, v13
  v_lshl_add_u32 v15, v12, 7, v13
  v_add_u32 v15, 33792, v15
  s_and_b32 s36, s3, 1
  s_lshl_b32 s37, s36, 4
  v_add_u32 v16, s37, v3
  v_lshlrev_b32 v17, 4, v4
  v_mul_u32_u24 v18, 1056, v16
  v_add_u32 v18, v18, v17
  v_lshl_add_u32 v19, v16, 7, v17
  v_add_u32 v19, 33792, v19
  v_mov_b32 v20, 0x3f803f80
  v_mov_b32 v21, 0x3f803f80
  v_mov_b32 v22, 0x3f803f80
  v_mov_b32 v23, 0x3f803f80
  v_lshl_add_u32 v24, v10, 4, v4
  v_lshlrev_b32 v24, 4, v24
  v_lshl_add_u32 v24, v11, 1, v24
  s_lshl_b32 s37, s36, 3
  v_add_u32 v24, s37, v24
  v_cmp_gt_u32 vcc, 2, v4
  s_nop 1
  v_cndmask_b32 v24, v6, v24, vcc
  s_mul_i32 s38, s3, 18
  s_add_u32 s38, s38, s28
  s_lshl_b32 s38, s38, 10
  s_add_u32 s38, s38, 4456448
  s_waitcnt vmcnt(0)
  s_barrier
  ds_read_b64_tr_b16 v[32:33], v14 offset:0
  ds_read_b64_tr_b16 v[34:35], v14 offset:16896
  ds_read_b64_tr_b16 v[36:37], v14 offset:128
  ds_read_b64_tr_b16 v[38:39], v14 offset:17024
  ds_read_b64_tr_b16 v[40:41], v14 offset:256
  ds_read_b64_tr_b16 v[42:43], v14 offset:17152
  ds_read_b64_tr_b16 v[44:45], v14 offset:384
  ds_read_b64_tr_b16 v[46:47], v14 offset:17280
  ds_read_b64_tr_b16 v[48:49], v14 offset:512
  ds_read_b64_tr_b16 v[50:51], v14 offset:17408
  ds_read_b64_tr_b16 v[52:53], v14 offset:640
  ds_read_b64_tr_b16 v[54:55], v14 offset:17536
  ds_read_b64_tr_b16 v[56:57], v14 offset:768
  ds_read_b64_tr_b16 v[58:59], v14 offset:17664
  ds_read_b64_tr_b16 v[60:61], v14 offset:896
  ds_read_b64_tr_b16 v[62:63], v14 offset:17792
  ds_read_b64_tr_b16 v[64:65], v15 offset:0
  ds_read_b64_tr_b16 v[66:67], v15 offset:2048
  ds_read_b128 v[72:75], v18 offset:0
  ds_read_b128 v[76:79], v18 offset:64
  ds_read_b128 v[80:83], v18 offset:128
  ds_read_b128 v[84:87], v18 offset:192
  ds_read_b128 v[88:91], v18 offset:256
  ds_read_b128 v[92:95], v18 offset:320
  ds_read_b128 v[96:99], v18 offset:384
  ds_read_b128 v[100:103], v18 offset:448
  ds_read_b128 v[104:107], v18 offset:512
  ds_read_b128 v[108:111], v18 offset:576
  ds_read_b128 v[112:115], v18 offset:640
  ds_read_b128 v[116:119], v18 offset:704
  ds_read_b128 v[120:123], v18 offset:768
  ds_read_b128 v[124:127], v18 offset:832
  ds_read_b128 v[128:131], v18 offset:896
  ds_read_b128 v[132:135], v18 offset:960
  ds_read_b128 v[136:139], v19 offset:0
  ds_read_b128 v[140:143], v19 offset:64
  s_mov_b32 s65, s2
  s_mul_i32 s64, s65, 12288
  s_add_u32 s64, s64, 0
  v_lshlrev_b32 v243, 4, v0
  s_add_u32 s60, s12, 6324224
  s_addc_u32 s61, s13, 0
  s_mov_b32 s62, 3178496
  s_mov_b32 s63, 0x20000
  v_mov_b32 v244, -1
  v_mov_b32 v245, -1
  v_mov_b32 v246, -1
  v_mov_b32 v247, -1
  buffer_store_dwordx4 v[244:247], v243, s[60:63], s64 offen sc1
  s_add_u32 s64, s64, 4096
  buffer_store_dwordx4 v[244:247], v243, s[60:63], s64 offen sc1
  s_add_u32 s64, s64, 4096
  buffer_store_dwordx4 v[244:247], v243, s[60:63], s64 offen sc1
  s_add_u32 s64, s64, 4096
  s_waitcnt lgkmcnt(15)
  buffer_store_dwordx4 v[32:35], v5, s[16:19], s38 offen
  s_add_u32 s38, s38, 73728
  s_waitcnt lgkmcnt(15)
  buffer_store_dwordx4 v[36:39], v5, s[16:19], s38 offen
  s_add_u32 s38, s38, 73728
  s_waitcnt lgkmcnt(15)
  buffer_store_dwordx4 v[40:43], v5, s[16:19], s38 offen
  s_add_u32 s38, s38, 73728
  s_waitcnt lgkmcnt(15)
  buffer_store_dwordx4 v[44:47], v5, s[16:19], s38 offen
  s_add_u32 s38, s38, 73728
  s_waitcnt lgkmcnt(15)
  buffer_store_dwordx4 v[48:51], v5, s[16:19], s38 offen
  s_add_u32 s38, s38, 73728
  s_waitcnt lgkmcnt(15)
  buffer_store_dwordx4 v[52:55], v5, s[16:19], s38 offen
  s_add_u32 s38, s38, 73728
  s_waitcnt lgkmcnt(15)
  buffer_store_dwordx4 v[56:59], v5, s[16:19], s38 offen
  s_add_u32 s38, s38, 73728
  s_waitcnt lgkmcnt(15)
  buffer_store_dwordx4 v[60:63], v5, s[16:19], s38 offen
  s_add_u32 s38, s38, 73728
  s_waitcnt lgkmcnt(15)
  buffer_store_dwordx4 v[64:67], v5, s[16:19], s38 offen
  s_add_u32 s38, s38, 73728
  s_waitcnt lgkmcnt(15)
  v_mfma_f32_16x16x32_bf16 v[28:31], v[20:23], v[72:75], 0
  s_waitcnt lgkmcnt(15)
  v_mfma_f32_16x16x32_bf16 v[28:31], v[20:23], v[76:79], v[28:31]
  s_waitcnt lgkmcnt(15)
  v_mfma_f32_16x16x32_bf16 v[28:31], v[20:23], v[80:83], v[28:31]
  s_waitcnt lgkmcnt(14)
  v_mfma_f32_16x16x32_bf16 v[28:31], v[20:23], v[84:87], v[28:31]
  s_waitcnt lgkmcnt(13)
  v_mfma_f32_16x16x32_bf16 v[28:31], v[20:23], v[88:91], v[28:31]
  s_waitcnt lgkmcnt(12)
  v_mfma_f32_16x16x32_bf16 v[28:31], v[20:23], v[92:95], v[28:31]
  s_waitcnt lgkmcnt(11)
  v_mfma_f32_16x16x32_bf16 v[28:31], v[20:23], v[96:99], v[28:31]
  s_waitcnt lgkmcnt(10)
  v_mfma_f32_16x16x32_bf16 v[28:31], v[20:23], v[100:103], v[28:31]
  s_waitcnt lgkmcnt(9)
  v_mfma_f32_16x16x32_bf16 v[28:31], v[20:23], v[104:107], v[28:31]
  s_waitcnt lgkmcnt(8)
  v_mfma_f32_16x16x32_bf16 v[28:31], v[20:23], v[108:111], v[28:31]
  s_waitcnt lgkmcnt(7)
  v_mfma_f32_16x16x32_bf16 v[28:31], v[20:23], v[112:115], v[28:31]
  s_waitcnt lgkmcnt(6)
  v_mfma_f32_16x16x32_bf16 v[28:31], v[20:23], v[116:119], v[28:31]
  s_waitcnt lgkmcnt(5)
  v_mfma_f32_16x16x32_bf16 v[28:31], v[20:23], v[120:123], v[28:31]
  s_waitcnt lgkmcnt(4)
  v_mfma_f32_16x16x32_bf16 v[28:31], v[20:23], v[124:127], v[28:31]
  s_waitcnt lgkmcnt(3)
  v_mfma_f32_16x16x32_bf16 v[28:31], v[20:23], v[128:131], v[28:31]
  s_waitcnt lgkmcnt(2)
  v_mfma_f32_16x16x32_bf16 v[28:31], v[20:23], v[132:135], v[28:31]
  s_waitcnt lgkmcnt(1)
  v_mfma_f32_16x16x32_bf16 v[28:31], v[20:23], v[136:139], v[28:31]
  s_waitcnt lgkmcnt(0)
  v_mfma_f32_16x16x32_bf16 v[28:31], v[20:23], v[140:143], v[28:31]
  s_mov_b32 s31, 0x3ae38e39
  s_nop 6
  v_mul_f32 v28, s31, v28
  v_cvt_pk_bf16_f32 v29, v28, v28
  v_lshlrev_b32 v29, 16, v29
  v_sub_f32 v28, v28, v29
  v_cmp_eq_u32 vcc, 0, v4
  s_nop 1
  v_cndmask_b32 v28, v28, v29, vcc
  v_cvt_pk_bf16_f32 v28, v28, v28
  s_lshl_b32 s38, s28, 10
  s_add_u32 s38, s38, 5120000
  buffer_store_short v28, v24, s[16:19], s38 offen
  s_endpgm
prep_zero:
prep_fill:
  s_waitcnt lgkmcnt(0)
  s_sub_u32 s65, s2, 128
  s_cmp_lt_u32 s2, 120
  s_cselect_b32 s65, s2, s65
  s_mul_i32 s64, s65, 16384
  s_add_u32 s64, s64, 4294500352
  v_lshlrev_b32 v243, 4, v0
  s_add_u32 s60, s12, 6324224
  s_addc_u32 s61, s13, 0
  s_mov_b32 s62, 3178496
  s_mov_b32 s63, 0x20000
  v_mov_b32 v244, -1
  v_mov_b32 v245, -1
  v_mov_b32 v246, -1
  v_mov_b32 v247, -1
  buffer_store_dwordx4 v[244:247], v243, s[60:63], s64 offen sc1
  s_add_u32 s64, s64, 4096
  buffer_store_dwordx4 v[244:247], v243, s[60:63], s64 offen sc1
  s_add_u32 s64, s64, 4096
  buffer_store_dwordx4 v[244:247], v243, s[60:63], s64 offen sc1
  s_add_u32 s64, s64, 4096
  buffer_store_dwordx4 v[244:247], v243, s[60:63], s64 offen sc1
  s_add_u32 s64, s64, 4096
  s_endpgm
  s_cmp_ge_u32 s2, 116
  s_cbranch_scc1 prep_end
  s_sub_u32 s28, s2, 114
  s_lshl_b32 s28, s28, 12
  s_add_u32 s28, s28, 58720256
  v_lshlrev_b32 v7, 4, v0
  v_mov_b32 v8, 0
  v_mov_b32 v9, 0
  v_mov_b32 v10, 0
  v_mov_b32 v11, 0
  s_waitcnt lgkmcnt(0)
  s_mov_b32 s16, s12
  s_mov_b32 s17, s13
  s_mov_b32 s18, 268435456
  s_mov_b32 s19, 0x20000
  buffer_store_dwordx4 v[8:11], v7, s[16:19], s28 offen
prep_end:
  s_endpgm
prep_kernel_codeend:
.section .rodata,"a"
.p2align 6
.amdhsa_kernel prep_kernel
  .amdhsa_next_free_vgpr 256
  .amdhsa_next_free_sgpr 102
  .amdhsa_accum_offset 256
  .amdhsa_group_segment_fixed_size 0
  .amdhsa_kernarg_size 88
  .amdhsa_user_sgpr_count 2
  .amdhsa_user_sgpr_kernarg_segment_ptr 1
  .amdhsa_system_sgpr_workgroup_id_x 1
.end_amdhsa_kernel
.text
.globl attn_kernel
.p2align 8
.type attn_kernel,@function
attn_kernel:
  s_cmp_ge_u32 s2, 256
  s_cbranch_scc1 af_end
  s_load_dwordx2 s[12:13], s[0:1], 80
  s_load_dwordx2 s[56:57], s[0:1], 0
  s_load_dwordx4 s[44:47], s[0:1], 40
  v_and_b32 v1, 63, v0
  v_lshrrev_b32 v2, 6, v0
  s_nop 0
  v_readfirstlane_b32 s3, v2
  v_lshlrev_b32 v5, 4, v1
  s_and_b32 s4, s2, 7
  s_lshr_b32 s5, s2, 3
  s_and_b32 s6, s4, 3
  s_lshl_b32 s6, s6, 2
  s_and_b32 s7, s5, 3
  s_add_u32 s6, s6, s7
  s_lshr_b32 s7, s4, 2
  s_lshl_b32 s7, s7, 3
  s_lshr_b32 s5, s5, 2
  s_add_u32 s7, s7, s5
  s_lshl_b32 s8, s6, 3
  s_add_u32 s8, s8, s3
  s_lshl_b32 s9, s3, 10
  s_mul_i32 s10, s7, 129024
  s_add_u32 s10, s10, 2359296
  s_mul_i32 s11, s8, 18432
  s_add_u32 s10, s10, s9
  s_waitcnt lgkmcnt(0)
  s_mov_b32 s16, s12
  s_mov_b32 s17, s13
  s_mov_b32 s18, 268435456
  s_mov_b32 s19, 0x20000
  s_add_u32 m0, s9, 0
  s_nop 0
  buffer_load_dwordx4 v5, s[16:19], s10 offen lds
  s_add_u32 s10, s10, 8192
  s_add_u32 m0, s9, 8192
  s_nop 0
  buffer_load_dwordx4 v5, s[16:19], s10 offen lds
  s_add_u32 s10, s10, 8192
  buffer_load_dwordx4 v[16:19], v5, s[16:19], s11 offen offset:0
  s_add_u32 m0, s9, 16384
  s_nop 0
  buffer_load_dwordx4 v5, s[16:19], s10 offen lds
  s_add_u32 s10, s10, 8192
  buffer_load_dwordx4 v[20:23], v5, s[16:19], s11 offen offset:1024
  s_add_u32 m0, s9, 24576
  s_nop 0
  buffer_load_dwordx4 v5, s[16:19], s10 offen lds
  s_add_u32 s10, s10, 8192
  buffer_load_dwordx4 v[24:27], v5, s[16:19], s11 offen offset:2048
  s_add_u32 m0, s9, 32768
  s_nop 0
  buffer_load_dwordx4 v5, s[16:19], s10 offen lds
  s_add_u32 s10, s10, 8192
  buffer_load_dwordx4 v[28:31], v5, s[16:19], s11 offen offset:3072
  s_add_u32 s11, s11, 4096
  s_lshr_b32 s14, s2, 3
  s_mul_i32 s14, s14, 21504
  s_mul_i32 s36, s3, 7168
  s_add_u32 s14, s14, s36
  s_add_u32 s14, s14, 4420608
  s_cmp_lt_u32 s3, 5
  s_cselect_b32 s14, 1073741824, s14
  v_min_u32 v136, 880, v5
  v_lshlrev_b32 v136, 3, v136
  buffer_load_dword v137, v136, s[16:19], s14 offen
  v_and_b32 v3, 15, v1
  v_lshrrev_b32 v4, 4, v1
  v_mov_b32 v6, 0x40000000
  s_mul_i32 s20, s3, 2304
  v_lshlrev_b32 v7, 4, v3
  v_add_u32 v7, s20, v7
  v_lshl_add_u32 v8, v4, 10, v7
  v_lshl_add_u32 v9, v4, 3, v7
  s_mul_i32 s22, s3, 3840
  s_add_u32 s22, s22, 129024
  v_mul_u32_u24 v10, 240, v3
  v_add_u32 v10, s22, v10
  v_mul_u32_u24 v11, 80, v4
  v_add_u32 v11, v11, v10
  v_subrev_u32 v11, 160, v11
  v_lshl_add_u32 v12, v4, 3, v10
  v_mul_u32_u24 v13, 40, v4
  v_add_u32 v13, v13, v10
  s_mov_b32 s24, 1069066811
  s_mov_b32 s25, 3216550459
  s_cmp_ge_u32 s3, 3
  s_cselect_b32 s26, 1, 0
  s_mul_i32 s27, s26, 3
  s_sub_u32 s27, s3, s27
  s_mul_i32 s28, s26, 80
  s_lshl_b32 s29, s27, 3
  s_cmp_lt_u32 s27, 2
  s_cselect_b32 s29, s29, 64
  s_cselect_b32 s30, 16, 0
  s_add_u32 s28, s28, s29
  s_add_u32 s28, s28, 129024
  s_mul_i32 s29, s26, 40
  s_add_u32 s29, s29, 129184
  v_lshrrev_b32 v7, 2, v3
  v_and_b32 v10, 3, v3
  v_lshl_add_u32 v7, v4, 3, v7
  v_mul_u32_u24 v7, 240, v7
  v_mul_u32_u24 v124, s30, v10
  v_add3_u32 v124, v124, v7, s28
  v_add_u32 v126, s29, v7
  v_lshl_add_u32 v125, v10, 3, v126
  s_lshl_b32 s31, s7, 4
  s_add_u32 s31, s31, s6
  s_mul_i32 s31, s31, 3200
  s_mul_i32 s32, s26, 1600
  s_add_u32 s31, s31, s32
  s_add_u32 s31, s31, 6324224
  s_lshl_b32 s32, s27, 10
  v_lshl_add_u32 v2, v1, 4, s32
  s_lshl_b32 s32, s27, 8
  v_lshl_add_u32 v7, v3, 2, v4
  v_lshl_add_u32 v7, v7, 4, s32
  v_add_u32 v7, 2560, v7
  v_xor_b32 v10, s26, v4
  v_lshl_add_u32 v10, v3, 1, v10
  v_lshlrev_b32 v10, 4, v10
  v_cmp_gt_u32 vcc, 2, v4
  s_nop 1
  v_cndmask_b32 v10, v6, v10, vcc
  s_cmp_eq_u32 s27, 2
  s_cselect_b64 vcc, -1, 0
  v_add_u32 v14, 2048, v10
  v_cndmask_b32 v2, v2, v14, vcc
  v_add_u32 v14, 3072, v10
  v_cndmask_b32 v7, v7, v14, vcc
  v_cmp_gt_u32 vcc, 4, v3
  s_nop 1
  v_cndmask_b32 v7, v6, v7, vcc
  v_lshrrev_b32 v2, 1, v2
  v_lshrrev_b32 v7, 1, v7
  s_cmp_eq_u32 s27, 2
  s_cselect_b32 s34, 0xffff, -1
  s_cselect_b32 s35, 0, -1
  s_mul_i32 s60, s7, 51200
  s_add_u32 s60, s60, 6324224
  s_add_u32 s61, s60, 3200
  s_add_u32 s62, s61, 3200
  s_add_u32 s63, s62, 3200
  s_add_u32 s64, s63, 3200
  s_add_u32 s65, s64, 3200
  s_add_u32 s66, s65, 3200
  s_add_u32 s67, s66, 3200
  s_add_u32 s68, s67, 3200
  s_add_u32 s69, s68, 3200
  s_add_u32 s70, s69, 3200
  s_add_u32 s71, s70, 3200
  s_add_u32 s72, s71, 3200
  s_add_u32 s73, s72, 3200
  s_add_u32 s74, s73, 3200
  s_add_u32 s75, s74, 3200
  s_mul_i32 s22, s8, 18
  s_add_u32 s23, s22, s7
  s_lshl_b32 s23, s23, 10
  s_add_u32 s23, s23, 7143424
  s_lshr_b32 s14, s7, 3
  s_add_u32 s22, s22, s14
  s_lshl_b32 s22, s22, 10
  s_bfe_u32 s14, s7, 0x20001
  s_lshl_b32 s14, s14, 8
  s_add_u32 s22, s22, s14
  s_and_b32 s14, s7, 1
  s_lshl_b32 s14, s14, 7
  s_add_u32 s22, s22, s14
  s_add_u32 s22, s22, 7159808
  s_lshl_b32 s37, s6, 2
  s_lshr_b32 s14, s7, 2
  s_add_u32 s37, s37, s14
  s_and_b32 s38, s7, 3
  s_and_b32 s14, s38, 1
  s_lshl_b32 s15, s3, 1
  s_add_u32 s15, s15, s14
  s_xor_b32 s39, s14, 1
  s_lshl_b32 s39, s39, 3
  s_cmp_lt_u32 s3, 4
  s_cselect_b32 s15, s15, s39
  s_mul_i32 s39, s38, 9
  s_add_u32 s39, s39, s15
  s_add_u32 s40, s39, 1
  s_cmp_lt_u32 s3, 4
  s_cselect_b32 s40, s40, 36
  s_mul_i32 s50, s39, 18432
  s_add_u32 s50, s50, 4456448
  s_mul_i32 s51, s40, 18432
  s_add_u32 s51, s51, 4456448
  s_mul_i32 s52, s37, 36864
  s_mul_i32 s14, s38, 288
  s_add_u32 s53, s52, s14
  s_add_u32 s52, s52, s9
  s_add_u32 s52, s52, 7143424
  s_mov_b32 s58, 2359296
  s_mov_b32 s59, 0x20000
  s_lshl_b32 s80, s7, 11
  s_add_u32 s80, s80, 9502720
  s_lshl_b32 s14, s6, 7
  s_add_u32 s81, s80, s14
  s_lshl_b32 s36, s3, 2
  s_add_u32 s81, s81, s36
  s_lshl_b32 s82, s6, 11
  s_add_u32 s82, s82, 9535488
  s_lshl_b32 s14, s7, 7
  s_add_u32 s83, s82, s14
  s_add_u32 s83, s83, s36
  s_lshr_b32 s14, s7, 2
  s_lshl_b32 s14, s14, 3
  s_add_u32 s82, s82, s14
  v_add_u32 v14, 0x10000, v5
  s_cmp_lt_u32 s3, 5
  s_cselect_b32 s50, s50, 1073741824
  s_cselect_b32 s51, s51, 1073741824
  v_lshlrev_b32 v15, 2, v3
  s_lshl_b32 s29, s37, 7
  s_add_u32 s29, s29, 5242880
  s_sub_u32 s21, s9, 5120
  s_lshr_b32 s14, s21, 4
  v_add_u32 v131, s14, v1
  v_add_u32 v131, 0, v131
  v_mul_u32_u24 v132, 3641, v131
  v_lshrrev_b32 v132, 16, v132
  v_mul_u32_u24 v133, 18, v132
  v_sub_u32 v133, v131, v133
  v_mul_u32_u24 v132, 1152, v132
  v_lshl_add_u32 v128, v133, 4, v132
  v_add_u32 v131, s14, v1
  v_add_u32 v131, 192, v131
  v_mul_u32_u24 v132, 3641, v131
  v_lshrrev_b32 v132, 16, v132
  v_mul_u32_u24 v133, 18, v132
  v_sub_u32 v133, v131, v133
  v_mul_u32_u24 v132, 1152, v132
  v_lshl_add_u32 v129, v133, 4, v132
  v_add_u32 v131, s14, v1
  v_add_u32 v131, 384, v131
  v_mul_u32_u24 v132, 3641, v131
  v_lshrrev_b32 v132, 16, v132
  v_mul_u32_u24 v133, 18, v132
  v_sub_u32 v133, v131, v133
  v_mul_u32_u24 v132, 1152, v132
  v_lshl_add_u32 v130, v133, 4, v132
  buffer_load_dword v1, v15, s[16:19], s29 offen
  buffer_load_dword v15, v15, s[16:19], s29 offen offset:64
  s_waitcnt vmcnt(11)
  s_barrier
  ds_read_b128 v[40:43], v5 offset:0
  ds_read_b128 v[44:47], v5 offset:1024
  ds_read_b128 v[48:51], v5 offset:2048
  ds_read_b128 v[52:55], v5 offset:3072
  ds_read_b128 v[56:59], v5 offset:4096
  ds_read_b128 v[60:63], v5 offset:5120
  ds_read_b128 v[64:67], v5 offset:6144
  s_waitcnt vmcnt(8)
  s_barrier
  ds_read_b128 v[68:71], v5 offset:7168
  ds_read_b128 v[72:75], v5 offset:8192
  s_waitcnt lgkmcnt(8)
  v_mfma_f32_16x16x32_bf16 v[96:99], v[40:43], v[16:19], 0
  ds_read_b128 v[76:79], v5 offset:9216
  s_waitcnt lgkmcnt(8)
  v_mfma_f32_16x16x32_bf16 v[100:103], v[44:47], v[16:19], 0
  ds_read_b128 v[80:83], v5 offset:10240
  s_waitcnt lgkmcnt(8)
  v_mfma_f32_16x16x32_bf16 v[104:107], v[48:51], v[16:19], 0
  ds_read_b128 v[84:87], v5 offset:11264
  s_add_u32 m0, s9, 40960
  s_nop 0
  buffer_load_dwordx4 v5, s[16:19], s10 offen lds
  s_add_u32 s10, s10, 8192
  s_waitcnt lgkmcnt(8)
  v_mfma_f32_16x16x32_bf16 v[108:111], v[52:55], v[16:19], 0
  ds_read_b128 v[88:91], v5 offset:12288
  buffer_load_dwordx4 v[32:35], v5, s[16:19], s11 offen offset:0
  s_waitcnt lgkmcnt(8)
  v_mfma_f32_16x16x32_bf16 v[112:115], v[56:59], v[16:19], 0
  ds_read_b128 v[92:95], v5 offset:13312
  s_waitcnt lgkmcnt(8)
  v_mfma_f32_16x16x32_bf16 v[116:119], v[60:63], v[16:19], 0
  s_waitcnt lgkmcnt(7)
  v_mfma_f32_16x16x32_bf16 v[120:123], v[64:67], v[16:19], 0
  ds_read_b128 v[40:43], v5 offset:14336
  ds_read_b128 v[44:47], v5 offset:15360
  s_waitcnt vmcnt(9) lgkmcnt(8)
  v_mfma_f32_16x16x32_bf16 v[96:99], v[68:71], v[20:23], v[96:99]
  ds_read_b128 v[48:51], v5 offset:16384
  s_waitcnt lgkmcnt(8)
  v_mfma_f32_16x16x32_bf16 v[100:103], v[72:75], v[20:23], v[100:103]
  ds_read_b128 v[52:55], v5 offset:17408
  s_waitcnt lgkmcnt(8)
  v_mfma_f32_16x16x32_bf16 v[104:107], v[76:79], v[20:23], v[104:107]
  ds_read_b128 v[56:59], v5 offset:18432
  s_add_u32 m0, s9, 49152
  s_nop 0
  buffer_load_dwordx4 v5, s[16:19], s10 offen lds
  s_add_u32 s10, s10, 8192
  s_waitcnt lgkmcnt(8)
  v_mfma_f32_16x16x32_bf16 v[108:111], v[80:83], v[20:23], v[108:111]
  ds_read_b128 v[60:63], v5 offset:19456
  buffer_load_dwordx4 v[36:39], v5, s[16:19], s11 offen offset:1024
  s_waitcnt lgkmcnt(8)
  v_mfma_f32_16x16x32_bf16 v[112:115], v[84:87], v[20:23], v[112:115]
  ds_read_b128 v[64:67], v5 offset:20480
  s_waitcnt lgkmcnt(8)
  v_mfma_f32_16x16x32_bf16 v[116:119], v[88:91], v[20:23], v[116:119]
  s_waitcnt lgkmcnt(7)
  v_mfma_f32_16x16x32_bf16 v[120:123], v[92:95], v[20:23], v[120:123]
  s_waitcnt vmcnt(8)
  s_barrier
  ds_read_b128 v[68:71], v5 offset:21504
  ds_read_b128 v[72:75], v5 offset:22528
  s_waitcnt lgkmcnt(8)
  v_mfma_f32_16x16x32_bf16 v[96:99], v[40:43], v[24:27], v[96:99]
  ds_read_b128 v[76:79], v5 offset:23552
  s_waitcnt lgkmcnt(8)
  v_mfma_f32_16x16x32_bf16 v[100:103], v[44:47], v[24:27], v[100:103]
  ds_read_b128 v[80:83], v5 offset:24576
  s_waitcnt lgkmcnt(8)
  v_mfma_f32_16x16x32_bf16 v[104:107], v[48:51], v[24:27], v[104:107]
  ds_read_b128 v[84:87], v5 offset:25600
  buffer_load_dwordx4 v[16:19], v5, s[16:19], s11 offen offset:2048
  s_waitcnt lgkmcnt(8)
  v_mfma_f32_16x16x32_bf16 v[108:111], v[52:55], v[24:27], v[108:111]
  ds_read_b128 v[88:91], v5 offset:26624
  s_waitcnt lgkmcnt(8)
  v_mfma_f32_16x16x32_bf16 v[112:115], v[56:59], v[24:27], v[112:115]
  ds_read_b128 v[92:95], v5 offset:27648
  s_waitcnt lgkmcnt(8)
  v_mfma_f32_16x16x32_bf16 v[116:119], v[60:63], v[24:27], v[116:119]
  s_waitcnt lgkmcnt(7)
  v_mfma_f32_16x16x32_bf16 v[120:123], v[64:67], v[24:27], v[120:123]
  ds_read_b128 v[40:43], v5 offset:28672
  ds_read_b128 v[44:47], v5 offset:29696
  s_waitcnt vmcnt(8) lgkmcnt(8)
  v_mfma_f32_16x16x32_bf16 v[96:99], v[68:71], v[28:31], v[96:99]
  ds_read_b128 v[48:51], v5 offset:30720
  s_waitcnt lgkmcnt(8)
  v_mfma_f32_16x16x32_bf16 v[100:103], v[72:75], v[28:31], v[100:103]
  ds_read_b128 v[52:55], v5 offset:31744
  s_waitcnt lgkmcnt(8)
  v_mfma_f32_16x16x32_bf16 v[104:107], v[76:79], v[28:31], v[104:107]
  ds_read_b128 v[56:59], v5 offset:32768
  s_add_u32 m0, s9, 57344
  s_nop 0
  buffer_load_dwordx4 v5, s[16:19], s10 offen lds
  s_add_u32 s10, s10, 8192
  s_waitcnt lgkmcnt(8)
  v_mfma_f32_16x16x32_bf16 v[108:111], v[80:83], v[28:31], v[108:111]
  ds_read_b128 v[60:63], v5 offset:33792
  buffer_load_dwordx4 v[20:23], v5, s[16:19], s11 offen offset:3072
  s_add_u32 s11, s11, 4096
  s_waitcnt lgkmcnt(8)
  v_mfma_f32_16x16x32_bf16 v[112:115], v[84:87], v[28:31], v[112:115]
  ds_read_b128 v[64:67], v5 offset:34816
  s_waitcnt lgkmcnt(8)
  v_mfma_f32_16x16x32_bf16 v[116:119], v[88:91], v[28:31], v[116:119]
  s_waitcnt lgkmcnt(7)
  v_mfma_f32_16x16x32_bf16 v[120:123], v[92:95], v[28:31], v[120:123]
  s_waitcnt vmcnt(4)
  s_barrier
  ds_read_b128 v[68:71], v5 offset:35840
  ds_read_b128 v[72:75], v5 offset:36864
  s_waitcnt lgkmcnt(8)
  v_mfma_f32_16x16x32_bf16 v[96:99], v[40:43], v[32:35], v[96:99]
  ds_read_b128 v[76:79], v5 offset:37888
  s_waitcnt lgkmcnt(8)
  v_mfma_f32_16x16x32_bf16 v[100:103], v[44:47], v[32:35], v[100:103]
  ds_read_b128 v[80:83], v5 offset:38912
  s_waitcnt lgkmcnt(8)
  v_mfma_f32_16x16x32_bf16 v[104:107], v[48:51], v[32:35], v[104:107]
  ds_read_b128 v[84:87], v5 offset:39936
  s_add_u32 m0, s9, 65536
  s_nop 0
  buffer_load_dwordx4 v5, s[16:19], s10 offen lds
  s_add_u32 s10, s10, 8192
  s_waitcnt lgkmcnt(8)
  v_mfma_f32_16x16x32_bf16 v[108:111], v[52:55], v[32:35], v[108:111]
  ds_read_b128 v[88:91], v5 offset:40960
  buffer_load_dwordx4 v[24:27], v5, s[16:19], s11 offen offset:0
  s_waitcnt lgkmcnt(8)
  v_mfma_f32_16x16x32_bf16 v[112:115], v[56:59], v[32:35], v[112:115]
  ds_read_b128 v[92:95], v5 offset:41984
  s_waitcnt lgkmcnt(8)
  v_mfma_f32_16x16x32_bf16 v[116:119], v[60:63], v[32:35], v[116:119]
  s_waitcnt lgkmcnt(7)
  v_mfma_f32_16x16x32_bf16 v[120:123], v[64:67], v[32:35], v[120:123]
  ds_read_b128 v[40:43], v5 offset:43008
  ds_read_b128 v[44:47], v5 offset:44032
  s_waitcnt vmcnt(5) lgkmcnt(8)
  v_mfma_f32_16x16x32_bf16 v[96:99], v[68:71], v[36:39], v[96:99]
  ds_read_b128 v[48:51], v5 offset:45056
  s_waitcnt lgkmcnt(8)
  v_mfma_f32_16x16x32_bf16 v[100:103], v[72:75], v[36:39], v[100:103]
  ds_read_b128 v[52:55], v5 offset:46080
  s_waitcnt lgkmcnt(8)
  v_mfma_f32_16x16x32_bf16 v[104:107], v[76:79], v[36:39], v[104:107]
  ds_read_b128 v[56:59], v5 offset:47104
  s_add_u32 m0, s9, 73728
  s_nop 0
  buffer_load_dwordx4 v5, s[16:19], s10 offen lds
  s_add_u32 s10, s10, 8192
  s_waitcnt lgkmcnt(8)
  v_mfma_f32_16x16x32_bf16 v[108:111], v[80:83], v[36:39], v[108:111]
  ds_read_b128 v[60:63], v5 offset:48128
  buffer_load_dwordx4 v[28:31], v5, s[16:19], s11 offen offset:1024
  s_waitcnt lgkmcnt(8)
  v_mfma_f32_16x16x32_bf16 v[112:115], v[84:87], v[36:39], v[112:115]
  ds_read_b128 v[64:67], v5 offset:49152
  s_waitcnt lgkmcnt(8)
  v_mfma_f32_16x16x32_bf16 v[116:119], v[88:91], v[36:39], v[116:119]
  s_waitcnt lgkmcnt(7)
  v_mfma_f32_16x16x32_bf16 v[120:123], v[92:95], v[36:39], v[120:123]
  s_waitcnt vmcnt(5)
  s_barrier
  ds_read_b128 v[68:71], v5 offset:50176
  ds_read_b128 v[72:75], v5 offset:51200
  s_waitcnt lgkmcnt(8)
  v_mfma_f32_16x16x32_bf16 v[96:99], v[40:43], v[16:19], v[96:99]
  ds_read_b128 v[76:79], v5 offset:52224
  s_waitcnt lgkmcnt(8)
  v_mfma_f32_16x16x32_bf16 v[100:103], v[44:47], v[16:19], v[100:103]
  ds_read_b128 v[80:83], v5 offset:53248
  s_waitcnt lgkmcnt(8)
  v_mfma_f32_16x16x32_bf16 v[104:107], v[48:51], v[16:19], v[104:107]
  ds_read_b128 v[84:87], v5 offset:54272
  s_add_u32 m0, s9, 81920
  s_nop 0
  buffer_load_dwordx4 v5, s[16:19], s10 offen lds
  s_add_u32 s10, s10, 8192
  s_waitcnt lgkmcnt(8)
  v_mfma_f32_16x16x32_bf16 v[108:111], v[52:55], v[16:19], v[108:111]
  ds_read_b128 v[88:91], v5 offset:55296
  buffer_load_dwordx4 v[32:35], v5, s[16:19], s11 offen offset:2048
  s_waitcnt lgkmcnt(8)
  v_mfma_f32_16x16x32_bf16 v[112:115], v[56:59], v[16:19], v[112:115]
  ds_read_b128 v[92:95], v5 offset:56320
  s_waitcnt lgkmcnt(8)
  v_mfma_f32_16x16x32_bf16 v[116:119], v[60:63], v[16:19], v[116:119]
  s_waitcnt lgkmcnt(7)
  v_mfma_f32_16x16x32_bf16 v[120:123], v[64:67], v[16:19], v[120:123]
  ds_read_b128 v[40:43], v5 offset:57344
  ds_read_b128 v[44:47], v5 offset:58368
  s_waitcnt vmcnt(6) lgkmcnt(8)
  v_mfma_f32_16x16x32_bf16 v[96:99], v[68:71], v[20:23], v[96:99]
  ds_read_b128 v[48:51], v5 offset:59392
  s_waitcnt lgkmcnt(8)
  v_mfma_f32_16x16x32_bf16 v[100:103], v[72:75], v[20:23], v[100:103]
  ds_read_b128 v[52:55], v5 offset:60416
  s_waitcnt lgkmcnt(8)
  v_mfma_f32_16x16x32_bf16 v[104:107], v[76:79], v[20:23], v[104:107]
  ds_read_b128 v[56:59], v5 offset:61440
  s_add_u32 m0, s9, 90112
  s_nop 0
  buffer_load_dwordx4 v5, s[16:19], s10 offen lds
  s_add_u32 s10, s10, 8192
  s_waitcnt lgkmcnt(8)
  v_mfma_f32_16x16x32_bf16 v[108:111], v[80:83], v[20:23], v[108:111]
  ds_read_b128 v[60:63], v5 offset:62464
  buffer_load_dwordx4 v[36:39], v5, s[16:19], s11 offen offset:3072
  s_add_u32 s11, s11, 4096
  s_waitcnt lgkmcnt(8)
  v_mfma_f32_16x16x32_bf16 v[112:115], v[84:87], v[20:23], v[112:115]
  ds_read_b128 v[64:67], v5 offset:63488
  s_waitcnt lgkmcnt(8)
  v_mfma_f32_16x16x32_bf16 v[116:119], v[88:91], v[20:23], v[116:119]
  s_waitcnt lgkmcnt(7)
  v_mfma_f32_16x16x32_bf16 v[120:123], v[92:95], v[20:23], v[120:123]
  s_waitcnt vmcnt(5)
  s_barrier
  ds_read_b128 v[68:71], v5 offset:64512
  ds_read_b128 v[72:75], v14 offset:0
  s_waitcnt lgkmcnt(8)
  v_mfma_f32_16x16x32_bf16 v[96:99], v[40:43], v[24:27], v[96:99]
  ds_read_b128 v[76:79], v14 offset:1024
  s_waitcnt lgkmcnt(8)
  v_mfma_f32_16x16x32_bf16 v[100:103], v[44:47], v[24:27], v[100:103]
  ds_read_b128 v[80:83], v14 offset:2048
  s_waitcnt lgkmcnt(8)
  v_mfma_f32_16x16x32_bf16 v[104:107], v[48:51], v[24:27], v[104:107]
  ds_read_b128 v[84:87], v14 offset:3072
  s_add_u32 m0, s9, 98304
  s_nop 0
  buffer_load_dwordx4 v5, s[16:19], s10 offen lds
  s_add_u32 s10, s10, 8192
  s_waitcnt lgkmcnt(8)
  v_mfma_f32_16x16x32_bf16 v[108:111], v[52:55], v[24:27], v[108:111]
  ds_read_b128 v[88:91], v14 offset:4096
  buffer_load_dwordx4 v[16:19], v5, s[16:19], s11 offen offset:0
  s_waitcnt lgkmcnt(8)
  v_mfma_f32_16x16x32_bf16 v[112:115], v[56:59], v[24:27], v[112:115]
  ds_read_b128 v[92:95], v14 offset:5120
  s_waitcnt lgkmcnt(8)
  v_mfma_f32_16x16x32_bf16 v[116:119], v[60:63], v[24:27], v[116:119]
  s_waitcnt lgkmcnt(7)
  v_mfma_f32_16x16x32_bf16 v[120:123], v[64:67], v[24:27], v[120:123]
  ds_read_b128 v[40:43], v14 offset:6144
  ds_read_b128 v[44:47], v14 offset:7168
  s_waitcnt vmcnt(6) lgkmcnt(8)
  v_mfma_f32_16x16x32_bf16 v[96:99], v[68:71], v[28:31], v[96:99]
  ds_read_b128 v[48:51], v14 offset:8192
  s_waitcnt lgkmcnt(8)
  v_mfma_f32_16x16x32_bf16 v[100:103], v[72:75], v[28:31], v[100:103]
  ds_read_b128 v[52:55], v14 offset:9216
  s_waitcnt lgkmcnt(8)
  v_mfma_f32_16x16x32_bf16 v[104:107], v[76:79], v[28:31], v[104:107]
  ds_read_b128 v[56:59], v14 offset:10240
  s_add_u32 m0, s9, 106496
  s_nop 0
  buffer_load_dwordx4 v5, s[16:19], s10 offen lds
  s_add_u32 s10, s10, 8192
  s_waitcnt lgkmcnt(8)
  v_mfma_f32_16x16x32_bf16 v[108:111], v[80:83], v[28:31], v[108:111]
  ds_read_b128 v[60:63], v14 offset:11264
  buffer_load_dwordx4 v[20:23], v5, s[16:19], s11 offen offset:1024
  s_waitcnt lgkmcnt(8)
  v_mfma_f32_16x16x32_bf16 v[112:115], v[84:87], v[28:31], v[112:115]
  ds_read_b128 v[64:67], v14 offset:12288
  s_waitcnt lgkmcnt(8)
  v_mfma_f32_16x16x32_bf16 v[116:119], v[88:91], v[28:31], v[116:119]
  s_waitcnt lgkmcnt(7)
  v_mfma_f32_16x16x32_bf16 v[120:123], v[92:95], v[28:31], v[120:123]
  s_waitcnt vmcnt(5)
  s_barrier
  ds_read_b128 v[68:71], v14 offset:13312
  ds_read_b128 v[72:75], v14 offset:14336
  s_waitcnt lgkmcnt(8)
  v_mfma_f32_16x16x32_bf16 v[96:99], v[40:43], v[32:35], v[96:99]
  ds_read_b128 v[76:79], v14 offset:15360
  s_waitcnt lgkmcnt(8)
  v_mfma_f32_16x16x32_bf16 v[100:103], v[44:47], v[32:35], v[100:103]
  ds_read_b128 v[80:83], v14 offset:16384
  s_waitcnt lgkmcnt(8)
  v_mfma_f32_16x16x32_bf16 v[104:107], v[48:51], v[32:35], v[104:107]
  ds_read_b128 v[84:87], v14 offset:17408
  buffer_load_dwordx4 v[24:27], v5, s[16:19], s11 offen offset:2048
  s_waitcnt lgkmcnt(8)
  v_mfma_f32_16x16x32_bf16 v[108:111], v[52:55], v[32:35], v[108:111]
  ds_read_b128 v[88:91], v14 offset:18432
  s_waitcnt lgkmcnt(8)
  v_mfma_f32_16x16x32_bf16 v[112:115], v[56:59], v[32:35], v[112:115]
  ds_read_b128 v[92:95], v14 offset:19456
  s_waitcnt lgkmcnt(8)
  v_mfma_f32_16x16x32_bf16 v[116:119], v[60:63], v[32:35], v[116:119]
  s_waitcnt lgkmcnt(7)
  v_mfma_f32_16x16x32_bf16 v[120:123], v[64:67], v[32:35], v[120:123]
  ds_read_b128 v[40:43], v14 offset:20480
  ds_read_b128 v[44:47], v14 offset:21504
  s_waitcnt vmcnt(5) lgkmcnt(8)
  v_mfma_f32_16x16x32_bf16 v[96:99], v[68:71], v[36:39], v[96:99]
  ds_read_b128 v[48:51], v14 offset:22528
  s_waitcnt lgkmcnt(8)
  v_mfma_f32_16x16x32_bf16 v[100:103], v[72:75], v[36:39], v[100:103]
  ds_read_b128 v[52:55], v14 offset:23552
  s_waitcnt lgkmcnt(8)
  v_mfma_f32_16x16x32_bf16 v[104:107], v[76:79], v[36:39], v[104:107]
  ds_read_b128 v[56:59], v14 offset:24576
  s_add_u32 m0, s9, 114688
  s_nop 0
  buffer_load_dwordx4 v5, s[16:19], s10 offen lds
  s_add_u32 s10, s10, 8192
  s_waitcnt lgkmcnt(8)
  v_mfma_f32_16x16x32_bf16 v[108:111], v[80:83], v[36:39], v[108:111]
  ds_read_b128 v[60:63], v14 offset:25600
  buffer_load_dwordx4 v[28:31], v5, s[16:19], s11 offen offset:3072
  s_add_u32 s11, s11, 4096
  s_waitcnt lgkmcnt(8)
  v_mfma_f32_16x16x32_bf16 v[112:115], v[84:87], v[36:39], v[112:115]
  ds_read_b128 v[64:67], v14 offset:26624
  s_waitcnt lgkmcnt(8)
  v_mfma_f32_16x16x32_bf16 v[116:119], v[88:91], v[36:39], v[116:119]
  s_waitcnt lgkmcnt(7)
  v_mfma_f32_16x16x32_bf16 v[120:123], v[92:95], v[36:39], v[120:123]
  s_waitcnt vmcnt(4)
  s_barrier
  ds_read_b128 v[68:71], v14 offset:27648
  ds_read_b128 v[72:75], v14 offset:28672
  s_waitcnt lgkmcnt(8)
  v_mfma_f32_16x16x32_bf16 v[96:99], v[40:43], v[16:19], v[96:99]
  ds_read_b128 v[76:79], v14 offset:29696
  s_waitcnt lgkmcnt(8)
  v_mfma_f32_16x16x32_bf16 v[100:103], v[44:47], v[16:19], v[100:103]
  ds_read_b128 v[80:83], v14 offset:30720
  s_waitcnt lgkmcnt(8)
  v_mfma_f32_16x16x32_bf16 v[104:107], v[48:51], v[16:19], v[104:107]
  ds_read_b128 v[84:87], v14 offset:31744
  s_add_u32 m0, s9, 122880
  s_nop 0
  buffer_load_dwordx4 v5, s[16:19], s10 offen lds
  s_add_u32 s10, s10, 8192
  s_waitcnt lgkmcnt(8)
  v_mfma_f32_16x16x32_bf16 v[108:111], v[52:55], v[16:19], v[108:111]
  ds_read_b128 v[88:91], v14 offset:32768
  buffer_load_dwordx4 v[32:35], v5, s[16:19], s11 offen offset:0
  s_waitcnt lgkmcnt(8)
  v_mfma_f32_16x16x32_bf16 v[112:115], v[56:59], v[16:19], v[112:115]
  ds_read_b128 v[92:95], v14 offset:33792
  s_waitcnt lgkmcnt(8)
  v_mfma_f32_16x16x32_bf16 v[116:119], v[60:63], v[16:19], v[116:119]
  s_waitcnt lgkmcnt(7)
  v_mfma_f32_16x16x32_bf16 v[120:123], v[64:67], v[16:19], v[120:123]
  ds_read_b128 v[40:43], v14 offset:34816
  ds_read_b128 v[44:47], v14 offset:35840
  s_waitcnt vmcnt(5) lgkmcnt(8)
  v_mfma_f32_16x16x32_bf16 v[96:99], v[68:71], v[20:23], v[96:99]
  ds_read_b128 v[48:51], v14 offset:36864
  s_waitcnt lgkmcnt(8)
  v_mfma_f32_16x16x32_bf16 v[100:103], v[72:75], v[20:23], v[100:103]
  ds_read_b128 v[52:55], v14 offset:37888
  s_waitcnt lgkmcnt(8)
  v_mfma_f32_16x16x32_bf16 v[104:107], v[76:79], v[20:23], v[104:107]
  ds_read_b128 v[56:59], v14 offset:38912
  buffer_load_dwordx4 v[36:39], v5, s[16:19], s11 offen offset:1024
  s_waitcnt lgkmcnt(8)
  v_mfma_f32_16x16x32_bf16 v[108:111], v[80:83], v[20:23], v[108:111]
  ds_read_b128 v[60:63], v14 offset:39936
  s_waitcnt lgkmcnt(8)
  v_mfma_f32_16x16x32_bf16 v[112:115], v[84:87], v[20:23], v[112:115]
  ds_read_b128 v[64:67], v14 offset:40960
  s_waitcnt lgkmcnt(8)
  v_mfma_f32_16x16x32_bf16 v[116:119], v[88:91], v[20:23], v[116:119]
  s_waitcnt lgkmcnt(7)
  v_mfma_f32_16x16x32_bf16 v[120:123], v[92:95], v[20:23], v[120:123]
  s_waitcnt vmcnt(4)
  s_barrier
  s_cmp_lt_u32 s3, 5
  s_cbranch_scc1 af_nox
  s_add_u32 m0, s21, 61440
  s_nop 0
  buffer_load_dwordx4 v128, s[56:59], s53 offen lds
  s_add_u32 m0, s21, 64512
  s_nop 0
  buffer_load_dwordx4 v129, s[56:59], s53 offen lds
  s_add_u32 m0, s21, 67584
  s_nop 0
  buffer_load_dwordx4 v130, s[56:59], s53 offen lds
af_nox:
  ds_read_b128 v[68:71], v14 offset:41984
  ds_read_b128 v[72:75], v14 offset:43008
  s_waitcnt lgkmcnt(8)
  v_mfma_f32_16x16x32_bf16 v[96:99], v[40:43], v[24:27], v[96:99]
  ds_read_b128 v[76:79], v14 offset:44032
  s_waitcnt lgkmcnt(8)
  v_mfma_f32_16x16x32_bf16 v[100:103], v[44:47], v[24:27], v[100:103]
  ds_read_b128 v[80:83], v14 offset:45056
  s_waitcnt lgkmcnt(8)
  v_mfma_f32_16x16x32_bf16 v[104:107], v[48:51], v[24:27], v[104:107]
  ds_read_b128 v[84:87], v14 offset:46080
  buffer_load_dwordx4 v[128:131], v5, s[16:19], s50 offen offset:0
  s_waitcnt lgkmcnt(8)
  v_mfma_f32_16x16x32_bf16 v[108:111], v[52:55], v[24:27], v[108:111]
  ds_read_b128 v[88:91], v14 offset:47104
  buffer_load_dwordx4 v[132:135], v5, s[16:19], s51 offen offset:0
  s_waitcnt lgkmcnt(8)
  v_mfma_f32_16x16x32_bf16 v[112:115], v[56:59], v[24:27], v[112:115]
  ds_read_b128 v[92:95], v14 offset:48128
  s_waitcnt lgkmcnt(8)
  v_mfma_f32_16x16x32_bf16 v[116:119], v[60:63], v[24:27], v[116:119]
  s_waitcnt lgkmcnt(7)
  v_mfma_f32_16x16x32_bf16 v[120:123], v[64:67], v[24:27], v[120:123]
  ds_read_b128 v[40:43], v14 offset:49152
  ds_read_b128 v[44:47], v14 offset:50176
  s_waitcnt vmcnt(5) lgkmcnt(8)
  v_mfma_f32_16x16x32_bf16 v[96:99], v[68:71], v[28:31], v[96:99]
  ds_read_b128 v[48:51], v14 offset:51200
  s_waitcnt lgkmcnt(8)
  v_mfma_f32_16x16x32_bf16 v[100:103], v[72:75], v[28:31], v[100:103]
  ds_read_b128 v[52:55], v14 offset:52224
  s_waitcnt lgkmcnt(8)
  v_mfma_f32_16x16x32_bf16 v[104:107], v[76:79], v[28:31], v[104:107]
  ds_read_b128 v[56:59], v14 offset:53248
  buffer_load_dwordx4 v[136:139], v5, s[16:19], s50 offen offset:1024
  s_waitcnt lgkmcnt(8)
  v_mfma_f32_16x16x32_bf16 v[108:111], v[80:83], v[28:31], v[108:111]
  ds_read_b128 v[60:63], v14 offset:54272
  buffer_load_dwordx4 v[140:143], v5, s[16:19], s51 offen offset:1024
  s_waitcnt lgkmcnt(8)
  v_mfma_f32_16x16x32_bf16 v[112:115], v[84:87], v[28:31], v[112:115]
  ds_read_b128 v[64:67], v14 offset:55296
  s_waitcnt lgkmcnt(8)
  v_mfma_f32_16x16x32_bf16 v[116:119], v[88:91], v[28:31], v[116:119]
  s_waitcnt lgkmcnt(7)
  v_mfma_f32_16x16x32_bf16 v[120:123], v[92:95], v[28:31], v[120:123]
  s_waitcnt vmcnt(6)
  s_barrier
  ds_read_b128 v[68:71], v14 offset:56320
  ds_read_b128 v[72:75], v14 offset:57344
  s_waitcnt vmcnt(5) lgkmcnt(8)
  v_mfma_f32_16x16x32_bf16 v[96:99], v[40:43], v[32:35], v[96:99]
  ds_read_b128 v[76:79], v14 offset:58368
  s_waitcnt lgkmcnt(8)
  v_mfma_f32_16x16x32_bf16 v[100:103], v[44:47], v[32:35], v[100:103]
  ds_read_b128 v[80:83], v14 offset:59392
  s_waitcnt lgkmcnt(8)
  v_mfma_f32_16x16x32_bf16 v[104:107], v[48:51], v[32:35], v[104:107]
  ds_read_b128 v[84:87], v14 offset:60416
  buffer_load_dwordx4 v[144:147], v5, s[16:19], s50 offen offset:2048
  s_waitcnt lgkmcnt(8)
  v_mfma_f32_16x16x32_bf16 v[108:111], v[52:55], v[32:35], v[108:111]
  ds_read_b128 v[88:91], v14 offset:61440
  buffer_load_dwordx4 v[148:151], v5, s[16:19], s51 offen offset:2048
  s_waitcnt lgkmcnt(8)
  v_mfma_f32_16x16x32_bf16 v[112:115], v[56:59], v[32:35], v[112:115]
  ds_read_b128 v[92:95], v14 offset:62464
  s_waitcnt lgkmcnt(8)
  v_mfma_f32_16x16x32_bf16 v[116:119], v[60:63], v[32:35], v[116:119]
  s_waitcnt lgkmcnt(7)
  v_mfma_f32_16x16x32_bf16 v[120:123], v[64:67], v[32:35], v[120:123]
  s_waitcnt vmcnt(6) lgkmcnt(6)
  v_mfma_f32_16x16x32_bf16 v[96:99], v[68:71], v[36:39], v[96:99]
  s_waitcnt lgkmcnt(5)
  v_mfma_f32_16x16x32_bf16 v[100:103], v[72:75], v[36:39], v[100:103]
  s_waitcnt lgkmcnt(4)
  v_mfma_f32_16x16x32_bf16 v[104:107], v[76:79], v[36:39], v[104:107]
  buffer_load_dwordx4 v[152:155], v5, s[16:19], s50 offen offset:3072
  s_waitcnt lgkmcnt(3)
  v_mfma_f32_16x16x32_bf16 v[108:111], v[80:83], v[36:39], v[108:111]
  buffer_load_dwordx4 v[156:159], v5, s[16:19], s51 offen offset:3072
  s_add_u32 s50, s50, 4096
  s_add_u32 s51, s51, 4096
  s_waitcnt lgkmcnt(2)
  v_mfma_f32_16x16x32_bf16 v[112:115], v[84:87], v[36:39], v[112:115]
  s_waitcnt lgkmcnt(1)
  v_mfma_f32_16x16x32_bf16 v[116:119], v[88:91], v[36:39], v[116:119]
  s_waitcnt lgkmcnt(0)
  v_mfma_f32_16x16x32_bf16 v[120:123], v[92:95], v[36:39], v[120:123]
  s_nop 5
  v_cvt_pk_bf16_f32 v78, v116, v117
  v_cvt_pk_bf16_f32 v79, v118, v119
  v_cvt_pk_bf16_f32 v80, v120, v121
  v_cvt_pk_bf16_f32 v81, v122, v123
  v_cvt_pk_bf16_f32 v82, v114, v115
  v_mov_b32 v83, 0x3f80
  ds_write_b64 v12, v[78:79] offset:160
  ds_write_b64 v12, v[80:81] offset:200
  s_mov_b64 exec, 0xffffffff
  ds_write_b64 v13, v[82:83] offset:192
  s_mov_b64 exec, -1
  v_max3_f32 v84, v96, v97, v98
  v_min3_f32 v85, v96, v97, v98
  v_max3_f32 v84, v84, v99, v100
  v_min3_f32 v85, v85, v99, v100
  buffer_load_dwordx4 v[160:163], v5, s[16:19], s50 offen offset:0
  v_max3_f32 v84, v84, v101, v102
  v_min3_f32 v85, v85, v101, v102
  v_max3_f32 v84, v84, v103, v104
  v_min3_f32 v85, v85, v103, v104
  buffer_load_dwordx4 v[164:167], v5, s[16:19], s51 offen offset:0
  v_max3_f32 v84, v84, v105, v106
  v_min3_f32 v85, v85, v105, v106
  v_max3_f32 v84, v84, v107, v108
  v_min3_f32 v85, v85, v107, v108
  v_max3_f32 v84, v84, v109, v110
  v_min3_f32 v85, v85, v109, v110
  buffer_load_dwordx4 v[168:171], v5, s[16:19], s50 offen offset:1024
  v_max3_f32 v84, v84, v111, v112
  v_min3_f32 v85, v85, v111, v112
  v_max_f32 v84, v84, v113
  v_min_f32 v85, v85, v113
  v_mul_f32 v86, s25, v84
  v_mul_f32 v87, s24, v85
  v_fma_f32 v40, v96, s24, v86
  v_fma_f32 v96, v96, s25, v87
  v_exp_f32 v40, v40
  v_exp_f32 v96, v96
  v_fma_f32 v41, v97, s24, v86
  v_fma_f32 v97, v97, s25, v87
  v_exp_f32 v41, v41
  v_exp_f32 v97, v97
  v_add_f32 v84, v40, v41
  v_add_f32 v85, v96, v97
  buffer_load_dwordx4 v[172:175], v5, s[16:19], s51 offen offset:1024
  v_fma_f32 v42, v98, s24, v86
  v_fma_f32 v98, v98, s25, v87
  v_exp_f32 v42, v42
  v_exp_f32 v98, v98
  v_add_f32 v84, v84, v42
  v_add_f32 v85, v85, v98
  v_fma_f32 v43, v99, s24, v86
  v_fma_f32 v99, v99, s25, v87
  v_exp_f32 v43, v43
  v_exp_f32 v99, v99
  v_add_f32 v84, v84, v43
  v_add_f32 v85, v85, v99
  buffer_load_dwordx4 v[176:179], v5, s[16:19], s50 offen offset:2048
  v_fma_f32 v44, v100, s24, v86
  v_fma_f32 v100, v100, s25, v87
  v_exp_f32 v44, v44
  v_exp_f32 v100, v100
  v_add_f32 v84, v84, v44
  v_add_f32 v85, v85, v100
  v_fma_f32 v45, v101, s24, v86
  v_fma_f32 v101, v101, s25, v87
  v_exp_f32 v45, v45
  v_exp_f32 v101, v101
  v_add_f32 v84, v84, v45
  v_add_f32 v85, v85, v101
  v_fma_f32 v46, v102, s24, v86
  v_fma_f32 v102, v102, s25, v87
  v_exp_f32 v46, v46
  v_exp_f32 v102, v102
  v_add_f32 v84, v84, v46
  v_add_f32 v85, v85, v102
  buffer_load_dwordx4 v[180:183], v5, s[16:19], s51 offen offset:2048
  v_fma_f32 v47, v103, s24, v86
  v_fma_f32 v103, v103, s25, v87
  v_exp_f32 v47, v47
  v_exp_f32 v103, v103
  v_add_f32 v84, v84, v47
  v_add_f32 v85, v85, v103
  v_fma_f32 v48, v104, s24, v86
  v_fma_f32 v104, v104, s25, v87
  v_exp_f32 v48, v48
  v_exp_f32 v104, v104
  v_add_f32 v84, v84, v48
  v_add_f32 v85, v85, v104
  v_fma_f32 v49, v105, s24, v86
  v_fma_f32 v105, v105, s25, v87
  v_exp_f32 v49, v49
  v_exp_f32 v105, v105
  v_add_f32 v84, v84, v49
  v_add_f32 v85, v85, v105
  buffer_load_dwordx4 v[184:187], v5, s[16:19], s50 offen offset:3072
  v_fma_f32 v50, v106, s24, v86
  v_fma_f32 v106, v106, s25, v87
  v_exp_f32 v50, v50
  v_exp_f32 v106, v106
  v_add_f32 v84, v84, v50
  v_add_f32 v85, v85, v106
  v_fma_f32 v51, v107, s24, v86
  v_fma_f32 v107, v107, s25, v87
  v_exp_f32 v51, v51
  v_exp_f32 v107, v107
  v_add_f32 v84, v84, v51
  v_add_f32 v85, v85, v107
  buffer_load_dwordx4 v[188:191], v5, s[16:19], s51 offen offset:3072
  s_add_u32 s50, s50, 4096
  s_add_u32 s51, s51, 4096
  v_fma_f32 v52, v108, s24, v86
  v_fma_f32 v108, v108, s25, v87
  v_exp_f32 v52, v52
  v_exp_f32 v108, v108
  v_add_f32 v84, v84, v52
  v_add_f32 v85, v85, v108
  v_fma_f32 v53, v109, s24, v86
  v_fma_f32 v109, v109, s25, v87
  v_exp_f32 v53, v53
  v_exp_f32 v109, v109
  v_add_f32 v84, v84, v53
  v_add_f32 v85, v85, v109
  v_fma_f32 v54, v110, s24, v86
  v_fma_f32 v110, v110, s25, v87
  v_exp_f32 v54, v54
  v_exp_f32 v110, v110
  v_add_f32 v84, v84, v54
  v_add_f32 v85, v85, v110
  buffer_load_dwordx4 v[192:195], v5, s[16:19], s50 offen offset:0
  v_fma_f32 v55, v111, s24, v86
  v_fma_f32 v111, v111, s25, v87
  v_exp_f32 v55, v55
  v_exp_f32 v111, v111
  v_add_f32 v84, v84, v55
  v_add_f32 v85, v85, v111
  v_fma_f32 v56, v112, s24, v86
  v_fma_f32 v112, v112, s25, v87
  v_exp_f32 v56, v56
  v_exp_f32 v112, v112
  v_add_f32 v84, v84, v56
  v_add_f32 v85, v85, v112
  v_fma_f32 v57, v113, s24, v86
  v_fma_f32 v113, v113, s25, v87
  v_exp_f32 v57, v57
  v_exp_f32 v113, v113
  v_add_f32 v84, v84, v57
  v_add_f32 v85, v85, v113
  buffer_load_dwordx4 v[196:199], v5, s[16:19], s51 offen offset:0
  v_rcp_f32 v84, v84
  v_rcp_f32 v85, v85
  v_mul_f32 v40, v40, v84
  v_mul_f32 v41, v41, v84
  v_cvt_pk_bf16_f32 v60, v40, v41
  v_mul_f32 v42, v42, v84
  v_mul_f32 v43, v43, v84
  v_cvt_pk_bf16_f32 v61, v42, v43
  buffer_load_dwordx4 v[200:203], v5, s[16:19], s50 offen offset:1024
  v_mul_f32 v44, v44, v84
  v_mul_f32 v45, v45, v84
  v_cvt_pk_bf16_f32 v62, v44, v45
  v_mul_f32 v46, v46, v84
  v_mul_f32 v47, v47, v84
  v_cvt_pk_bf16_f32 v63, v46, v47
  v_mul_f32 v48, v48, v84
  v_mul_f32 v49, v49, v84
  v_cvt_pk_bf16_f32 v64, v48, v49
  buffer_load_dwordx4 v[204:207], v5, s[16:19], s51 offen offset:1024
  v_mul_f32 v50, v50, v84
  v_mul_f32 v51, v51, v84
  v_cvt_pk_bf16_f32 v65, v50, v51
  v_mul_f32 v52, v52, v84
  v_mul_f32 v53, v53, v84
  v_cvt_pk_bf16_f32 v66, v52, v53
  v_mul_f32 v54, v54, v84
  v_mul_f32 v55, v55, v84
  v_cvt_pk_bf16_f32 v67, v54, v55
  buffer_load_dwordx4 v[208:211], v5, s[16:19], s50 offen offset:2048
  v_mul_f32 v56, v56, v84
  v_mul_f32 v57, v57, v84
  v_cvt_pk_bf16_f32 v68, v56, v57
  v_mul_f32 v96, v96, v85
  v_mul_f32 v97, v97, v85
  v_cvt_pk_bf16_f32 v69, v96, v97
  buffer_load_dwordx4 v[212:215], v5, s[16:19], s51 offen offset:2048
  v_mul_f32 v98, v98, v85
  v_mul_f32 v99, v99, v85
  v_cvt_pk_bf16_f32 v70, v98, v99
  v_mul_f32 v100, v100, v85
  v_mul_f32 v101, v101, v85
  v_cvt_pk_bf16_f32 v71, v100, v101
  v_mul_f32 v102, v102, v85
  v_mul_f32 v103, v103, v85
  v_cvt_pk_bf16_f32 v72, v102, v103
  buffer_load_dwordx4 v[216:219], v5, s[16:19], s50 offen offset:3072
  v_mul_f32 v104, v104, v85
  v_mul_f32 v105, v105, v85
  v_cvt_pk_bf16_f32 v73, v104, v105
  v_mul_f32 v106, v106, v85
  v_mul_f32 v107, v107, v85
  v_cvt_pk_bf16_f32 v74, v106, v107
  v_mul_f32 v108, v108, v85
  v_mul_f32 v109, v109, v85
  v_cvt_pk_bf16_f32 v75, v108, v109
  buffer_load_dwordx4 v[220:223], v5, s[16:19], s51 offen offset:3072
  s_add_u32 s50, s50, 4096
  s_add_u32 s51, s51, 4096
  v_mul_f32 v110, v110, v85
  v_mul_f32 v111, v111, v85
  v_cvt_pk_bf16_f32 v76, v110, v111
  v_mul_f32 v112, v112, v85
  v_mul_f32 v113, v113, v85
  v_cvt_pk_bf16_f32 v77, v112, v113
  s_mov_b32 exec_lo, 0
  ds_write_b128 v11, v[60:63] offset:0
  ds_write_b128 v11, v[64:67] offset:16
  ds_write_b128 v11, v[68:71] offset:32
  ds_write_b128 v11, v[72:75] offset:48
  ds_write_b64 v11, v[76:77] offset:64
  s_mov_b32 exec_lo, -1
  s_mov_b32 exec_hi, 0
  s_waitcnt lgkmcnt(0)
  s_barrier
  ds_write_b128 v8, v[60:63] offset:0
  ds_write_b128 v8, v[64:67] offset:256
  ds_write_b128 v8, v[68:71] offset:512
  ds_write_b128 v8, v[72:75] offset:768
  ds_write_b64 v9, v[76:77] offset:2048
  s_mov_b64 exec, -1
  s_cmp_ge_u32 s3, 6
  s_cbranch_scc1 af_nokv
  ds_read_b64_tr_b16 v[16:17], v124 offset:0
  ds_read_b64_tr_b16 v[40:41], v125 offset:0
  ds_read_b64_tr_b16 v[56:57], v126 offset:32
  ds_read_b64_tr_b16 v[18:19], v124 offset:960
  ds_read_b64_tr_b16 v[42:43], v125 offset:960
  ds_read_b64_tr_b16 v[58:59], v126 offset:992
  ds_read_b64_tr_b16 v[20:21], v124 offset:7680
  ds_read_b64_tr_b16 v[44:45], v125 offset:7680
  ds_read_b64_tr_b16 v[60:61], v126 offset:7712
  ds_read_b64_tr_b16 v[22:23], v124 offset:8640
  ds_read_b64_tr_b16 v[46:47], v125 offset:8640
  ds_read_b64_tr_b16 v[62:63], v126 offset:8672
  ds_read_b64_tr_b16 v[24:25], v124 offset:15360
  ds_read_b64_tr_b16 v[48:49], v125 offset:15360
  ds_read_b64_tr_b16 v[64:65], v126 offset:15392
  ds_read_b64_tr_b16 v[26:27], v124 offset:16320
  ds_read_b64_tr_b16 v[50:51], v125 offset:16320
  ds_read_b64_tr_b16 v[66:67], v126 offset:16352
  ds_read_b64_tr_b16 v[28:29], v124 offset:23040
  ds_read_b64_tr_b16 v[52:53], v125 offset:23040
  ds_read_b64_tr_b16 v[68:69], v126 offset:23072
  ds_read_b64_tr_b16 v[30:31], v124 offset:24000
  ds_read_b64_tr_b16 v[54:55], v125 offset:24000
  ds_read_b64_tr_b16 v[70:71], v126 offset:24032
  s_waitcnt lgkmcnt(15)
  v_mfma_f32_16x16x32_bf16 v[32:35], v[16:19], v[40:43], 0
  s_waitcnt lgkmcnt(15)
  v_mfma_f32_16x16x32_bf16 v[36:39], v[16:19], v[56:59], 0
  s_waitcnt lgkmcnt(13)
  v_mfma_f32_16x16x32_bf16 v[32:35], v[20:23], v[44:47], v[32:35]
  s_waitcnt lgkmcnt(12)
  v_mfma_f32_16x16x32_bf16 v[36:39], v[20:23], v[60:63], v[36:39]
  s_waitcnt lgkmcnt(7)
  v_mfma_f32_16x16x32_bf16 v[32:35], v[24:27], v[48:51], v[32:35]
  s_waitcnt lgkmcnt(6)
  v_mfma_f32_16x16x32_bf16 v[36:39], v[24:27], v[64:67], v[36:39]
  s_waitcnt lgkmcnt(1)
  v_mfma_f32_16x16x32_bf16 v[32:35], v[28:31], v[52:55], v[32:35]
  s_waitcnt lgkmcnt(0)
  v_mfma_f32_16x16x32_bf16 v[36:39], v[28:31], v[68:71], v[36:39]
  s_nop 5
  v_cndmask_b32_e64 v32, 0, v32, s[34:35]
  v_cndmask_b32_e64 v33, 0, v33, s[34:35]
  v_cndmask_b32_e64 v34, 0, v34, s[34:35]
  v_cndmask_b32_e64 v35, 0, v35, s[34:35]
  v_cvt_pk_bf16_f32 v32, v32, v33
  v_cvt_pk_bf16_f32 v33, v34, v35
  buffer_store_dwordx2 v[32:33], v2, s[16:19], s31 offen sc1
  v_cndmask_b32_e64 v36, 0, v36, s[34:35]
  v_cndmask_b32_e64 v37, 0, v37, s[34:35]
  v_cndmask_b32_e64 v38, 0, v38, s[34:35]
  v_cndmask_b32_e64 v39, 0, v39, s[34:35]
  v_cvt_pk_bf16_f32 v36, v36, v37
  v_cvt_pk_bf16_f32 v37, v38, v39
  buffer_store_dwordx2 v[36:37], v7, s[16:19], s31 offen sc1
af_nokv:
  s_waitcnt lgkmcnt(0)
  v_lshlrev_b32 v7, 3, v0
  v_cmp_gt_u32 vcc, 400, v0
  s_nop 1
  v_cndmask_b32 v7, v6, v7, vcc
  buffer_load_dwordx4 v[224:227], v5, s[16:19], s50 offen offset:0
  buffer_load_dwordx4 v[228:231], v5, s[16:19], s51 offen offset:0
  buffer_load_dwordx4 v[232:235], v5, s[16:19], s50 offen offset:1024
  buffer_load_dwordx4 v[236:239], v5, s[16:19], s51 offen offset:1024
  buffer_load_dwordx4 v[240:243], v5, s[16:19], s50 offen offset:2048
  buffer_load_dwordx4 v[244:247], v5, s[16:19], s51 offen offset:2048
  buffer_load_dwordx4 v[248:251], v5, s[16:19], s50 offen offset:3072
  buffer_load_dwordx4 v[252:255], v5, s[16:19], s51 offen offset:3072
  s_add_u32 s50, s50, 4096
  s_add_u32 s51, s51, 4096
  buffer_load_dwordx4 v[88:91], v5, s[16:19], s50 offen offset:0
  buffer_load_dwordx4 v[92:95], v5, s[16:19], s51 offen offset:0
  buffer_load_dwordx4 v[104:107], v5, s[16:19], s50 offen offset:1024
  buffer_load_dwordx4 v[108:111], v5, s[16:19], s51 offen offset:1024
  s_barrier
  s_sleep 6
  buffer_load_dwordx2 v[32:33], v7, s[16:19], s60 offen sc1
  buffer_load_dwordx2 v[36:37], v7, s[16:19], s61 offen sc1
  buffer_load_dwordx2 v[40:41], v7, s[16:19], s62 offen sc1
  buffer_load_dwordx2 v[44:45], v7, s[16:19], s63 offen sc1
  buffer_load_dwordx2 v[48:49], v7, s[16:19], s64 offen sc1
  buffer_load_dwordx2 v[52:53], v7, s[16:19], s65 offen sc1
  buffer_load_dwordx2 v[56:57], v7, s[16:19], s66 offen sc1
  buffer_load_dwordx2 v[60:61], v7, s[16:19], s67 offen sc1
  buffer_load_dwordx2 v[64:65], v7, s[16:19], s68 offen sc1
  buffer_load_dwordx2 v[68:69], v7, s[16:19], s69 offen sc1
  buffer_load_dwordx2 v[72:73], v7, s[16:19], s70 offen sc1
  buffer_load_dwordx2 v[76:77], v7, s[16:19], s71 offen sc1
  buffer_load_dwordx2 v[80:81], v7, s[16:19], s72 offen sc1
  buffer_load_dwordx2 v[84:85], v7, s[16:19], s73 offen sc1
  buffer_load_dwordx2 v[96:97], v7, s[16:19], s74 offen sc1
  buffer_load_dwordx2 v[100:101], v7, s[16:19], s75 offen sc1
  v_add_u32 v10, s20, v5
  v_lshlrev_b32 v11, 4, v3
  v_add_u32 v11, s20, v11
  ds_read_b128 v[16:19], v10
  ds_read_b128 v[20:23], v10 offset:1024
  ds_read_b128 v[24:27], v11 offset:2048
  v_cmp_eq_u32 vcc, 0, v4
  s_nop 1
  v_cndmask_b32 v8, v6, v5, vcc
  v_lshrrev_b32 v8, 1, v8
  v_mov_b32 v9, 1472
  v_add_u32 v10, 1024, v5
  v_cndmask_b32 v10, v9, v10, vcc
  v_and_b32 v11, 3, v3
  v_lshl_add_u32 v12, v11, 2, v4
  v_lshlrev_b32 v12, 4, v12
  v_lshlrev_b32 v11, 4, v11
  v_add_u32 v11, 1536, v11
  v_cndmask_b32 v11, v9, v11, vcc
  v_subrev_u32 v28, 200, v0
  v_cmp_gt_u32 vcc, 200, v0
  s_nop 1
  v_cndmask_b32 v28, v28, v0, vcc
  v_sub_u32 v13, v0, v28
  v_and_b32 v29, 63, v28
  v_lshrrev_b32 v30, 6, v28
  v_lshl_add_u32 v29, v29, 1, v30
  v_and_b32 v30, 15, v28
  v_bfe_u32 v31, v28, 4, 1
  v_lshl_add_u32 v30, v30, 1, v31
  v_add_u32 v30, 160, v30
  v_cmp_gt_u32 vcc, 128, v28
  s_nop 1
  v_cndmask_b32 v29, v28, v29, vcc
  v_subrev_u32 v31, 160, v28
  v_cmp_gt_u32 vcc, 32, v31
  s_nop 1
  v_cndmask_b32 v29, v29, v30, vcc
  v_add_lshl_u32 v13, v13, v29, 3
  s_mov_b32 s33, 4000
  s_mov_b32 s54, 0x3f80
  s_mov_b32 s55, 0x3f800000
  s_waitcnt vmcnt(15)
  v_dot2_f32_bf16 v28, v32, s54, 0
  v_dot2_f32_bf16 v29, v32, s55, 0
  v_dot2_f32_bf16 v30, v33, s54, 0
  v_dot2_f32_bf16 v31, v33, s55, 0
  s_waitcnt vmcnt(14)
  v_dot2_f32_bf16 v28, v36, s54, v28
  v_dot2_f32_bf16 v29, v36, s55, v29
  v_dot2_f32_bf16 v30, v37, s54, v30
  v_dot2_f32_bf16 v31, v37, s55, v31
  s_waitcnt vmcnt(13)
  v_dot2_f32_bf16 v28, v40, s54, v28
  v_dot2_f32_bf16 v29, v40, s55, v29
  v_dot2_f32_bf16 v30, v41, s54, v30
  v_dot2_f32_bf16 v31, v41, s55, v31
  s_waitcnt vmcnt(12)
  v_dot2_f32_bf16 v28, v44, s54, v28
  v_dot2_f32_bf16 v29, v44, s55, v29
  v_dot2_f32_bf16 v30, v45, s54, v30
  v_dot2_f32_bf16 v31, v45, s55, v31
  s_waitcnt vmcnt(11)
  v_dot2_f32_bf16 v28, v48, s54, v28
  v_dot2_f32_bf16 v29, v48, s55, v29
  v_dot2_f32_bf16 v30, v49, s54, v30
  v_dot2_f32_bf16 v31, v49, s55, v31
  s_waitcnt vmcnt(10)
  v_dot2_f32_bf16 v28, v52, s54, v28
  v_dot2_f32_bf16 v29, v52, s55, v29
  v_dot2_f32_bf16 v30, v53, s54, v30
  v_dot2_f32_bf16 v31, v53, s55, v31
  s_waitcnt vmcnt(9)
  v_dot2_f32_bf16 v28, v56, s54, v28
  v_dot2_f32_bf16 v29, v56, s55, v29
  v_dot2_f32_bf16 v30, v57, s54, v30
  v_dot2_f32_bf16 v31, v57, s55, v31
  s_waitcnt vmcnt(8)
  v_dot2_f32_bf16 v28, v60, s54, v28
  v_dot2_f32_bf16 v29, v60, s55, v29
  v_dot2_f32_bf16 v30, v61, s54, v30
  v_dot2_f32_bf16 v31, v61, s55, v31
  s_waitcnt vmcnt(7)
  v_dot2_f32_bf16 v28, v64, s54, v28
  v_dot2_f32_bf16 v29, v64, s55, v29
  v_dot2_f32_bf16 v30, v65, s54, v30
  v_dot2_f32_bf16 v31, v65, s55, v31
  s_waitcnt vmcnt(6)
  v_dot2_f32_bf16 v28, v68, s54, v28
  v_dot2_f32_bf16 v29, v68, s55, v29
  v_dot2_f32_bf16 v30, v69, s54, v30
  v_dot2_f32_bf16 v31, v69, s55, v31
  s_waitcnt vmcnt(5)
  v_dot2_f32_bf16 v28, v72, s54, v28
  v_dot2_f32_bf16 v29, v72, s55, v29
  v_dot2_f32_bf16 v30, v73, s54, v30
  v_dot2_f32_bf16 v31, v73, s55, v31
  s_waitcnt vmcnt(4)
  v_dot2_f32_bf16 v28, v76, s54, v28
  v_dot2_f32_bf16 v29, v76, s55, v29
  v_dot2_f32_bf16 v30, v77, s54, v30
  v_dot2_f32_bf16 v31, v77, s55, v31
  s_waitcnt vmcnt(3)
  v_dot2_f32_bf16 v28, v80, s54, v28
  v_dot2_f32_bf16 v29, v80, s55, v29
  v_dot2_f32_bf16 v30, v81, s54, v30
  v_dot2_f32_bf16 v31, v81, s55, v31
  s_waitcnt vmcnt(2)
  v_dot2_f32_bf16 v28, v84, s54, v28
  v_dot2_f32_bf16 v29, v84, s55, v29
  v_dot2_f32_bf16 v30, v85, s54, v30
  v_dot2_f32_bf16 v31, v85, s55, v31
  s_waitcnt vmcnt(1)
  v_dot2_f32_bf16 v28, v96, s54, v28
  v_dot2_f32_bf16 v29, v96, s55, v29
  v_dot2_f32_bf16 v30, v97, s54, v30
  v_dot2_f32_bf16 v31, v97, s55, v31
  s_waitcnt vmcnt(0)
  v_dot2_f32_bf16 v28, v100, s54, v28
  v_dot2_f32_bf16 v29, v100, s55, v29
  v_dot2_f32_bf16 v30, v101, s54, v30
  v_dot2_f32_bf16 v31, v101, s55, v31
  s_nop 2
  v_cmp_u_f32 vcc, v28, v30
  s_nop 1
  s_cmp_lg_u64 vcc, 0
  s_cbranch_scc1 af_kvslow
af_kvgo:
  v_cvt_pk_bf16_f32 v28, v28, v29
  v_cvt_pk_bf16_f32 v29, v30, v31
  ds_write_b64 v13, v[28:29] offset:20480
  s_waitcnt lgkmcnt(0)
  s_barrier
  ds_read_b128 v[40:43], v5 offset:20480
  ds_read_b128 v[44:47], v12 offset:21760
  ds_read_b128 v[48:51], v10 offset:20480
  ds_read_b128 v[52:55], v11 offset:20480
  ds_read_b128 v[56:59], v5 offset:22080
  ds_read_b128 v[60:63], v12 offset:23360
  ds_read_b128 v[64:67], v10 offset:22080
  ds_read_b128 v[68:71], v11 offset:22080
  s_waitcnt lgkmcnt(7)
  v_mfma_f32_16x16x32_bf16 v[72:75], v[40:43], v[16:19], 0
  s_waitcnt lgkmcnt(6)
  v_mfma_f32_16x16x32_bf16 v[76:79], v[44:47], v[16:19], 0
  s_waitcnt lgkmcnt(3)
  v_mfma_f32_16x16x32_bf16 v[80:83], v[56:59], v[20:23], 0
  s_waitcnt lgkmcnt(2)
  v_mfma_f32_16x16x32_bf16 v[84:87], v[60:63], v[20:23], 0
  v_mfma_f32_16x16x32_bf16 v[76:79], v[52:55], v[24:27], v[76:79]
  v_mfma_f32_16x16x32_bf16 v[72:75], v[48:51], v[24:27], v[72:75]
  s_waitcnt lgkmcnt(0)
  v_mfma_f32_16x16x32_bf16 v[84:87], v[68:71], v[24:27], v[84:87]
  v_mfma_f32_16x16x32_bf16 v[80:83], v[64:67], v[24:27], v[80:83]
  s_nop 3
  v_cvt_pk_bf16_f32 v78, v78, v78
  v_lshlrev_b32 v78, 16, v78
  v_add_f32 v78, 0x358637bd, v78
  v_cvt_pk_bf16_f32 v78, v78, v78
  v_lshlrev_b32 v78, 16, v78
  v_rcp_f32 v78, v78
  v_cvt_pk_bf16_f32 v86, v86, v86
  v_lshlrev_b32 v86, 16, v86
  v_add_f32 v86, 0x358637bd, v86
  v_cvt_pk_bf16_f32 v86, v86, v86
  v_lshlrev_b32 v86, 16, v86
  v_rcp_f32 v86, v86
  v_mul_f32 v72, v72, v78
  v_mul_f32 v73, v73, v78
  v_mul_f32 v74, v74, v78
  v_mul_f32 v75, v75, v78
  v_mul_f32 v76, v76, v78
  v_mul_f32 v77, v77, v78
  v_cvt_pk_bf16_f32 v96, v72, v73
  v_cvt_pk_bf16_f32 v97, v74, v75
  v_cvt_pk_bf16_f32 v100, v76, v77
  v_mul_f32 v80, v80, v86
  v_mul_f32 v81, v81, v86
  v_mul_f32 v82, v82, v86
  v_mul_f32 v83, v83, v86
  v_mul_f32 v84, v84, v86
  v_mul_f32 v85, v85, v86
  v_cvt_pk_bf16_f32 v98, v80, v81
  v_cvt_pk_bf16_f32 v99, v82, v83
  v_cvt_pk_bf16_f32 v101, v84, v85
  buffer_store_dwordx4 v[96:99], v5, s[16:19], s23 offen sc1
  buffer_store_dwordx2 v[100:101], v8, s[16:19], s22 offen sc1
  s_add_u32 s61, s52, 8192
  s_add_u32 s62, s52, 16384
  s_add_u32 s63, s52, 24576
  s_add_u32 s64, s52, 32768
  s_mov_b32 s60, s52
  s_cmp_lt_u32 s3, 4
  s_cselect_b32 s64, s64, 1073741824
  s_sleep 14
  buffer_load_dwordx4 v[56:59], v5, s[16:19], s60 offen sc1
  buffer_load_dwordx4 v[60:63], v5, s[16:19], s61 offen sc1
  buffer_load_dwordx4 v[64:67], v5, s[16:19], s62 offen sc1
  buffer_load_dwordx4 v[68:71], v5, s[16:19], s63 offen sc1
  buffer_load_dwordx4 v[72:75], v5, s[16:19], s64 offen sc1
  v_add_u32 v10, s9, v5
  v_and_b32 v12, 0x70, v5
  v_lshlrev_b32 v12, 1, v12
  v_lshl_add_u32 v12, v4, 8, v12
  v_bfe_u32 v13, v5, 7, 1
  v_lshl_add_u32 v12, v13, 3, v12
  v_add_u32 v12, s9, v12
  v_add_u32 v13, 16, v12
  v_add_u32 v8, 8, v10
  s_cmp_lt_u32 s3, 2
  s_cselect_b64 vcc, -1, 0
  v_cndmask_b32 v7, v12, v10, vcc
  v_cndmask_b32 v12, v10, v12, vcc
  v_cndmask_b32 v2, v13, v8, vcc
  v_cndmask_b32 v13, v8, v13, vcc
  v_mul_u32_u24 v14, 288, v3
  v_lshl_add_u32 v14, v4, 3, v14
  s_lshl_b32 s30, s15, 5
  s_add_u32 s30, s30, 61440
  v_add_u32 v14, s30, v14
  v_lshlrev_b32 v11, 2, v3
  v_add_u32 v9, 71680, v11
  s_mul_i32 s32, s37, 36
  s_lshr_b32 s14, s39, 1
  s_add_u32 s32, s32, s14
  s_lshl_b32 s32, s32, 10
  s_add_u32 s28, s32, 17825792
  s_add_u32 s32, s32, 15204352
  s_add_u32 s34, s32, 18432
  s_add_u32 s35, s28, 18432
  s_mov_b32 s31, 0xffff0000
  s_mov_b32 s33, 4000
  s_waitcnt vmcnt(4)
  v_cmp_u_f32_e64 s[66:67], v56, v57
  v_cmp_u_f32 vcc, v58, v59
  s_nop 1
  s_or_b64 s[66:67], s[66:67], vcc
  s_waitcnt vmcnt(3)
  v_cmp_u_f32_e64 s[68:69], v60, v61
  v_cmp_u_f32 vcc, v62, v63
  s_nop 1
  s_or_b64 s[68:69], s[68:69], vcc
  s_waitcnt vmcnt(2)
  v_cmp_u_f32_e64 s[70:71], v64, v65
  v_cmp_u_f32 vcc, v66, v67
  s_nop 1
  s_or_b64 s[70:71], s[70:71], vcc
  s_waitcnt vmcnt(1)
  v_cmp_u_f32_e64 s[72:73], v68, v69
  v_cmp_u_f32 vcc, v70, v71
  s_nop 1
  s_or_b64 s[72:73], s[72:73], vcc
  s_waitcnt vmcnt(0)
  v_cmp_u_f32_e64 s[74:75], v72, v73
  v_cmp_u_f32 vcc, v74, v75
  s_nop 1
  s_or_b64 s[74:75], s[74:75], vcc
  s_or_b64 vcc, s[66:67], s[68:69]
  s_or_b64 s[54:55], s[70:71], s[72:73]
  s_or_b64 vcc, vcc, s[74:75]
  s_or_b64 vcc, vcc, s[54:55]
  s_cbranch_scc1 af_ofslow
af_ofgo:
  ds_write_b128 v10, v[56:59] offset:24576
  ds_write_b128 v10, v[60:63] offset:32768
  ds_write_b64 v12, v[64:65] offset:40960
  ds_write_b64 v13, v[66:67] offset:40960
  ds_write_b128 v10, v[68:71] offset:49152
  s_cmp_ge_u32 s3, 4
  s_cbranch_scc1 af_no5
  ds_write_b64 v7, v[72:73] offset:57344
  ds_write_b64 v2, v[74:75] offset:57344
af_no5:
  s_waitcnt vmcnt(0) lgkmcnt(0)
  s_barrier
  s_cmp_ge_u32 s3, 5
  s_cbranch_scc1 af_lt
  ds_read_b128 v[16:19], v5 offset:24576
  ds_read_b128 v[20:23], v5 offset:43008
  ds_read_b128 v[24:27], v5 offset:25600
  ds_read_b128 v[28:31], v5 offset:44032
  ds_read_b128 v[32:35], v5 offset:26624
  ds_read_b128 v[36:39], v5 offset:45056
  s_waitcnt lgkmcnt(5)
  v_mfma_f32_16x16x32_bf16 v[44:47], v[132:135], v[16:19], 0
  s_waitcnt lgkmcnt(4)
  v_mfma_f32_16x16x32_bf16 v[52:55], v[132:135], v[20:23], 0
  v_mfma_f32_16x16x32_bf16 v[40:43], v[128:131], v[16:19], 0
  v_mfma_f32_16x16x32_bf16 v[48:51], v[128:131], v[20:23], 0
  ds_read_b128 v[16:19], v5 offset:27648
  ds_read_b128 v[20:23], v5 offset:46080
  s_waitcnt lgkmcnt(5)
  v_mfma_f32_16x16x32_bf16 v[44:47], v[140:143], v[24:27], v[44:47]
  s_waitcnt lgkmcnt(4)
  v_mfma_f32_16x16x32_bf16 v[52:55], v[140:143], v[28:31], v[52:55]
  v_mfma_f32_16x16x32_bf16 v[40:43], v[136:139], v[24:27], v[40:43]
  v_mfma_f32_16x16x32_bf16 v[48:51], v[136:139], v[28:31], v[48:51]
  ds_read_b128 v[24:27], v5 offset:28672
  ds_read_b128 v[28:31], v5 offset:47104
  s_waitcnt lgkmcnt(5)
  v_mfma_f32_16x16x32_bf16 v[44:47], v[148:151], v[32:35], v[44:47]
  s_waitcnt lgkmcnt(4)
  v_mfma_f32_16x16x32_bf16 v[52:55], v[148:151], v[36:39], v[52:55]
  v_mfma_f32_16x16x32_bf16 v[40:43], v[144:147], v[32:35], v[40:43]
  v_mfma_f32_16x16x32_bf16 v[48:51], v[144:147], v[36:39], v[48:51]
  ds_read_b128 v[32:35], v5 offset:29696
  ds_read_b128 v[36:39], v5 offset:48128
  s_waitcnt lgkmcnt(5)
  v_mfma_f32_16x16x32_bf16 v[44:47], v[156:159], v[16:19], v[44:47]
  s_waitcnt lgkmcnt(4)
  v_mfma_f32_16x16x32_bf16 v[52:55], v[156:159], v[20:23], v[52:55]
  v_mfma_f32_16x16x32_bf16 v[40:43], v[152:155], v[16:19], v[40:43]
  v_mfma_f32_16x16x32_bf16 v[48:51], v[152:155], v[20:23], v[48:51]
  ds_read_b128 v[16:19], v5 offset:30720
  ds_read_b128 v[20:23], v5 offset:49152
  s_waitcnt lgkmcnt(5)
  v_mfma_f32_16x16x32_bf16 v[44:47], v[164:167], v[24:27], v[44:47]
  s_waitcnt lgkmcnt(4)
  v_mfma_f32_16x16x32_bf16 v[52:55], v[164:167], v[28:31], v[52:55]
  v_mfma_f32_16x16x32_bf16 v[40:43], v[160:163], v[24:27], v[40:43]
  v_mfma_f32_16x16x32_bf16 v[48:51], v[160:163], v[28:31], v[48:51]
  ds_read_b128 v[24:27], v5 offset:31744
  ds_read_b128 v[28:31], v5 offset:50176
  s_waitcnt lgkmcnt(5)
  v_mfma_f32_16x16x32_bf16 v[44:47], v[172:175], v[32:35], v[44:47]
  s_waitcnt lgkmcnt(4)
  v_mfma_f32_16x16x32_bf16 v[52:55], v[172:175], v[36:39], v[52:55]
  v_mfma_f32_16x16x32_bf16 v[40:43], v[168:171], v[32:35], v[40:43]
  v_mfma_f32_16x16x32_bf16 v[48:51], v[168:171], v[36:39], v[48:51]
  ds_read_b128 v[32:35], v5 offset:32768
  ds_read_b128 v[36:39], v5 offset:51200
  s_waitcnt lgkmcnt(5)
  v_mfma_f32_16x16x32_bf16 v[44:47], v[180:183], v[16:19], v[44:47]
  s_waitcnt lgkmcnt(4)
  v_mfma_f32_16x16x32_bf16 v[52:55], v[180:183], v[20:23], v[52:55]
  v_mfma_f32_16x16x32_bf16 v[40:43], v[176:179], v[16:19], v[40:43]
  v_mfma_f32_16x16x32_bf16 v[48:51], v[176:179], v[20:23], v[48:51]
  ds_read_b128 v[16:19], v5 offset:33792
  ds_read_b128 v[20:23], v5 offset:52224
  s_waitcnt lgkmcnt(5)
  v_mfma_f32_16x16x32_bf16 v[44:47], v[188:191], v[24:27], v[44:47]
  s_waitcnt lgkmcnt(4)
  v_mfma_f32_16x16x32_bf16 v[52:55], v[188:191], v[28:31], v[52:55]
  v_mfma_f32_16x16x32_bf16 v[40:43], v[184:187], v[24:27], v[40:43]
  v_mfma_f32_16x16x32_bf16 v[48:51], v[184:187], v[28:31], v[48:51]
  ds_read_b128 v[24:27], v5 offset:34816
  ds_read_b128 v[28:31], v5 offset:53248
  s_waitcnt lgkmcnt(5)
  v_mfma_f32_16x16x32_bf16 v[44:47], v[196:199], v[32:35], v[44:47]
  s_waitcnt lgkmcnt(4)
  v_mfma_f32_16x16x32_bf16 v[52:55], v[196:199], v[36:39], v[52:55]
  v_mfma_f32_16x16x32_bf16 v[40:43], v[192:195], v[32:35], v[40:43]
  v_mfma_f32_16x16x32_bf16 v[48:51], v[192:195], v[36:39], v[48:51]
  ds_read_b128 v[32:35], v5 offset:35840
  ds_read_b128 v[36:39], v5 offset:54272
  s_waitcnt lgkmcnt(5)
  v_mfma_f32_16x16x32_bf16 v[44:47], v[204:207], v[16:19], v[44:47]
  s_waitcnt lgkmcnt(4)
  v_mfma_f32_16x16x32_bf16 v[52:55], v[204:207], v[20:23], v[52:55]
  v_mfma_f32_16x16x32_bf16 v[40:43], v[200:203], v[16:19], v[40:43]
  v_mfma_f32_16x16x32_bf16 v[48:51], v[200:203], v[20:23], v[48:51]
  ds_read_b128 v[16:19], v5 offset:36864
  ds_read_b128 v[20:23], v5 offset:55296
  s_waitcnt lgkmcnt(5)
  v_mfma_f32_16x16x32_bf16 v[44:47], v[212:215], v[24:27], v[44:47]
  s_waitcnt lgkmcnt(4)
  v_mfma_f32_16x16x32_bf16 v[52:55], v[212:215], v[28:31], v[52:55]
  v_mfma_f32_16x16x32_bf16 v[40:43], v[208:211], v[24:27], v[40:43]
  v_mfma_f32_16x16x32_bf16 v[48:51], v[208:211], v[28:31], v[48:51]
  ds_read_b128 v[24:27], v5 offset:37888
  ds_read_b128 v[28:31], v5 offset:56320
  s_waitcnt lgkmcnt(5)
  v_mfma_f32_16x16x32_bf16 v[44:47], v[220:223], v[32:35], v[44:47]
  s_waitcnt lgkmcnt(4)
  v_mfma_f32_16x16x32_bf16 v[52:55], v[220:223], v[36:39], v[52:55]
  v_mfma_f32_16x16x32_bf16 v[40:43], v[216:219], v[32:35], v[40:43]
  v_mfma_f32_16x16x32_bf16 v[48:51], v[216:219], v[36:39], v[48:51]
  ds_read_b128 v[32:35], v5 offset:38912
  ds_read_b128 v[36:39], v5 offset:57344
  s_waitcnt lgkmcnt(5)
  v_mfma_f32_16x16x32_bf16 v[44:47], v[228:231], v[16:19], v[44:47]
  s_waitcnt lgkmcnt(4)
  v_mfma_f32_16x16x32_bf16 v[52:55], v[228:231], v[20:23], v[52:55]
  v_mfma_f32_16x16x32_bf16 v[40:43], v[224:227], v[16:19], v[40:43]
  v_mfma_f32_16x16x32_bf16 v[48:51], v[224:227], v[20:23], v[48:51]
  ds_read_b128 v[16:19], v5 offset:39936
  ds_read_b128 v[20:23], v5 offset:58368
  s_waitcnt lgkmcnt(5)
  v_mfma_f32_16x16x32_bf16 v[44:47], v[236:239], v[24:27], v[44:47]
  s_waitcnt lgkmcnt(4)
  v_mfma_f32_16x16x32_bf16 v[52:55], v[236:239], v[28:31], v[52:55]
  v_mfma_f32_16x16x32_bf16 v[40:43], v[232:235], v[24:27], v[40:43]
  v_mfma_f32_16x16x32_bf16 v[48:51], v[232:235], v[28:31], v[48:51]
  ds_read_b128 v[24:27], v5 offset:40960
  ds_read_b128 v[28:31], v5 offset:59392
  s_waitcnt lgkmcnt(5)
  v_mfma_f32_16x16x32_bf16 v[44:47], v[244:247], v[32:35], v[44:47]
  s_waitcnt lgkmcnt(4)
  v_mfma_f32_16x16x32_bf16 v[52:55], v[244:247], v[36:39], v[52:55]
  v_mfma_f32_16x16x32_bf16 v[40:43], v[240:243], v[32:35], v[40:43]
  v_mfma_f32_16x16x32_bf16 v[48:51], v[240:243], v[36:39], v[48:51]
  ds_read_b128 v[32:35], v5 offset:41984
  ds_read_b128 v[36:39], v5 offset:60416
  s_waitcnt lgkmcnt(5)
  v_mfma_f32_16x16x32_bf16 v[44:47], v[252:255], v[16:19], v[44:47]
  s_waitcnt lgkmcnt(4)
  v_mfma_f32_16x16x32_bf16 v[52:55], v[252:255], v[20:23], v[52:55]
  v_mfma_f32_16x16x32_bf16 v[40:43], v[248:251], v[16:19], v[40:43]
  v_mfma_f32_16x16x32_bf16 v[48:51], v[248:251], v[20:23], v[48:51]
  ds_read_b64 v[76:77], v14 offset:0
  ds_read_b64 v[78:79], v14 offset:32
  ds_read_b64 v[80:81], v14 offset:4608
  ds_read_b64 v[82:83], v14 offset:4640
  s_waitcnt lgkmcnt(7)
  v_mfma_f32_16x16x32_bf16 v[44:47], v[92:95], v[24:27], v[44:47]
  s_waitcnt lgkmcnt(6)
  v_mfma_f32_16x16x32_bf16 v[52:55], v[92:95], v[28:31], v[52:55]
  v_mfma_f32_16x16x32_bf16 v[40:43], v[88:91], v[24:27], v[40:43]
  v_mfma_f32_16x16x32_bf16 v[48:51], v[88:91], v[28:31], v[48:51]
  s_waitcnt lgkmcnt(5)
  v_mfma_f32_16x16x32_bf16 v[44:47], v[108:111], v[32:35], v[44:47]
  s_waitcnt lgkmcnt(4)
  v_mfma_f32_16x16x32_bf16 v[52:55], v[108:111], v[36:39], v[52:55]
  v_mfma_f32_16x16x32_bf16 v[40:43], v[104:107], v[32:35], v[40:43]
  v_mfma_f32_16x16x32_bf16 v[48:51], v[104:107], v[36:39], v[48:51]
  s_cmp_lt_u32 s3, 4
  s_cbranch_scc1 af_nomean
  s_nop 1
  v_add_f32 v44, v44, v45
  v_add_f32 v44, v44, v1
  v_cvt_pk_bf16_f32 v44, v44, v44
  v_lshlrev_b32 v44, 16, v44
  v_add_f32 v52, v52, v53
  v_add_f32 v52, v52, v15
  v_cvt_pk_bf16_f32 v52, v52, v52
  v_lshlrev_b32 v52, 16, v52
  s_mov_b64 exec, 0xffff
  ds_write_b32 v9, v44
  ds_write_b32 v9, v52 offset:64
  s_mov_b64 exec, -1
  s_waitcnt lgkmcnt(0)
af_nomean:
  s_nop 4
  v_cvt_pk_bf16_f32 v41, v40, v41
  v_lshlrev_b32 v40, 16, v41
  v_and_b32 v41, s31, v41
  s_waitcnt lgkmcnt(3)
  v_lshlrev_b32 v120, 16, v76
  v_and_b32 v121, s31, v76
  v_add_f32 v40, v40, v120
  v_add_f32 v41, v41, v121
  v_cvt_pk_bf16_f32 v96, v40, v41
  v_lshlrev_b32 v40, 16, v96
  v_and_b32 v41, s31, v96
  v_cvt_pk_bf16_f32 v43, v42, v43
  v_lshlrev_b32 v42, 16, v43
  v_and_b32 v43, s31, v43
  v_lshlrev_b32 v120, 16, v77
  v_and_b32 v121, s31, v77
  v_add_f32 v42, v42, v120
  v_add_f32 v43, v43, v121
  v_cvt_pk_bf16_f32 v97, v42, v43
  v_lshlrev_b32 v42, 16, v97
  v_and_b32 v43, s31, v97
  v_cvt_pk_bf16_f32 v45, v44, v45
  v_lshlrev_b32 v44, 16, v45
  v_and_b32 v45, s31, v45
  s_waitcnt lgkmcnt(2)
  v_lshlrev_b32 v120, 16, v78
  v_and_b32 v121, s31, v78
  v_add_f32 v44, v44, v120
  v_add_f32 v45, v45, v121
  v_cvt_pk_bf16_f32 v98, v44, v45
  v_lshlrev_b32 v44, 16, v98
  v_and_b32 v45, s31, v98
  v_cvt_pk_bf16_f32 v47, v46, v47
  v_lshlrev_b32 v46, 16, v47
  v_and_b32 v47, s31, v47
  v_lshlrev_b32 v120, 16, v79
  v_and_b32 v121, s31, v79
  v_add_f32 v46, v46, v120
  v_add_f32 v47, v47, v121
  v_cvt_pk_bf16_f32 v99, v46, v47
  v_lshlrev_b32 v46, 16, v99
  v_and_b32 v47, s31, v99
  v_cvt_pk_bf16_f32 v49, v48, v49
  v_lshlrev_b32 v48, 16, v49
  v_and_b32 v49, s31, v49
  s_waitcnt lgkmcnt(1)
  v_lshlrev_b32 v120, 16, v80
  v_and_b32 v121, s31, v80
  v_add_f32 v48, v48, v120
  v_add_f32 v49, v49, v121
  v_cvt_pk_bf16_f32 v100, v48, v49
  v_lshlrev_b32 v48, 16, v100
  v_and_b32 v49, s31, v100
  v_cvt_pk_bf16_f32 v51, v50, v51
  v_lshlrev_b32 v50, 16, v51
  v_and_b32 v51, s31, v51
  v_lshlrev_b32 v120, 16, v81
  v_and_b32 v121, s31, v81
  v_add_f32 v50, v50, v120
  v_add_f32 v51, v51, v121
  v_cvt_pk_bf16_f32 v101, v50, v51
  v_lshlrev_b32 v50, 16, v101
  v_and_b32 v51, s31, v101
  v_cvt_pk_bf16_f32 v53, v52, v53
  v_lshlrev_b32 v52, 16, v53
  v_and_b32 v53, s31, v53
  s_waitcnt lgkmcnt(0)
  v_lshlrev_b32 v120, 16, v82
  v_and_b32 v121, s31, v82
  v_add_f32 v52, v52, v120
  v_add_f32 v53, v53, v121
  v_cvt_pk_bf16_f32 v102, v52, v53
  v_lshlrev_b32 v52, 16, v102
  v_and_b32 v53, s31, v102
  v_cvt_pk_bf16_f32 v55, v54, v55
  v_lshlrev_b32 v54, 16, v55
  v_and_b32 v55, s31, v55
  v_lshlrev_b32 v120, 16, v83
  v_and_b32 v121, s31, v83
  v_add_f32 v54, v54, v120
  v_add_f32 v55, v55, v121
  v_cvt_pk_bf16_f32 v103, v54, v55
  v_lshlrev_b32 v54, 16, v103
  v_and_b32 v55, s31, v103
  s_barrier
  ds_read_b32 v12, v9
  ds_read_b32 v13, v9 offset:64
  s_cmp_lt_u32 s3, 4
  s_cbranch_scc0 af_single
  buffer_store_dwordx4 v[96:99], v5, s[16:19], s28 offen
  buffer_store_dwordx4 v[100:103], v5, s[16:19], s35 offen
  s_waitcnt lgkmcnt(1)
  v_sub_f32 v40, v40, v12
  v_sub_f32 v41, v41, v12
  v_cvt_pk_bf16_f32 v112, v40, v41
  v_sub_f32 v42, v42, v12
  v_sub_f32 v43, v43, v12
  v_cvt_pk_bf16_f32 v113, v42, v43
  v_sub_f32 v44, v44, v12
  v_sub_f32 v45, v45, v12
  v_cvt_pk_bf16_f32 v114, v44, v45
  v_sub_f32 v46, v46, v12
  v_sub_f32 v47, v47, v12
  v_cvt_pk_bf16_f32 v115, v46, v47
  buffer_store_dwordx4 v[112:115], v5, s[16:19], s32 offen
  s_waitcnt lgkmcnt(0)
  v_sub_f32 v48, v48, v13
  v_sub_f32 v49, v49, v13
  v_cvt_pk_bf16_f32 v116, v48, v49
  v_sub_f32 v50, v50, v13
  v_sub_f32 v51, v51, v13
  v_cvt_pk_bf16_f32 v117, v50, v51
  v_sub_f32 v52, v52, v13
  v_sub_f32 v53, v53, v13
  v_cvt_pk_bf16_f32 v118, v52, v53
  v_sub_f32 v54, v54, v13
  v_sub_f32 v55, v55, v13
  v_cvt_pk_bf16_f32 v119, v54, v55
  buffer_store_dwordx4 v[116:119], v5, s[16:19], s34 offen
  s_endpgm
af_single:
  s_and_b32 s14, s39, 1
  s_lshl_b32 s14, s14, 3
  v_add_u32 v10, s14, v5
  s_nop 1
  buffer_store_dwordx2 v[96:97], v10, s[16:19], s28 offen
  buffer_store_dwordx2 v[100:101], v10, s[16:19], s35 offen
  s_waitcnt lgkmcnt(1)
  v_sub_f32 v40, v40, v12
  v_sub_f32 v41, v41, v12
  v_cvt_pk_bf16_f32 v112, v40, v41
  v_sub_f32 v42, v42, v12
  v_sub_f32 v43, v43, v12
  v_cvt_pk_bf16_f32 v113, v42, v43
  s_waitcnt lgkmcnt(0)
  v_sub_f32 v48, v48, v13
  v_sub_f32 v49, v49, v13
  v_cvt_pk_bf16_f32 v116, v48, v49
  v_sub_f32 v50, v50, v13
  v_sub_f32 v51, v51, v13
  v_cvt_pk_bf16_f32 v117, v50, v51
  buffer_store_dwordx2 v[112:113], v10, s[16:19], s32 offen
  buffer_store_dwordx2 v[116:117], v10, s[16:19], s34 offen
af_end:
  s_endpgm
af_lt:
  v_lshrrev_b32 v143, 4, v5
  v_mul_u32_u24 v140, 3, v143
  v_add_u32 v140, s3, v140
  v_subrev_u32 v140, 5, v140
  s_getpc_b64 s[42:43]
attn_kernel_pc_ffn_kernel:
  s_add_u32 s42, s42, ffn_kernel-attn_kernel_pc_ffn_kernel
  s_addc_u32 s43, s43, 0
  s_bfe_u32 s14, s2, 0x50003
  s_mul_i32 s14, s14, 1280
  v_min_u32 v146, 9, v143
  v_lshlrev_b32 v146, 7, v146
  v_add_u32 v146, s14, v146
  v_min_u32 v146, ffn_kernel_codeend-ffn_kernel-4, v146
  global_load_dword v147, v146, s[42:43]
  v_mul_u32_u24 v141, 21846, v140
  v_lshrrev_b32 v141, 16, v141
  v_mul_u32_u24 v142, 3, v141
  v_sub_u32 v142, v140, v142
  v_lshlrev_b32 v142, 2, v142
  v_mov_b32 v143, 1155
  v_lshrrev_b32 v142, v142, v143
  v_and_b32 v142, 15, v142
  v_mul_u32_u24 v141, 9216, v141
  v_lshl_add_u32 v141, v142, 7, v141
  v_cmp_gt_u32 vcc, 54, v140
  s_nop 1
  v_cndmask_b32 v141, v6, v141, vcc
  s_mul_i32 s14, s4, 1152
  s_lshr_b32 s15, s2, 3
  s_mul_i32 s15, s15, 165888
  s_add_u32 s15, s15, s14
  s_mov_b32 s76, s46
  s_mov_b32 s77, s47
  s_mov_b32 s46, 5308416
  s_mov_b32 s47, 0x20000
  s_mov_b32 s78, 5308416
  s_mov_b32 s79, 0x20000
  buffer_load_dword v144, v141, s[44:47], s15 offen
  buffer_load_dword v145, v141, s[76:79], s15 offen
  s_endpgm 0
af_kvslow:
  s_sub_u32 s33, s33, 1
  s_cmp_lt_i32 s33, 0
  s_cbranch_scc1 af_kvgo
  v_cmp_u_f32 vcc, v32, v33
  s_nop 1
  s_cmp_lg_u64 vcc, 0
  s_cbranch_scc0 af_kv0
  buffer_load_dwordx2 v[32:33], v7, s[16:19], s60 offen sc1
af_kv0:
  v_cmp_u_f32 vcc, v36, v37
  s_nop 1
  s_cmp_lg_u64 vcc, 0
  s_cbranch_scc0 af_kv1
  buffer_load_dwordx2 v[36:37], v7, s[16:19], s61 offen sc1
af_kv1:
  v_cmp_u_f32 vcc, v40, v41
  s_nop 1
  s_cmp_lg_u64 vcc, 0
  s_cbranch_scc0 af_kv2
  buffer_load_dwordx2 v[40:41], v7, s[16:19], s62 offen sc1
af_kv2:
  v_cmp_u_f32 vcc, v44, v45
  s_nop 1
  s_cmp_lg_u64 vcc, 0
  s_cbranch_scc0 af_kv3
  buffer_load_dwordx2 v[44:45], v7, s[16:19], s63 offen sc1
af_kv3:
  v_cmp_u_f32 vcc, v48, v49
  s_nop 1
  s_cmp_lg_u64 vcc, 0
  s_cbranch_scc0 af_kv4
  buffer_load_dwordx2 v[48:49], v7, s[16:19], s64 offen sc1
af_kv4:
  v_cmp_u_f32 vcc, v52, v53
  s_nop 1
  s_cmp_lg_u64 vcc, 0
  s_cbranch_scc0 af_kv5
  buffer_load_dwordx2 v[52:53], v7, s[16:19], s65 offen sc1
af_kv5:
  v_cmp_u_f32 vcc, v56, v57
  s_nop 1
  s_cmp_lg_u64 vcc, 0
  s_cbranch_scc0 af_kv6
  buffer_load_dwordx2 v[56:57], v7, s[16:19], s66 offen sc1
af_kv6:
  v_cmp_u_f32 vcc, v60, v61
  s_nop 1
  s_cmp_lg_u64 vcc, 0
  s_cbranch_scc0 af_kv7
  buffer_load_dwordx2 v[60:61], v7, s[16:19], s67 offen sc1
af_kv7:
  v_cmp_u_f32 vcc, v64, v65
  s_nop 1
  s_cmp_lg_u64 vcc, 0
  s_cbranch_scc0 af_kv8
  buffer_load_dwordx2 v[64:65], v7, s[16:19], s68 offen sc1
af_kv8:
  v_cmp_u_f32 vcc, v68, v69
  s_nop 1
  s_cmp_lg_u64 vcc, 0
  s_cbranch_scc0 af_kv9
  buffer_load_dwordx2 v[68:69], v7, s[16:19], s69 offen sc1
af_kv9:
  v_cmp_u_f32 vcc, v72, v73
  s_nop 1
  s_cmp_lg_u64 vcc, 0
  s_cbranch_scc0 af_kv10
  buffer_load_dwordx2 v[72:73], v7, s[16:19], s70 offen sc1
af_kv10:
  v_cmp_u_f32 vcc, v76, v77
  s_nop 1
  s_cmp_lg_u64 vcc, 0
  s_cbranch_scc0 af_kv11
  buffer_load_dwordx2 v[76:77], v7, s[16:19], s71 offen sc1
af_kv11:
  v_cmp_u_f32 vcc, v80, v81
  s_nop 1
  s_cmp_lg_u64 vcc, 0
  s_cbranch_scc0 af_kv12
  buffer_load_dwordx2 v[80:81], v7, s[16:19], s72 offen sc1
af_kv12:
  v_cmp_u_f32 vcc, v84, v85
  s_nop 1
  s_cmp_lg_u64 vcc, 0
  s_cbranch_scc0 af_kv13
  buffer_load_dwordx2 v[84:85], v7, s[16:19], s73 offen sc1
af_kv13:
  v_cmp_u_f32 vcc, v96, v97
  s_nop 1
  s_cmp_lg_u64 vcc, 0
  s_cbranch_scc0 af_kv14
  buffer_load_dwordx2 v[96:97], v7, s[16:19], s74 offen sc1
af_kv14:
  v_cmp_u_f32 vcc, v100, v101
  s_nop 1
  s_cmp_lg_u64 vcc, 0
  s_cbranch_scc0 af_kv15
  buffer_load_dwordx2 v[100:101], v7, s[16:19], s75 offen sc1
af_kv15:
  s_waitcnt vmcnt(0)
  s_mov_b32 s54, 0x3f80
  s_mov_b32 s55, 0x3f800000
  v_dot2_f32_bf16 v28, v32, s54, 0
  v_dot2_f32_bf16 v29, v32, s55, 0
  v_dot2_f32_bf16 v30, v33, s54, 0
  v_dot2_f32_bf16 v31, v33, s55, 0
  v_dot2_f32_bf16 v28, v36, s54, v28
  v_dot2_f32_bf16 v29, v36, s55, v29
  v_dot2_f32_bf16 v30, v37, s54, v30
  v_dot2_f32_bf16 v31, v37, s55, v31
  v_dot2_f32_bf16 v28, v40, s54, v28
  v_dot2_f32_bf16 v29, v40, s55, v29
  v_dot2_f32_bf16 v30, v41, s54, v30
  v_dot2_f32_bf16 v31, v41, s55, v31
  v_dot2_f32_bf16 v28, v44, s54, v28
  v_dot2_f32_bf16 v29, v44, s55, v29
  v_dot2_f32_bf16 v30, v45, s54, v30
  v_dot2_f32_bf16 v31, v45, s55, v31
  v_dot2_f32_bf16 v28, v48, s54, v28
  v_dot2_f32_bf16 v29, v48, s55, v29
  v_dot2_f32_bf16 v30, v49, s54, v30
  v_dot2_f32_bf16 v31, v49, s55, v31
  v_dot2_f32_bf16 v28, v52, s54, v28
  v_dot2_f32_bf16 v29, v52, s55, v29
  v_dot2_f32_bf16 v30, v53, s54, v30
  v_dot2_f32_bf16 v31, v53, s55, v31
  v_dot2_f32_bf16 v28, v56, s54, v28
  v_dot2_f32_bf16 v29, v56, s55, v29
  v_dot2_f32_bf16 v30, v57, s54, v30
  v_dot2_f32_bf16 v31, v57, s55, v31
  v_dot2_f32_bf16 v28, v60, s54, v28
  v_dot2_f32_bf16 v29, v60, s55, v29
  v_dot2_f32_bf16 v30, v61, s54, v30
  v_dot2_f32_bf16 v31, v61, s55, v31
  v_dot2_f32_bf16 v28, v64, s54, v28
  v_dot2_f32_bf16 v29, v64, s55, v29
  v_dot2_f32_bf16 v30, v65, s54, v30
  v_dot2_f32_bf16 v31, v65, s55, v31
  v_dot2_f32_bf16 v28, v68, s54, v28
  v_dot2_f32_bf16 v29, v68, s55, v29
  v_dot2_f32_bf16 v30, v69, s54, v30
  v_dot2_f32_bf16 v31, v69, s55, v31
  v_dot2_f32_bf16 v28, v72, s54, v28
  v_dot2_f32_bf16 v29, v72, s55, v29
  v_dot2_f32_bf16 v30, v73, s54, v30
  v_dot2_f32_bf16 v31, v73, s55, v31
  v_dot2_f32_bf16 v28, v76, s54, v28
  v_dot2_f32_bf16 v29, v76, s55, v29
  v_dot2_f32_bf16 v30, v77, s54, v30
  v_dot2_f32_bf16 v31, v77, s55, v31
  v_dot2_f32_bf16 v28, v80, s54, v28
  v_dot2_f32_bf16 v29, v80, s55, v29
  v_dot2_f32_bf16 v30, v81, s54, v30
  v_dot2_f32_bf16 v31, v81, s55, v31
  v_dot2_f32_bf16 v28, v84, s54, v28
  v_dot2_f32_bf16 v29, v84, s55, v29
  v_dot2_f32_bf16 v30, v85, s54, v30
  v_dot2_f32_bf16 v31, v85, s55, v31
  v_dot2_f32_bf16 v28, v96, s54, v28
  v_dot2_f32_bf16 v29, v96, s55, v29
  v_dot2_f32_bf16 v30, v97, s54, v30
  v_dot2_f32_bf16 v31, v97, s55, v31
  v_dot2_f32_bf16 v28, v100, s54, v28
  v_dot2_f32_bf16 v29, v100, s55, v29
  v_dot2_f32_bf16 v30, v101, s54, v30
  v_dot2_f32_bf16 v31, v101, s55, v31
  s_nop 2
  v_cmp_u_f32 vcc, v28, v30
  s_nop 1
  s_cmp_lg_u64 vcc, 0
  s_cbranch_scc1 af_kvslow
  s_branch af_kvgo
af_ofslow:
  s_sub_u32 s33, s33, 1
  s_cmp_lt_i32 s33, 0
  s_cbranch_scc1 af_ofgo
  s_cmp_eq_u64 s[66:67], 0
  s_cbranch_scc1 af_of0
  buffer_load_dwordx4 v[56:59], v5, s[16:19], s60 offen sc1
af_of0:
  s_cmp_eq_u64 s[68:69], 0
  s_cbranch_scc1 af_of1
  buffer_load_dwordx4 v[60:63], v5, s[16:19], s61 offen sc1
af_of1:
  s_cmp_eq_u64 s[70:71], 0
  s_cbranch_scc1 af_of2
  buffer_load_dwordx4 v[64:67], v5, s[16:19], s62 offen sc1
af_of2:
  s_cmp_eq_u64 s[72:73], 0
  s_cbranch_scc1 af_of3
  buffer_load_dwordx4 v[68:71], v5, s[16:19], s63 offen sc1
af_of3:
  s_cmp_eq_u64 s[74:75], 0
  s_cbranch_scc1 af_of4
  buffer_load_dwordx4 v[72:75], v5, s[16:19], s64 offen sc1
af_of4:
  s_waitcnt vmcnt(0)
  v_cmp_u_f32_e64 s[66:67], v56, v57
  v_cmp_u_f32 vcc, v58, v59
  s_nop 1
  s_or_b64 s[66:67], s[66:67], vcc
  v_cmp_u_f32_e64 s[68:69], v60, v61
  v_cmp_u_f32 vcc, v62, v63
  s_nop 1
  s_or_b64 s[68:69], s[68:69], vcc
  v_cmp_u_f32_e64 s[70:71], v64, v65
  v_cmp_u_f32 vcc, v66, v67
  s_nop 1
  s_or_b64 s[70:71], s[70:71], vcc
  v_cmp_u_f32_e64 s[72:73], v68, v69
  v_cmp_u_f32 vcc, v70, v71
  s_nop 1
  s_or_b64 s[72:73], s[72:73], vcc
  v_cmp_u_f32_e64 s[74:75], v72, v73
  v_cmp_u_f32 vcc, v74, v75
  s_nop 1
  s_or_b64 s[74:75], s[74:75], vcc
  s_or_b64 vcc, s[66:67], s[68:69]
  s_or_b64 s[54:55], s[70:71], s[72:73]
  s_or_b64 vcc, vcc, s[74:75]
  s_or_b64 vcc, vcc, s[54:55]
  s_cbranch_scc1 af_ofslow
  s_branch af_ofgo
attn_kernel_codeend:
.section .rodata,"a"
.p2align 6
.amdhsa_kernel attn_kernel
  .amdhsa_next_free_vgpr 256
  .amdhsa_next_free_sgpr 102
  .amdhsa_accum_offset 256
  .amdhsa_group_segment_fixed_size 0
  .amdhsa_kernarg_size 88
  .amdhsa_user_sgpr_count 2
  .amdhsa_user_sgpr_kernarg_segment_ptr 1
  .amdhsa_system_sgpr_workgroup_id_x 1
.end_amdhsa_kernel
.text
.globl ffn_kernel
.p2align 8
.type ffn_kernel,@function
ffn_kernel:
  s_cmp_ge_u32 s2, 256
  s_cbranch_scc1 ffn_end
  s_load_dwordx4 s[4:7], s[0:1], 40
  s_load_dwordx2 s[8:9], s[0:1], 56
  s_load_dwordx2 s[12:13], s[0:1], 80
  v_and_b32 v1, 63, v0
  v_lshrrev_b32 v2, 6, v0
  s_nop 0
  v_readfirstlane_b32 s3, v2
  s_and_b32 s10, s2, 7
  s_bfe_u32 s11, s2, 0x10003
  s_lshr_b32 s14, s2, 4
  v_lshlrev_b32 v7, 4, v1
  v_add_u32 v8, 17408, v7
  v_lshrrev_b32 v2, 3, v1
  v_and_b32 v3, 6, v2
  v_and_b32 v35, 7, v1
  v_xor_b32 v3, v3, v35
  v_lshlrev_b32 v3, 4, v3
  s_lshl_b32 s67, s3, 11
  s_lshl_b32 s68, s3, 10
  s_lshl_b32 s15, s3, 3
  v_add_u32 v2, s15, v2
  v_mul_u32_u24 v4, 9216, v2
  v_add_u32 v4, v4, v3
  v_mul_u32_u24 v6, 1152, v2
  v_add_u32 v6, v6, v3
  s_lshl_b32 s69, s14, 3
  s_lshl_b32 s15, s3, 1
  s_add_u32 s69, s69, s15
  s_mul_i32 s69, s69, 18432
  s_add_u32 s69, s69, 15204352
  s_mul_i32 s71, s10, 576
  s_mul_i32 s72, s11, 320
  s_add_u32 s72, s72, s71
  s_lshl_b32 s40, s72, 1
  s_add_u32 s41, s40, 294912
  s_add_u32 s42, s41, 294912
  s_add_u32 s43, s42, 294912
  s_add_u32 s44, s43, 294912
  s_add_u32 s45, s44, 294912
  s_add_u32 s46, s45, 294912
  s_add_u32 s47, s46, 294912
  s_add_u32 s48, s47, 294912
  s_add_u32 s49, s48, 294912
  s_add_u32 s50, s49, 294912
  s_add_u32 s51, s50, 294912
  s_add_u32 s52, s51, 294912
  s_add_u32 s53, s52, 294912
  s_add_u32 s54, s53, 294912
  s_add_u32 s55, s54, 294912
  s_add_u32 s56, s55, 294912
  s_add_u32 s57, s56, 294912
  s_waitcnt lgkmcnt(0)
  s_mov_b32 s16, s12
  s_mov_b32 s17, s13
  s_mov_b32 s18, 268435456
  s_mov_b32 s19, 0x20000
  s_mov_b32 s20, s4
  s_mov_b32 s21, s5
  s_mov_b32 s22, 5308416
  s_mov_b32 s23, 0x20000
  s_sub_u32 s24, s6, 1024
  s_subb_u32 s25, s7, 0
  s_mov_b32 s26, 5309440
  s_mov_b32 s27, 0x20000
  s_add_u32 m0, s67, 155648
  s_nop 0
  buffer_load_dwordx4 v7, s[16:19], s69 offen lds
  buffer_load_dwordx4 v8, s[16:19], s69 offen offset:1024 lds
  s_add_u32 s69, s69, 1024
  s_add_u32 m0, s67, 147456
  s_nop 0
  buffer_load_dwordx4 v4, s[20:23], s40 offen lds
  buffer_load_dwordx4 v4, s[24:27], s40 offen offset:1024 lds
  s_add_u32 m0, s67, 139264
  s_nop 0
  buffer_load_dwordx4 v7, s[16:19], s69 offen lds
  buffer_load_dwordx4 v8, s[16:19], s69 offen offset:1024 lds
  s_add_u32 s69, s69, 1024
  s_add_u32 m0, s67, 131072
  s_nop 0
  buffer_load_dwordx4 v4, s[20:23], s41 offen lds
  buffer_load_dwordx4 v4, s[24:27], s41 offen offset:1024 lds
  v_and_b32 v2, 15, v1
  v_lshrrev_b32 v3, 4, v1
  s_lshr_b32 s73, s3, 1
  s_and_b32 s74, s3, 1
  s_add_u32 m0, s67, 122880
  s_nop 0
  buffer_load_dwordx4 v7, s[16:19], s69 offen lds
  buffer_load_dwordx4 v8, s[16:19], s69 offen offset:1024 lds
  s_add_u32 s69, s69, 1024
  s_add_u32 m0, s67, 114688
  s_nop 0
  buffer_load_dwordx4 v4, s[20:23], s42 offen lds
  buffer_load_dwordx4 v4, s[24:27], s42 offen offset:1024 lds
  v_lshrrev_b32 v37, 2, v2
  v_and_b32 v38, 1, v3
  v_lshl_add_u32 v37, v38, 2, v37
  s_lshl_b32 s15, s74, 2
  v_and_b32 v39, 6, v37
  v_xor_b32 v39, s15, v39
  v_lshlrev_b32 v39, 4, v39
  v_lshl_add_u32 v39, v37, 7, v39
  v_and_b32 v40, 3, v2
  v_lshl_add_u32 v39, v40, 3, v39
  v_lshrrev_b32 v41, 1, v3
  v_lshl_add_u32 v9, v41, 11, v39
  v_xor_b32 v10, 32, v9
  s_lshl_b32 s15, s73, 12
  v_add_u32 v18, s15, v7
  v_add_u32 v11, 65536, v9
  v_add_u32 v12, 65536, v10
  v_add_u32 v19, 65536, v18
  v_add_u32 v13, 131072, v9
  v_add_u32 v14, 131072, v10
  v_add_u32 v20, 131072, v18
  v_lshrrev_b32 v37, 2, v2
  v_lshl_add_u32 v37, v3, 2, v37
  v_xor_b32 v39, s74, v38
  v_lshlrev_b32 v39, 5, v39
  v_lshl_add_u32 v39, v37, 6, v39
  v_lshl_add_u32 v15, v40, 3, v39
  v_add_u32 v16, 65536, v15
  v_add_u32 v17, 131072, v15
  s_lshl_b32 s15, s74, 13
  s_add_u32 s15, s15, 90112
  v_add_u32 v21, s15, v18
  s_lshl_b32 s15, s74, 3
  s_add_u32 s15, s15, 155648
  v_add_u32 v22, s15, v18
  v_add_u32 v23, 0, v7
  v_add_u32 v24, 18432, v7
  v_add_u32 v25, 36864, v7
  v_add_u32 v26, 55296, v7
  v_lshrrev_b32 v37, 2, v1
  s_lshl_b32 s15, s74, 4
  v_add_u32 v37, s15, v37
  v_lshrrev_b32 v39, 3, v1
  v_and_b32 v39, 2, v39
  v_and_b32 v41, 3, v1
  v_xor_b32 v39, v39, v41
  v_mul_u32_u24 v5, 9216, v37
  v_lshl_add_u32 v5, v39, 4, v5
  s_cmp_eq_u32 s73, 0
  s_cselect_b32 s28, s4, s6
  s_cselect_b32 s29, s5, s7
  s_movk_i32 s75, -64
  s_cmp_eq_u32 s11, 0
  s_cselect_b32 s15, 512, s75
  s_cselect_b32 s75, 0, -1
  s_add_u32 s28, s28, s15
  s_addc_u32 s29, s29, s75
  s_mov_b32 s30, 5308416
  s_mov_b32 s31, 0x20000
  s_mov_b32 s32, s8
  s_mov_b32 s33, s9
  s_mov_b32 s34, 5308416
  s_mov_b32 s35, 0x20000
  s_sub_u32 s36, s8, 1024
  s_subb_u32 s37, s9, 0
  s_mov_b32 s38, 5309440
  s_mov_b32 s39, 0x20000
  s_mul_i32 s58, s72, 1152
  s_add_u32 s59, s58, 36864
  s_add_u32 s60, s59, 36864
  s_add_u32 s61, s60, 36864
  s_add_u32 s62, s61, 36864
  s_add_u32 s63, s62, 36864
  s_add_u32 s64, s63, 36864
  s_add_u32 s65, s64, 36864
  s_lshl_b32 s15, s11, 5
  s_add_u32 s15, s15, s71
  s_add_u32 s15, s15, 256
  s_mul_i32 s66, s15, 1152
  s_lshl_b32 s70, s10, 1
  s_add_u32 s70, s70, s11
  s_lshl_b32 s70, s70, 7
  s_lshl_b32 s15, s14, 3
  s_add_u32 s70, s70, s15
  s_lshl_b32 s15, s73, 2
  s_add_u32 s70, s70, s15
  s_mul_i32 s70, s70, 18
  s_add_u32 s70, s70, s74
  s_lshl_b32 s70, s70, 10
  s_add_u32 s70, s70, 20971520
  v_and_b32 v37, 1, v2
  v_cmp_eq_u32_e64 s[76:77], 1, v37
  v_and_b32 v37, 2, v2
  v_cmp_eq_u32_e64 s[78:79], 2, v37
  v_lshrrev_b32 v37, 2, v2
  v_cmp_eq_u32_e64 s[80:81], v37, v3
  v_mov_b32 v46, 0x40000000
  v_lshlrev_b32 v45, 7, v0
  v_cmp_gt_u32 vcc, 162, v0
  s_nop 1
  v_cndmask_b32 v45, v46, v45, vcc
  s_lshr_b32 s15, s2, 3
  s_mul_i32 s12, s15, 20736
  s_mul_i32 s15, s10, 663552
  s_add_u32 s12, s12, s15
  s_getpc_b64 s[82:83]
ffn_kernel_pc_red_kernel:
  s_add_u32 s82, s82, red_kernel-ffn_kernel_pc_red_kernel
  s_addc_u32 s83, s83, 0
  s_bfe_u32 s15, s2, 0x50003
  s_mul_i32 s15, s15, 128
  v_min_u32 v42, 0, v0
  v_lshlrev_b32 v42, 7, v42
  v_add_u32 v42, s15, v42
  v_min_u32 v42, red_kernel_codeend-red_kernel-4, v42
  global_load_dword v43, v42, s[82:83]
  s_waitcnt vmcnt(9)
  s_barrier
  ds_read_b64_tr_b16 v[48:49], v13 offset:16384
  ds_read_b64_tr_b16 v[50:51], v13 offset:20480
  ds_read_b128 a[0:3], v20 offset:24576
  ds_read_b128 a[4:7], v20 offset:25600
  ds_read_b128 a[8:11], v20 offset:26624
  ds_read_b128 a[12:15], v20 offset:27648
  ds_read_b64_tr_b16 v[52:53], v14 offset:16384
  ds_read_b64_tr_b16 v[54:55], v14 offset:20480
  ds_read_b64_tr_b16 v[56:57], v13 offset:17408
  ds_read_b64_tr_b16 v[58:59], v13 offset:21504
  ds_read_b64_tr_b16 v[60:61], v14 offset:17408
  ds_read_b64_tr_b16 v[62:63], v14 offset:21504
  s_waitcnt vmcnt(5) lgkmcnt(0)
  s_barrier
  v_mfma_f32_16x16x32_bf16 v[240:243], a[0:3], a[0:3], 0
  ds_read_b64_tr_b16 v[64:65], v13 offset:0
  s_add_u32 m0, s67, 155648
  v_mfma_f32_16x16x32_bf16 v[244:247], a[4:7], a[4:7], 0
  ds_read_b64_tr_b16 v[66:67], v13 offset:4096
  buffer_load_dwordx4 v7, s[16:19], s69 offen lds
  v_mfma_f32_16x16x32_bf16 v[248:251], a[8:11], a[8:11], 0
  ds_read_b128 a[16:19], v20 offset:8192
  v_mfma_f32_16x16x32_bf16 v[252:255], a[12:15], a[12:15], 0
  ds_read_b128 a[20:23], v20 offset:9216
  v_mfma_f32_16x16x32_bf16 v[80:83], v[48:51], a[0:3], 0
  ds_read_b128 a[24:27], v20 offset:10240
  buffer_load_dwordx4 v8, s[16:19], s69 offen offset:1024 lds
  v_mfma_f32_16x16x32_bf16 v[84:87], v[48:51], a[4:7], 0
  ds_read_b128 a[28:31], v20 offset:11264
  v_mfma_f32_16x16x32_bf16 v[88:91], v[48:51], a[8:11], 0
  ds_read_b64_tr_b16 v[68:69], v14 offset:0
  s_add_u32 s69, s69, 1024
  v_mfma_f32_16x16x32_bf16 v[92:95], v[48:51], a[12:15], 0
  ds_read_b64_tr_b16 v[70:71], v14 offset:4096
  s_add_u32 m0, s67, 147456
  v_mfma_f32_16x16x32_bf16 v[96:99], v[52:55], a[0:3], 0
  ds_read_b64_tr_b16 v[72:73], v13 offset:1024
  buffer_load_dwordx4 v4, s[20:23], s43 offen lds
  v_mfma_f32_16x16x32_bf16 v[100:103], v[52:55], a[4:7], 0
  ds_read_b64_tr_b16 v[74:75], v13 offset:5120
  v_mfma_f32_16x16x32_bf16 v[104:107], v[52:55], a[8:11], 0
  ds_read_b64_tr_b16 v[76:77], v14 offset:1024
  v_mfma_f32_16x16x32_bf16 v[108:111], v[52:55], a[12:15], 0
  ds_read_b64_tr_b16 v[78:79], v14 offset:5120
  buffer_load_dwordx4 v4, s[24:27], s43 offen offset:1024 lds
  v_mfma_f32_16x16x32_bf16 v[112:115], v[56:59], a[0:3], 0
  v_mfma_f32_16x16x32_bf16 v[116:119], v[56:59], a[4:7], 0
  s_add_u32 m0, s67, 106496
  v_mfma_f32_16x16x32_bf16 v[120:123], v[56:59], a[8:11], 0
  buffer_load_dwordx4 v7, s[16:19], s69 offen lds
  v_mfma_f32_16x16x32_bf16 v[124:127], v[56:59], a[12:15], 0
  v_mfma_f32_16x16x32_bf16 v[128:131], v[60:63], a[0:3], 0
  v_mfma_f32_16x16x32_bf16 v[132:135], v[60:63], a[4:7], 0
  buffer_load_dwordx4 v8, s[16:19], s69 offen offset:1024 lds
  v_mfma_f32_16x16x32_bf16 v[136:139], v[60:63], a[8:11], 0
  v_mfma_f32_16x16x32_bf16 v[140:143], v[60:63], a[12:15], 0
  s_waitcnt vmcnt(7) lgkmcnt(0)
  s_barrier
  v_mfma_f32_16x16x32_bf16 v[240:243], a[16:19], a[16:19], v[240:243]
  ds_read_b64_tr_b16 v[48:49], v11 offset:49152
  s_add_u32 s69, s69, 1024
  v_mfma_f32_16x16x32_bf16 v[244:247], a[20:23], a[20:23], v[244:247]
  ds_read_b64_tr_b16 v[50:51], v11 offset:53248
  s_add_u32 m0, s67, 139264
  v_mfma_f32_16x16x32_bf16 v[248:251], a[24:27], a[24:27], v[248:251]
  ds_read_b128 a[32:35], v19 offset:57344
  buffer_load_dwordx4 v4, s[20:23], s44 offen lds
  v_mfma_f32_16x16x32_bf16 v[252:255], a[28:31], a[28:31], v[252:255]
  ds_read_b128 a[36:39], v19 offset:58368
  v_mfma_f32_16x16x32_bf16 v[80:83], v[64:67], a[16:19], v[80:83]
  ds_read_b128 a[40:43], v19 offset:59392
  v_mfma_f32_16x16x32_bf16 v[84:87], v[64:67], a[20:23], v[84:87]
  ds_read_b128 a[44:47], v19 offset:60416
  buffer_load_dwordx4 v4, s[24:27], s44 offen offset:1024 lds
  v_mfma_f32_16x16x32_bf16 v[88:91], v[64:67], a[24:27], v[88:91]
  ds_read_b64_tr_b16 v[52:53], v12 offset:49152
  v_mfma_f32_16x16x32_bf16 v[92:95], v[64:67], a[28:31], v[92:95]
  ds_read_b64_tr_b16 v[54:55], v12 offset:53248
  s_add_u32 m0, s67, 131072
  v_mfma_f32_16x16x32_bf16 v[96:99], v[68:71], a[16:19], v[96:99]
  ds_read_b64_tr_b16 v[56:57], v11 offset:50176
  buffer_load_dwordx4 v7, s[16:19], s69 offen lds
  v_mfma_f32_16x16x32_bf16 v[100:103], v[68:71], a[20:23], v[100:103]
  ds_read_b64_tr_b16 v[58:59], v11 offset:54272
  v_mfma_f32_16x16x32_bf16 v[104:107], v[68:71], a[24:27], v[104:107]
  ds_read_b64_tr_b16 v[60:61], v12 offset:50176
  v_mfma_f32_16x16x32_bf16 v[108:111], v[68:71], a[28:31], v[108:111]
  ds_read_b64_tr_b16 v[62:63], v12 offset:54272
  buffer_load_dwordx4 v8, s[16:19], s69 offen offset:1024 lds
  v_mfma_f32_16x16x32_bf16 v[112:115], v[72:75], a[16:19], v[112:115]
  v_mfma_f32_16x16x32_bf16 v[116:119], v[72:75], a[20:23], v[116:119]
  s_add_u32 s69, s69, 1024
  s_add_u32 m0, s67, 98304
  v_mfma_f32_16x16x32_bf16 v[120:123], v[72:75], a[24:27], v[120:123]
  buffer_load_dwordx4 v4, s[20:23], s45 offen lds
  v_mfma_f32_16x16x32_bf16 v[124:127], v[72:75], a[28:31], v[124:127]
  v_mfma_f32_16x16x32_bf16 v[128:131], v[76:79], a[16:19], v[128:131]
  v_mfma_f32_16x16x32_bf16 v[132:135], v[76:79], a[20:23], v[132:135]
  buffer_load_dwordx4 v4, s[24:27], s45 offen offset:1024 lds
  v_mfma_f32_16x16x32_bf16 v[136:139], v[76:79], a[24:27], v[136:139]
  v_mfma_f32_16x16x32_bf16 v[140:143], v[76:79], a[28:31], v[140:143]
  s_waitcnt vmcnt(8) lgkmcnt(0)
  s_barrier
  v_mfma_f32_16x16x32_bf16 v[240:243], a[32:35], a[32:35], v[240:243]
  ds_read_b64_tr_b16 v[64:65], v13 offset:16384
  s_add_u32 m0, s67, 122880
  v_mfma_f32_16x16x32_bf16 v[244:247], a[36:39], a[36:39], v[244:247]
  ds_read_b64_tr_b16 v[66:67], v13 offset:20480
  buffer_load_dwordx4 v7, s[16:19], s69 offen lds
  v_mfma_f32_16x16x32_bf16 v[248:251], a[40:43], a[40:43], v[248:251]
  ds_read_b128 a[48:51], v20 offset:24576
  v_mfma_f32_16x16x32_bf16 v[252:255], a[44:47], a[44:47], v[252:255]
  ds_read_b128 a[52:55], v20 offset:25600
  v_mfma_f32_16x16x32_bf16 v[80:83], v[48:51], a[32:35], v[80:83]
  ds_read_b128 a[56:59], v20 offset:26624
  buffer_load_dwordx4 v8, s[16:19], s69 offen offset:1024 lds
  v_mfma_f32_16x16x32_bf16 v[84:87], v[48:51], a[36:39], v[84:87]
  ds_read_b128 a[60:63], v20 offset:27648
  v_mfma_f32_16x16x32_bf16 v[88:91], v[48:51], a[40:43], v[88:91]
  ds_read_b64_tr_b16 v[68:69], v14 offset:16384
  s_add_u32 s69, s69, 1024
  v_mfma_f32_16x16x32_bf16 v[92:95], v[48:51], a[44:47], v[92:95]
  ds_read_b64_tr_b16 v[70:71], v14 offset:20480
  s_add_u32 m0, s67, 114688
  v_mfma_f32_16x16x32_bf16 v[96:99], v[52:55], a[32:35], v[96:99]
  ds_read_b64_tr_b16 v[72:73], v13 offset:17408
  buffer_load_dwordx4 v4, s[20:23], s46 offen lds
  v_mfma_f32_16x16x32_bf16 v[100:103], v[52:55], a[36:39], v[100:103]
  ds_read_b64_tr_b16 v[74:75], v13 offset:21504
  v_mfma_f32_16x16x32_bf16 v[104:107], v[52:55], a[40:43], v[104:107]
  ds_read_b64_tr_b16 v[76:77], v14 offset:17408
  v_mfma_f32_16x16x32_bf16 v[108:111], v[52:55], a[44:47], v[108:111]
  ds_read_b64_tr_b16 v[78:79], v14 offset:21504
  buffer_load_dwordx4 v4, s[24:27], s46 offen offset:1024 lds
  v_mfma_f32_16x16x32_bf16 v[112:115], v[56:59], a[32:35], v[112:115]
  v_mfma_f32_16x16x32_bf16 v[116:119], v[56:59], a[36:39], v[116:119]
  s_add_u32 m0, s67, 90112
  v_mfma_f32_16x16x32_bf16 v[120:123], v[56:59], a[40:43], v[120:123]
  buffer_load_dwordx4 v7, s[16:19], s69 offen lds
  v_mfma_f32_16x16x32_bf16 v[124:127], v[56:59], a[44:47], v[124:127]
  v_mfma_f32_16x16x32_bf16 v[128:131], v[60:63], a[32:35], v[128:131]
  v_mfma_f32_16x16x32_bf16 v[132:135], v[60:63], a[36:39], v[132:135]
  buffer_load_dwordx4 v8, s[16:19], s69 offen offset:1024 lds
  v_mfma_f32_16x16x32_bf16 v[136:139], v[60:63], a[40:43], v[136:139]
  v_mfma_f32_16x16x32_bf16 v[140:143], v[60:63], a[44:47], v[140:143]
  s_waitcnt vmcnt(10) lgkmcnt(0)
  s_barrier
  v_mfma_f32_16x16x32_bf16 v[240:243], a[48:51], a[48:51], v[240:243]
  ds_read_b64_tr_b16 v[48:49], v13 offset:8192
  s_add_u32 s69, s69, 1024
  v_mfma_f32_16x16x32_bf16 v[244:247], a[52:55], a[52:55], v[244:247]
  ds_read_b64_tr_b16 v[50:51], v13 offset:12288
  s_add_u32 m0, s67, 155648
  v_mfma_f32_16x16x32_bf16 v[248:251], a[56:59], a[56:59], v[248:251]
  ds_read_b128 a[64:67], v19 offset:40960
  buffer_load_dwordx4 v4, s[20:23], s47 offen lds
  v_mfma_f32_16x16x32_bf16 v[252:255], a[60:63], a[60:63], v[252:255]
  ds_read_b128 a[68:71], v19 offset:41984
  v_mfma_f32_16x16x32_bf16 v[80:83], v[64:67], a[48:51], v[80:83]
  ds_read_b128 a[72:75], v19 offset:43008
  v_mfma_f32_16x16x32_bf16 v[84:87], v[64:67], a[52:55], v[84:87]
  ds_read_b128 a[76:79], v19 offset:44032
  buffer_load_dwordx4 v4, s[24:27], s47 offen offset:1024 lds
  v_mfma_f32_16x16x32_bf16 v[88:91], v[64:67], a[56:59], v[88:91]
  ds_read_b64_tr_b16 v[52:53], v14 offset:8192
  v_mfma_f32_16x16x32_bf16 v[92:95], v[64:67], a[60:63], v[92:95]
  ds_read_b64_tr_b16 v[54:55], v14 offset:12288
  s_add_u32 m0, s67, 147456
  v_mfma_f32_16x16x32_bf16 v[96:99], v[68:71], a[48:51], v[96:99]
  ds_read_b64_tr_b16 v[56:57], v13 offset:9216
  buffer_load_dwordx4 v7, s[16:19], s69 offen lds
  v_mfma_f32_16x16x32_bf16 v[100:103], v[68:71], a[52:55], v[100:103]
  ds_read_b64_tr_b16 v[58:59], v13 offset:13312
  v_mfma_f32_16x16x32_bf16 v[104:107], v[68:71], a[56:59], v[104:107]
  ds_read_b64_tr_b16 v[60:61], v14 offset:9216
  v_mfma_f32_16x16x32_bf16 v[108:111], v[68:71], a[60:63], v[108:111]
  ds_read_b64_tr_b16 v[62:63], v14 offset:13312
  buffer_load_dwordx4 v8, s[16:19], s69 offen offset:1024 lds
  v_mfma_f32_16x16x32_bf16 v[112:115], v[72:75], a[48:51], v[112:115]
  v_mfma_f32_16x16x32_bf16 v[116:119], v[72:75], a[52:55], v[116:119]
  s_add_u32 s69, s69, 1024
  s_add_u32 m0, s67, 81920
  v_mfma_f32_16x16x32_bf16 v[120:123], v[72:75], a[56:59], v[120:123]
  buffer_load_dwordx4 v4, s[20:23], s48 offen lds
  v_mfma_f32_16x16x32_bf16 v[124:127], v[72:75], a[60:63], v[124:127]
  v_mfma_f32_16x16x32_bf16 v[128:131], v[76:79], a[48:51], v[128:131]
  v_mfma_f32_16x16x32_bf16 v[132:135], v[76:79], a[52:55], v[132:135]
  buffer_load_dwordx4 v4, s[24:27], s48 offen offset:1024 lds
  v_mfma_f32_16x16x32_bf16 v[136:139], v[76:79], a[56:59], v[136:139]
  v_mfma_f32_16x16x32_bf16 v[140:143], v[76:79], a[60:63], v[140:143]
  s_waitcnt vmcnt(12) lgkmcnt(0)
  s_barrier
  v_mfma_f32_16x16x32_bf16 v[240:243], a[64:67], a[64:67], v[240:243]
  ds_read_b64_tr_b16 v[64:65], v11 offset:32768
  s_add_u32 m0, s67, 139264
  v_mfma_f32_16x16x32_bf16 v[244:247], a[68:71], a[68:71], v[244:247]
  ds_read_b64_tr_b16 v[66:67], v11 offset:36864
  buffer_load_dwordx4 v7, s[16:19], s69 offen lds
  v_mfma_f32_16x16x32_bf16 v[248:251], a[72:75], a[72:75], v[248:251]
  ds_read_b128 a[80:83], v20 offset:0
  v_mfma_f32_16x16x32_bf16 v[252:255], a[76:79], a[76:79], v[252:255]
  ds_read_b128 a[84:87], v20 offset:1024
  v_mfma_f32_16x16x32_bf16 v[80:83], v[48:51], a[64:67], v[80:83]
  ds_read_b128 a[88:91], v20 offset:2048
  buffer_load_dwordx4 v8, s[16:19], s69 offen offset:1024 lds
  v_mfma_f32_16x16x32_bf16 v[84:87], v[48:51], a[68:71], v[84:87]
  ds_read_b128 a[92:95], v20 offset:3072
  v_mfma_f32_16x16x32_bf16 v[88:91], v[48:51], a[72:75], v[88:91]
  ds_read_b64_tr_b16 v[68:69], v12 offset:32768
  s_add_u32 s69, s69, 1024
  v_mfma_f32_16x16x32_bf16 v[92:95], v[48:51], a[76:79], v[92:95]
  ds_read_b64_tr_b16 v[70:71], v12 offset:36864
  s_add_u32 m0, s67, 106496
  v_mfma_f32_16x16x32_bf16 v[96:99], v[52:55], a[64:67], v[96:99]
  ds_read_b64_tr_b16 v[72:73], v11 offset:33792
  buffer_load_dwordx4 v4, s[20:23], s49 offen lds
  v_mfma_f32_16x16x32_bf16 v[100:103], v[52:55], a[68:71], v[100:103]
  ds_read_b64_tr_b16 v[74:75], v11 offset:37888
  v_mfma_f32_16x16x32_bf16 v[104:107], v[52:55], a[72:75], v[104:107]
  ds_read_b64_tr_b16 v[76:77], v12 offset:33792
  v_mfma_f32_16x16x32_bf16 v[108:111], v[52:55], a[76:79], v[108:111]
  ds_read_b64_tr_b16 v[78:79], v12 offset:37888
  buffer_load_dwordx4 v4, s[24:27], s49 offen offset:1024 lds
  v_mfma_f32_16x16x32_bf16 v[112:115], v[56:59], a[64:67], v[112:115]
  v_mfma_f32_16x16x32_bf16 v[116:119], v[56:59], a[68:71], v[116:119]
  s_add_u32 m0, s67, 73728
  v_mfma_f32_16x16x32_bf16 v[120:123], v[56:59], a[72:75], v[120:123]
  buffer_load_dwordx4 v7, s[16:19], s69 offen lds
  v_mfma_f32_16x16x32_bf16 v[124:127], v[56:59], a[76:79], v[124:127]
  v_mfma_f32_16x16x32_bf16 v[128:131], v[60:63], a[64:67], v[128:131]
  v_mfma_f32_16x16x32_bf16 v[132:135], v[60:63], a[68:71], v[132:135]
  buffer_load_dwordx4 v8, s[16:19], s69 offen offset:1024 lds
  v_mfma_f32_16x16x32_bf16 v[136:139], v[60:63], a[72:75], v[136:139]
  v_mfma_f32_16x16x32_bf16 v[140:143], v[60:63], a[76:79], v[140:143]
  s_waitcnt vmcnt(14) lgkmcnt(0)
  s_barrier
  v_mfma_f32_16x16x32_bf16 v[240:243], a[80:83], a[80:83], v[240:243]
  ds_read_b64_tr_b16 v[48:49], v11 offset:49152
  s_add_u32 s69, s69, 1024
  v_mfma_f32_16x16x32_bf16 v[244:247], a[84:87], a[84:87], v[244:247]
  ds_read_b64_tr_b16 v[50:51], v11 offset:53248
  s_add_u32 m0, s67, 131072
  v_mfma_f32_16x16x32_bf16 v[248:251], a[88:91], a[88:91], v[248:251]
  ds_read_b128 a[96:99], v19 offset:57344
  buffer_load_dwordx4 v4, s[20:23], s50 offen lds
  v_mfma_f32_16x16x32_bf16 v[252:255], a[92:95], a[92:95], v[252:255]
  ds_read_b128 a[100:103], v19 offset:58368
  v_mfma_f32_16x16x32_bf16 v[80:83], v[64:67], a[80:83], v[80:83]
  ds_read_b128 a[104:107], v19 offset:59392
  v_mfma_f32_16x16x32_bf16 v[84:87], v[64:67], a[84:87], v[84:87]
  ds_read_b128 a[108:111], v19 offset:60416
  buffer_load_dwordx4 v4, s[24:27], s50 offen offset:1024 lds
  v_mfma_f32_16x16x32_bf16 v[88:91], v[64:67], a[88:91], v[88:91]
  ds_read_b64_tr_b16 v[52:53], v12 offset:49152
  v_mfma_f32_16x16x32_bf16 v[92:95], v[64:67], a[92:95], v[92:95]
  ds_read_b64_tr_b16 v[54:55], v12 offset:53248
  s_add_u32 m0, s67, 98304
  v_mfma_f32_16x16x32_bf16 v[96:99], v[68:71], a[80:83], v[96:99]
  ds_read_b64_tr_b16 v[56:57], v11 offset:50176
  buffer_load_dwordx4 v7, s[16:19], s69 offen lds
  v_mfma_f32_16x16x32_bf16 v[100:103], v[68:71], a[84:87], v[100:103]
  ds_read_b64_tr_b16 v[58:59], v11 offset:54272
  v_mfma_f32_16x16x32_bf16 v[104:107], v[68:71], a[88:91], v[104:107]
  ds_read_b64_tr_b16 v[60:61], v12 offset:50176
  v_mfma_f32_16x16x32_bf16 v[108:111], v[68:71], a[92:95], v[108:111]
  ds_read_b64_tr_b16 v[62:63], v12 offset:54272
  buffer_load_dwordx4 v8, s[16:19], s69 offen offset:1024 lds
  v_mfma_f32_16x16x32_bf16 v[112:115], v[72:75], a[80:83], v[112:115]
  v_mfma_f32_16x16x32_bf16 v[116:119], v[72:75], a[84:87], v[116:119]
  s_add_u32 s69, s69, 1024
  s_add_u32 m0, s67, 65536
  v_mfma_f32_16x16x32_bf16 v[120:123], v[72:75], a[88:91], v[120:123]
  buffer_load_dwordx4 v4, s[20:23], s51 offen lds
  v_mfma_f32_16x16x32_bf16 v[124:127], v[72:75], a[92:95], v[124:127]
  v_mfma_f32_16x16x32_bf16 v[128:131], v[76:79], a[80:83], v[128:131]
  v_mfma_f32_16x16x32_bf16 v[132:135], v[76:79], a[84:87], v[132:135]
  buffer_load_dwordx4 v4, s[24:27], s51 offen offset:1024 lds
  v_mfma_f32_16x16x32_bf16 v[136:139], v[76:79], a[88:91], v[136:139]
  v_mfma_f32_16x16x32_bf16 v[140:143], v[76:79], a[92:95], v[140:143]
  s_waitcnt vmcnt(12) lgkmcnt(0)
  s_barrier
  v_mfma_f32_16x16x32_bf16 v[240:243], a[96:99], a[96:99], v[240:243]
  ds_read_b64_tr_b16 v[64:65], v13 offset:24576
  s_add_u32 m0, s67, 122880
  v_mfma_f32_16x16x32_bf16 v[244:247], a[100:103], a[100:103], v[244:247]
  ds_read_b64_tr_b16 v[66:67], v13 offset:28672
  buffer_load_dwordx4 v7, s[16:19], s69 offen lds
  v_mfma_f32_16x16x32_bf16 v[248:251], a[104:107], a[104:107], v[248:251]
  ds_read_b128 a[112:115], v19 offset:24576
  v_mfma_f32_16x16x32_bf16 v[252:255], a[108:111], a[108:111], v[252:255]
  ds_read_b128 a[116:119], v19 offset:25600
  v_mfma_f32_16x16x32_bf16 v[80:83], v[48:51], a[96:99], v[80:83]
  ds_read_b128 a[120:123], v19 offset:26624
  buffer_load_dwordx4 v8, s[16:19], s69 offen offset:1024 lds
  v_mfma_f32_16x16x32_bf16 v[84:87], v[48:51], a[100:103], v[84:87]
  ds_read_b128 a[124:127], v19 offset:27648
  v_mfma_f32_16x16x32_bf16 v[88:91], v[48:51], a[104:107], v[88:91]
  ds_read_b64_tr_b16 v[68:69], v14 offset:24576
  s_add_u32 s69, s69, 1024
  v_mfma_f32_16x16x32_bf16 v[92:95], v[48:51], a[108:111], v[92:95]
  ds_read_b64_tr_b16 v[70:71], v14 offset:28672
  s_add_u32 m0, s67, 114688
  v_mfma_f32_16x16x32_bf16 v[96:99], v[52:55], a[96:99], v[96:99]
  ds_read_b64_tr_b16 v[72:73], v13 offset:25600
  buffer_load_dwordx4 v4, s[20:23], s52 offen lds
  v_mfma_f32_16x16x32_bf16 v[100:103], v[52:55], a[100:103], v[100:103]
  ds_read_b64_tr_b16 v[74:75], v13 offset:29696
  v_mfma_f32_16x16x32_bf16 v[104:107], v[52:55], a[104:107], v[104:107]
  ds_read_b64_tr_b16 v[76:77], v14 offset:25600
  v_mfma_f32_16x16x32_bf16 v[108:111], v[52:55], a[108:111], v[108:111]
  ds_read_b64_tr_b16 v[78:79], v14 offset:29696
  buffer_load_dwordx4 v4, s[24:27], s52 offen offset:1024 lds
  v_mfma_f32_16x16x32_bf16 v[112:115], v[56:59], a[96:99], v[112:115]
  v_mfma_f32_16x16x32_bf16 v[116:119], v[56:59], a[100:103], v[116:119]
  v_mfma_f32_16x16x32_bf16 v[120:123], v[56:59], a[104:107], v[120:123]
  v_mfma_f32_16x16x32_bf16 v[124:127], v[56:59], a[108:111], v[124:127]
  v_mfma_f32_16x16x32_bf16 v[128:131], v[60:63], a[96:99], v[128:131]
  v_mfma_f32_16x16x32_bf16 v[132:135], v[60:63], a[100:103], v[132:135]
  v_mfma_f32_16x16x32_bf16 v[136:139], v[60:63], a[104:107], v[136:139]
  v_mfma_f32_16x16x32_bf16 v[140:143], v[60:63], a[108:111], v[140:143]
  s_waitcnt lgkmcnt(0)
  v_mfma_f32_16x16x32_bf16 v[240:243], a[112:115], a[112:115], v[240:243]
  ds_read_b64_tr_b16 v[48:49], v11 offset:16384
  s_add_u32 m0, s67, 57344
  v_mfma_f32_16x16x32_bf16 v[244:247], a[116:119], a[116:119], v[244:247]
  ds_read_b64_tr_b16 v[50:51], v11 offset:20480
  buffer_load_dwordx4 v7, s[16:19], s69 offen lds
  v_mfma_f32_16x16x32_bf16 v[248:251], a[120:123], a[120:123], v[248:251]
  ds_read_b128 a[128:131], v20 offset:16384
  v_mfma_f32_16x16x32_bf16 v[252:255], a[124:127], a[124:127], v[252:255]
  ds_read_b128 a[132:135], v20 offset:17408
  v_mfma_f32_16x16x32_bf16 v[80:83], v[64:67], a[112:115], v[80:83]
  ds_read_b128 a[136:139], v20 offset:18432
  buffer_load_dwordx4 v8, s[16:19], s69 offen offset:1024 lds
  v_mfma_f32_16x16x32_bf16 v[84:87], v[64:67], a[116:119], v[84:87]
  ds_read_b128 a[140:143], v20 offset:19456
  v_mfma_f32_16x16x32_bf16 v[88:91], v[64:67], a[120:123], v[88:91]
  ds_read_b64_tr_b16 v[52:53], v12 offset:16384
  s_add_u32 s69, s69, 1024
  v_mfma_f32_16x16x32_bf16 v[92:95], v[64:67], a[124:127], v[92:95]
  ds_read_b64_tr_b16 v[54:55], v12 offset:20480
  s_add_u32 m0, s67, 49152
  v_mfma_f32_16x16x32_bf16 v[96:99], v[68:71], a[112:115], v[96:99]
  ds_read_b64_tr_b16 v[56:57], v11 offset:17408
  buffer_load_dwordx4 v4, s[20:23], s53 offen lds
  v_mfma_f32_16x16x32_bf16 v[100:103], v[68:71], a[116:119], v[100:103]
  ds_read_b64_tr_b16 v[58:59], v11 offset:21504
  v_mfma_f32_16x16x32_bf16 v[104:107], v[68:71], a[120:123], v[104:107]
  ds_read_b64_tr_b16 v[60:61], v12 offset:17408
  v_mfma_f32_16x16x32_bf16 v[108:111], v[68:71], a[124:127], v[108:111]
  ds_read_b64_tr_b16 v[62:63], v12 offset:21504
  buffer_load_dwordx4 v4, s[24:27], s53 offen offset:1024 lds
  v_mfma_f32_16x16x32_bf16 v[112:115], v[72:75], a[112:115], v[112:115]
  v_mfma_f32_16x16x32_bf16 v[116:119], v[72:75], a[116:119], v[116:119]
  v_mfma_f32_16x16x32_bf16 v[120:123], v[72:75], a[120:123], v[120:123]
  v_mfma_f32_16x16x32_bf16 v[124:127], v[72:75], a[124:127], v[124:127]
  v_mfma_f32_16x16x32_bf16 v[128:131], v[76:79], a[112:115], v[128:131]
  v_mfma_f32_16x16x32_bf16 v[132:135], v[76:79], a[116:119], v[132:135]
  v_mfma_f32_16x16x32_bf16 v[136:139], v[76:79], a[120:123], v[136:139]
  v_mfma_f32_16x16x32_bf16 v[140:143], v[76:79], a[124:127], v[140:143]
  s_waitcnt vmcnt(12) lgkmcnt(0)
  s_barrier
  v_mfma_f32_16x16x32_bf16 v[240:243], a[128:131], a[128:131], v[240:243]
  ds_read_b64_tr_b16 v[64:65], v11 offset:40960
  s_add_u32 m0, s67, 155648
  v_mfma_f32_16x16x32_bf16 v[244:247], a[132:135], a[132:135], v[244:247]
  ds_read_b64_tr_b16 v[66:67], v11 offset:45056
  buffer_load_dwordx4 v7, s[16:19], s69 offen lds
  v_mfma_f32_16x16x32_bf16 v[248:251], a[136:139], a[136:139], v[248:251]
  ds_read_b128 a[144:147], v20 offset:8192
  v_mfma_f32_16x16x32_bf16 v[252:255], a[140:143], a[140:143], v[252:255]
  ds_read_b128 a[148:151], v20 offset:9216
  v_mfma_f32_16x16x32_bf16 v[80:83], v[48:51], a[128:131], v[80:83]
  ds_read_b128 a[152:155], v20 offset:10240
  buffer_load_dwordx4 v8, s[16:19], s69 offen offset:1024 lds
  v_mfma_f32_16x16x32_bf16 v[84:87], v[48:51], a[132:135], v[84:87]
  ds_read_b128 a[156:159], v20 offset:11264
  v_mfma_f32_16x16x32_bf16 v[88:91], v[48:51], a[136:139], v[88:91]
  ds_read_b64_tr_b16 v[68:69], v12 offset:40960
  s_add_u32 s69, s69, 1024
  v_mfma_f32_16x16x32_bf16 v[92:95], v[48:51], a[140:143], v[92:95]
  ds_read_b64_tr_b16 v[70:71], v12 offset:45056
  s_add_u32 m0, s67, 147456
  v_mfma_f32_16x16x32_bf16 v[96:99], v[52:55], a[128:131], v[96:99]
  ds_read_b64_tr_b16 v[72:73], v11 offset:41984
  buffer_load_dwordx4 v4, s[20:23], s54 offen lds
  v_mfma_f32_16x16x32_bf16 v[100:103], v[52:55], a[132:135], v[100:103]
  ds_read_b64_tr_b16 v[74:75], v11 offset:46080
  v_mfma_f32_16x16x32_bf16 v[104:107], v[52:55], a[136:139], v[104:107]
  ds_read_b64_tr_b16 v[76:77], v12 offset:41984
  v_mfma_f32_16x16x32_bf16 v[108:111], v[52:55], a[140:143], v[108:111]
  ds_read_b64_tr_b16 v[78:79], v12 offset:46080
  buffer_load_dwordx4 v4, s[24:27], s54 offen offset:1024 lds
  v_mfma_f32_16x16x32_bf16 v[112:115], v[56:59], a[128:131], v[112:115]
  v_mfma_f32_16x16x32_bf16 v[116:119], v[56:59], a[132:135], v[116:119]
  v_mfma_f32_16x16x32_bf16 v[120:123], v[56:59], a[136:139], v[120:123]
  v_mfma_f32_16x16x32_bf16 v[124:127], v[56:59], a[140:143], v[124:127]
  v_mfma_f32_16x16x32_bf16 v[128:131], v[60:63], a[128:131], v[128:131]
  v_mfma_f32_16x16x32_bf16 v[132:135], v[60:63], a[132:135], v[132:135]
  v_mfma_f32_16x16x32_bf16 v[136:139], v[60:63], a[136:139], v[136:139]
  v_mfma_f32_16x16x32_bf16 v[140:143], v[60:63], a[140:143], v[140:143]
  s_waitcnt lgkmcnt(0)
  v_mfma_f32_16x16x32_bf16 v[240:243], a[144:147], a[144:147], v[240:243]
  ds_read_b64_tr_b16 v[48:49], v13 offset:0
  s_add_u32 m0, s67, 90112
  v_mfma_f32_16x16x32_bf16 v[244:247], a[148:151], a[148:151], v[244:247]
  ds_read_b64_tr_b16 v[50:51], v13 offset:4096
  buffer_load_dwordx4 v7, s[16:19], s69 offen lds
  v_mfma_f32_16x16x32_bf16 v[248:251], a[152:155], a[152:155], v[248:251]
  ds_read_b128 a[160:163], v19 offset:8192
  v_mfma_f32_16x16x32_bf16 v[252:255], a[156:159], a[156:159], v[252:255]
  ds_read_b128 a[164:167], v19 offset:9216
  v_mfma_f32_16x16x32_bf16 v[80:83], v[64:67], a[144:147], v[80:83]
  ds_read_b128 a[168:171], v19 offset:10240
  buffer_load_dwordx4 v8, s[16:19], s69 offen offset:1024 lds
  v_mfma_f32_16x16x32_bf16 v[84:87], v[64:67], a[148:151], v[84:87]
  ds_read_b128 a[172:175], v19 offset:11264
  v_mfma_f32_16x16x32_bf16 v[88:91], v[64:67], a[152:155], v[88:91]
  ds_read_b64_tr_b16 v[52:53], v14 offset:0
  s_add_u32 s69, s69, 1024
  v_mfma_f32_16x16x32_bf16 v[92:95], v[64:67], a[156:159], v[92:95]
  ds_read_b64_tr_b16 v[54:55], v14 offset:4096
  s_add_u32 m0, s67, 81920
  v_mfma_f32_16x16x32_bf16 v[96:99], v[68:71], a[144:147], v[96:99]
  ds_read_b64_tr_b16 v[56:57], v13 offset:1024
  buffer_load_dwordx4 v4, s[20:23], s55 offen lds
  v_mfma_f32_16x16x32_bf16 v[100:103], v[68:71], a[148:151], v[100:103]
  ds_read_b64_tr_b16 v[58:59], v13 offset:5120
  v_mfma_f32_16x16x32_bf16 v[104:107], v[68:71], a[152:155], v[104:107]
  ds_read_b64_tr_b16 v[60:61], v14 offset:1024
  v_mfma_f32_16x16x32_bf16 v[108:111], v[68:71], a[156:159], v[108:111]
  ds_read_b64_tr_b16 v[62:63], v14 offset:5120
  buffer_load_dwordx4 v4, s[24:27], s55 offen offset:1024 lds
  v_mfma_f32_16x16x32_bf16 v[112:115], v[72:75], a[144:147], v[112:115]
  v_mfma_f32_16x16x32_bf16 v[116:119], v[72:75], a[148:151], v[116:119]
  v_mfma_f32_16x16x32_bf16 v[120:123], v[72:75], a[152:155], v[120:123]
  v_mfma_f32_16x16x32_bf16 v[124:127], v[72:75], a[156:159], v[124:127]
  v_mfma_f32_16x16x32_bf16 v[128:131], v[76:79], a[144:147], v[128:131]
  v_mfma_f32_16x16x32_bf16 v[132:135], v[76:79], a[148:151], v[132:135]
  v_mfma_f32_16x16x32_bf16 v[136:139], v[76:79], a[152:155], v[136:139]
  v_mfma_f32_16x16x32_bf16 v[140:143], v[76:79], a[156:159], v[140:143]
  s_waitcnt vmcnt(12) lgkmcnt(0)
  s_barrier
  v_mfma_f32_16x16x32_bf16 v[240:243], a[160:163], a[160:163], v[240:243]
  ds_read_b64_tr_b16 v[64:65], v11 offset:0
  s_add_u32 m0, s67, 139264
  v_mfma_f32_16x16x32_bf16 v[244:247], a[164:167], a[164:167], v[244:247]
  ds_read_b64_tr_b16 v[66:67], v11 offset:4096
  buffer_load_dwordx4 v7, s[16:19], s69 offen lds
  v_mfma_f32_16x16x32_bf16 v[248:251], a[168:171], a[168:171], v[248:251]
  ds_read_b128 a[176:179], v19 offset:32768
  v_mfma_f32_16x16x32_bf16 v[252:255], a[172:175], a[172:175], v[252:255]
  ds_read_b128 a[180:183], v19 offset:33792
  v_mfma_f32_16x16x32_bf16 v[80:83], v[48:51], a[160:163], v[80:83]
  ds_read_b128 a[184:187], v19 offset:34816
  buffer_load_dwordx4 v8, s[16:19], s69 offen offset:1024 lds
  v_mfma_f32_16x16x32_bf16 v[84:87], v[48:51], a[164:167], v[84:87]
  ds_read_b128 a[188:191], v19 offset:35840
  v_mfma_f32_16x16x32_bf16 v[88:91], v[48:51], a[168:171], v[88:91]
  ds_read_b64_tr_b16 v[68:69], v12 offset:0
  s_add_u32 s69, s69, 1024
  v_mfma_f32_16x16x32_bf16 v[92:95], v[48:51], a[172:175], v[92:95]
  ds_read_b64_tr_b16 v[70:71], v12 offset:4096
  s_add_u32 m0, s67, 131072
  v_mfma_f32_16x16x32_bf16 v[96:99], v[52:55], a[160:163], v[96:99]
  ds_read_b64_tr_b16 v[72:73], v11 offset:1024
  buffer_load_dwordx4 v4, s[20:23], s56 offen lds
  v_mfma_f32_16x16x32_bf16 v[100:103], v[52:55], a[164:167], v[100:103]
  ds_read_b64_tr_b16 v[74:75], v11 offset:5120
  v_mfma_f32_16x16x32_bf16 v[104:107], v[52:55], a[168:171], v[104:107]
  ds_read_b64_tr_b16 v[76:77], v12 offset:1024
  v_mfma_f32_16x16x32_bf16 v[108:111], v[52:55], a[172:175], v[108:111]
  ds_read_b64_tr_b16 v[78:79], v12 offset:5120
  buffer_load_dwordx4 v4, s[24:27], s56 offen offset:1024 lds
  v_mfma_f32_16x16x32_bf16 v[112:115], v[56:59], a[160:163], v[112:115]
  v_mfma_f32_16x16x32_bf16 v[116:119], v[56:59], a[164:167], v[116:119]
  v_mfma_f32_16x16x32_bf16 v[120:123], v[56:59], a[168:171], v[120:123]
  v_mfma_f32_16x16x32_bf16 v[124:127], v[56:59], a[172:175], v[124:127]
  v_mfma_f32_16x16x32_bf16 v[128:131], v[60:63], a[160:163], v[128:131]
  v_mfma_f32_16x16x32_bf16 v[132:135], v[60:63], a[164:167], v[132:135]
  v_mfma_f32_16x16x32_bf16 v[136:139], v[60:63], a[168:171], v[136:139]
  v_mfma_f32_16x16x32_bf16 v[140:143], v[60:63], a[172:175], v[140:143]
  s_waitcnt lgkmcnt(0)
  v_mfma_f32_16x16x32_bf16 v[240:243], a[176:179], a[176:179], v[240:243]
  ds_read_b64_tr_b16 v[48:49], v11 offset:49152
  s_add_u32 m0, s67, 106496
  v_mfma_f32_16x16x32_bf16 v[244:247], a[180:183], a[180:183], v[244:247]
  ds_read_b64_tr_b16 v[50:51], v11 offset:53248
  buffer_load_dwordx4 v7, s[16:19], s69 offen lds
  v_mfma_f32_16x16x32_bf16 v[248:251], a[184:187], a[184:187], v[248:251]
  ds_read_b128 a[192:195], v19 offset:57344
  v_mfma_f32_16x16x32_bf16 v[252:255], a[188:191], a[188:191], v[252:255]
  ds_read_b128 a[196:199], v19 offset:58368
  v_mfma_f32_16x16x32_bf16 v[80:83], v[64:67], a[176:179], v[80:83]
  ds_read_b128 a[200:203], v19 offset:59392
  buffer_load_dwordx4 v8, s[16:19], s69 offen offset:1024 lds
  v_mfma_f32_16x16x32_bf16 v[84:87], v[64:67], a[180:183], v[84:87]
  ds_read_b128 a[204:207], v19 offset:60416
  v_mfma_f32_16x16x32_bf16 v[88:91], v[64:67], a[184:187], v[88:91]
  ds_read_b64_tr_b16 v[52:53], v12 offset:49152
  s_add_u32 s69, s69, 1024
  v_mfma_f32_16x16x32_bf16 v[92:95], v[64:67], a[188:191], v[92:95]
  ds_read_b64_tr_b16 v[54:55], v12 offset:53248
  s_add_u32 m0, s67, 73728
  v_mfma_f32_16x16x32_bf16 v[96:99], v[68:71], a[176:179], v[96:99]
  ds_read_b64_tr_b16 v[56:57], v11 offset:50176
  buffer_load_dwordx4 v4, s[20:23], s57 offen lds
  v_mfma_f32_16x16x32_bf16 v[100:103], v[68:71], a[180:183], v[100:103]
  ds_read_b64_tr_b16 v[58:59], v11 offset:54272
  v_mfma_f32_16x16x32_bf16 v[104:107], v[68:71], a[184:187], v[104:107]
  ds_read_b64_tr_b16 v[60:61], v12 offset:50176
  v_mfma_f32_16x16x32_bf16 v[108:111], v[68:71], a[188:191], v[108:111]
  ds_read_b64_tr_b16 v[62:63], v12 offset:54272
  buffer_load_dwordx4 v4, s[24:27], s57 offen offset:1024 lds
  v_mfma_f32_16x16x32_bf16 v[112:115], v[72:75], a[176:179], v[112:115]
  v_mfma_f32_16x16x32_bf16 v[116:119], v[72:75], a[180:183], v[116:119]
  v_mfma_f32_16x16x32_bf16 v[120:123], v[72:75], a[184:187], v[120:123]
  v_mfma_f32_16x16x32_bf16 v[124:127], v[72:75], a[188:191], v[124:127]
  v_mfma_f32_16x16x32_bf16 v[128:131], v[76:79], a[176:179], v[128:131]
  v_mfma_f32_16x16x32_bf16 v[132:135], v[76:79], a[180:183], v[132:135]
  v_mfma_f32_16x16x32_bf16 v[136:139], v[76:79], a[184:187], v[136:139]
  v_mfma_f32_16x16x32_bf16 v[140:143], v[76:79], a[188:191], v[140:143]
  s_waitcnt vmcnt(12) lgkmcnt(0)
  s_barrier
  v_mfma_f32_16x16x32_bf16 v[240:243], a[192:195], a[192:195], v[240:243]
  ds_read_b64_tr_b16 v[64:65], v9 offset:49152
  v_add_u32 v4, 128, v4
  v_mfma_f32_16x16x32_bf16 v[244:247], a[196:199], a[196:199], v[244:247]
  ds_read_b64_tr_b16 v[66:67], v9 offset:53248
  s_add_u32 m0, s67, 122880
  v_mfma_f32_16x16x32_bf16 v[248:251], a[200:203], a[200:203], v[248:251]
  ds_read_b128 a[208:211], v18 offset:57344
  buffer_load_dwordx4 v4, s[20:23], s40 offen lds
  v_mfma_f32_16x16x32_bf16 v[252:255], a[204:207], a[204:207], v[252:255]
  ds_read_b128 a[212:215], v18 offset:58368
  v_mfma_f32_16x16x32_bf16 v[80:83], v[48:51], a[192:195], v[80:83]
  ds_read_b128 a[216:219], v18 offset:59392
  v_mfma_f32_16x16x32_bf16 v[84:87], v[48:51], a[196:199], v[84:87]
  ds_read_b128 a[220:223], v18 offset:60416
  buffer_load_dwordx4 v4, s[24:27], s40 offen offset:1024 lds
  v_mfma_f32_16x16x32_bf16 v[88:91], v[48:51], a[200:203], v[88:91]
  ds_read_b64_tr_b16 v[68:69], v10 offset:49152
  v_mfma_f32_16x16x32_bf16 v[92:95], v[48:51], a[204:207], v[92:95]
  ds_read_b64_tr_b16 v[70:71], v10 offset:53248
  v_mfma_f32_16x16x32_bf16 v[96:99], v[52:55], a[192:195], v[96:99]
  ds_read_b64_tr_b16 v[72:73], v9 offset:50176
  v_mfma_f32_16x16x32_bf16 v[100:103], v[52:55], a[196:199], v[100:103]
  ds_read_b64_tr_b16 v[74:75], v9 offset:54272
  v_mfma_f32_16x16x32_bf16 v[104:107], v[52:55], a[200:203], v[104:107]
  ds_read_b64_tr_b16 v[76:77], v10 offset:50176
  v_mfma_f32_16x16x32_bf16 v[108:111], v[52:55], a[204:207], v[108:111]
  ds_read_b64_tr_b16 v[78:79], v10 offset:54272
  v_mfma_f32_16x16x32_bf16 v[112:115], v[56:59], a[192:195], v[112:115]
  v_mfma_f32_16x16x32_bf16 v[116:119], v[56:59], a[196:199], v[116:119]
  v_mfma_f32_16x16x32_bf16 v[120:123], v[56:59], a[200:203], v[120:123]
  v_mfma_f32_16x16x32_bf16 v[124:127], v[56:59], a[204:207], v[124:127]
  v_mfma_f32_16x16x32_bf16 v[128:131], v[60:63], a[192:195], v[128:131]
  v_mfma_f32_16x16x32_bf16 v[132:135], v[60:63], a[196:199], v[132:135]
  v_mfma_f32_16x16x32_bf16 v[136:139], v[60:63], a[200:203], v[136:139]
  v_mfma_f32_16x16x32_bf16 v[140:143], v[60:63], a[204:207], v[140:143]
  s_waitcnt lgkmcnt(0)
  v_mfma_f32_16x16x32_bf16 v[240:243], a[208:211], a[208:211], v[240:243]
  ds_read_b64_tr_b16 v[48:49], v13 offset:16384
  s_add_u32 m0, s67, 114688
  v_mfma_f32_16x16x32_bf16 v[244:247], a[212:215], a[212:215], v[244:247]
  ds_read_b64_tr_b16 v[50:51], v13 offset:20480
  buffer_load_dwordx4 v4, s[20:23], s41 offen lds
  v_mfma_f32_16x16x32_bf16 v[248:251], a[216:219], a[216:219], v[248:251]
  ds_read_b128 a[224:227], v20 offset:24576
  v_mfma_f32_16x16x32_bf16 v[252:255], a[220:223], a[220:223], v[252:255]
  ds_read_b128 a[228:231], v20 offset:25600
  v_mfma_f32_16x16x32_bf16 v[80:83], v[64:67], a[208:211], v[80:83]
  ds_read_b128 a[232:235], v20 offset:26624
  buffer_load_dwordx4 v4, s[24:27], s41 offen offset:1024 lds
  v_mfma_f32_16x16x32_bf16 v[84:87], v[64:67], a[212:215], v[84:87]
  ds_read_b128 a[236:239], v20 offset:27648
  v_mfma_f32_16x16x32_bf16 v[88:91], v[64:67], a[216:219], v[88:91]
  ds_read_b64_tr_b16 v[52:53], v14 offset:16384
  v_mfma_f32_16x16x32_bf16 v[92:95], v[64:67], a[220:223], v[92:95]
  ds_read_b64_tr_b16 v[54:55], v14 offset:20480
  v_mfma_f32_16x16x32_bf16 v[96:99], v[68:71], a[208:211], v[96:99]
  ds_read_b64_tr_b16 v[56:57], v13 offset:17408
  v_mfma_f32_16x16x32_bf16 v[100:103], v[68:71], a[212:215], v[100:103]
  ds_read_b64_tr_b16 v[58:59], v13 offset:21504
  v_mfma_f32_16x16x32_bf16 v[104:107], v[68:71], a[216:219], v[104:107]
  ds_read_b64_tr_b16 v[60:61], v14 offset:17408
  v_mfma_f32_16x16x32_bf16 v[108:111], v[68:71], a[220:223], v[108:111]
  ds_read_b64_tr_b16 v[62:63], v14 offset:21504
  v_mfma_f32_16x16x32_bf16 v[112:115], v[72:75], a[208:211], v[112:115]
  v_mfma_f32_16x16x32_bf16 v[116:119], v[72:75], a[212:215], v[116:119]
  v_mfma_f32_16x16x32_bf16 v[120:123], v[72:75], a[216:219], v[120:123]
  v_mfma_f32_16x16x32_bf16 v[124:127], v[72:75], a[220:223], v[124:127]
  v_mfma_f32_16x16x32_bf16 v[128:131], v[76:79], a[208:211], v[128:131]
  v_mfma_f32_16x16x32_bf16 v[132:135], v[76:79], a[212:215], v[132:135]
  v_mfma_f32_16x16x32_bf16 v[136:139], v[76:79], a[216:219], v[136:139]
  v_mfma_f32_16x16x32_bf16 v[140:143], v[76:79], a[220:223], v[140:143]
  s_waitcnt vmcnt(8) lgkmcnt(0)
  s_barrier
  v_mfma_f32_16x16x32_bf16 v[240:243], a[224:227], a[224:227], v[240:243]
  ds_read_b64_tr_b16 v[64:65], v11 offset:16384
  s_add_u32 m0, s67, 155648
  v_mfma_f32_16x16x32_bf16 v[244:247], a[228:231], a[228:231], v[244:247]
  ds_read_b64_tr_b16 v[66:67], v11 offset:20480
  buffer_load_dwordx4 v4, s[20:23], s42 offen lds
  v_mfma_f32_16x16x32_bf16 v[248:251], a[232:235], a[232:235], v[248:251]
  ds_read_b128 a[240:243], v19 offset:24576
  v_mfma_f32_16x16x32_bf16 v[252:255], a[236:239], a[236:239], v[252:255]
  ds_read_b128 a[244:247], v19 offset:25600
  v_mfma_f32_16x16x32_bf16 v[80:83], v[48:51], a[224:227], v[80:83]
  ds_read_b128 a[248:251], v19 offset:26624
  buffer_load_dwordx4 v4, s[24:27], s42 offen offset:1024 lds
  v_mfma_f32_16x16x32_bf16 v[84:87], v[48:51], a[228:231], v[84:87]
  ds_read_b128 a[252:255], v19 offset:27648
  v_mfma_f32_16x16x32_bf16 v[88:91], v[48:51], a[232:235], v[88:91]
  ds_read_b64_tr_b16 v[68:69], v12 offset:16384
  v_mfma_f32_16x16x32_bf16 v[92:95], v[48:51], a[236:239], v[92:95]
  ds_read_b64_tr_b16 v[70:71], v12 offset:20480
  v_mfma_f32_16x16x32_bf16 v[96:99], v[52:55], a[224:227], v[96:99]
  ds_read_b64_tr_b16 v[72:73], v11 offset:17408
  v_mfma_f32_16x16x32_bf16 v[100:103], v[52:55], a[228:231], v[100:103]
  ds_read_b64_tr_b16 v[74:75], v11 offset:21504
  v_mfma_f32_16x16x32_bf16 v[104:107], v[52:55], a[232:235], v[104:107]
  ds_read_b64_tr_b16 v[76:77], v12 offset:17408
  v_mfma_f32_16x16x32_bf16 v[108:111], v[52:55], a[236:239], v[108:111]
  ds_read_b64_tr_b16 v[78:79], v12 offset:21504
  v_mfma_f32_16x16x32_bf16 v[112:115], v[56:59], a[224:227], v[112:115]
  v_mfma_f32_16x16x32_bf16 v[116:119], v[56:59], a[228:231], v[116:119]
  v_mfma_f32_16x16x32_bf16 v[120:123], v[56:59], a[232:235], v[120:123]
  v_mfma_f32_16x16x32_bf16 v[124:127], v[56:59], a[236:239], v[124:127]
  v_mfma_f32_16x16x32_bf16 v[128:131], v[60:63], a[224:227], v[128:131]
  v_mfma_f32_16x16x32_bf16 v[132:135], v[60:63], a[228:231], v[132:135]
  v_mfma_f32_16x16x32_bf16 v[136:139], v[60:63], a[232:235], v[136:139]
  v_mfma_f32_16x16x32_bf16 v[140:143], v[60:63], a[236:239], v[140:143]
  s_waitcnt lgkmcnt(0)
  v_mfma_f32_16x16x32_bf16 v[240:243], a[240:243], a[240:243], v[240:243]
  ds_read_b64_tr_b16 v[48:49], v13 offset:0
  s_add_u32 m0, s67, 147456
  v_mfma_f32_16x16x32_bf16 v[244:247], a[244:247], a[244:247], v[244:247]
  ds_read_b64_tr_b16 v[50:51], v13 offset:4096
  buffer_load_dwordx4 v4, s[20:23], s43 offen lds
  v_mfma_f32_16x16x32_bf16 v[248:251], a[248:251], a[248:251], v[248:251]
  ds_read_b128 v[208:211], v20 offset:8192
  v_mfma_f32_16x16x32_bf16 v[252:255], a[252:255], a[252:255], v[252:255]
  ds_read_b128 v[212:215], v20 offset:9216
  v_mfma_f32_16x16x32_bf16 v[80:83], v[64:67], a[240:243], v[80:83]
  ds_read_b128 v[216:219], v20 offset:10240
  buffer_load_dwordx4 v4, s[24:27], s43 offen offset:1024 lds
  v_mfma_f32_16x16x32_bf16 v[84:87], v[64:67], a[244:247], v[84:87]
  ds_read_b128 v[220:223], v20 offset:11264
  v_mfma_f32_16x16x32_bf16 v[88:91], v[64:67], a[248:251], v[88:91]
  ds_read_b64_tr_b16 v[52:53], v14 offset:0
  v_mfma_f32_16x16x32_bf16 v[92:95], v[64:67], a[252:255], v[92:95]
  ds_read_b64_tr_b16 v[54:55], v14 offset:4096
  v_mfma_f32_16x16x32_bf16 v[96:99], v[68:71], a[240:243], v[96:99]
  ds_read_b64_tr_b16 v[56:57], v13 offset:1024
  v_mfma_f32_16x16x32_bf16 v[100:103], v[68:71], a[244:247], v[100:103]
  ds_read_b64_tr_b16 v[58:59], v13 offset:5120
  v_mfma_f32_16x16x32_bf16 v[104:107], v[68:71], a[248:251], v[104:107]
  ds_read_b64_tr_b16 v[60:61], v14 offset:1024
  v_mfma_f32_16x16x32_bf16 v[108:111], v[68:71], a[252:255], v[108:111]
  ds_read_b64_tr_b16 v[62:63], v14 offset:5120
  v_mfma_f32_16x16x32_bf16 v[112:115], v[72:75], a[240:243], v[112:115]
  v_mfma_f32_16x16x32_bf16 v[116:119], v[72:75], a[244:247], v[116:119]
  v_mfma_f32_16x16x32_bf16 v[120:123], v[72:75], a[248:251], v[120:123]
  v_mfma_f32_16x16x32_bf16 v[124:127], v[72:75], a[252:255], v[124:127]
  v_mfma_f32_16x16x32_bf16 v[128:131], v[76:79], a[240:243], v[128:131]
  v_mfma_f32_16x16x32_bf16 v[132:135], v[76:79], a[244:247], v[132:135]
  v_mfma_f32_16x16x32_bf16 v[136:139], v[76:79], a[248:251], v[136:139]
  v_mfma_f32_16x16x32_bf16 v[140:143], v[76:79], a[252:255], v[140:143]
  s_waitcnt vmcnt(6) lgkmcnt(0)
  s_barrier
  v_mfma_f32_16x16x32_bf16 v[240:243], v[208:211], v[208:211], v[240:243]
  ds_read_b64_tr_b16 v[64:65], v11 offset:8192
  s_add_u32 m0, s67, 139264
  v_mfma_f32_16x16x32_bf16 v[244:247], v[212:215], v[212:215], v[244:247]
  ds_read_b64_tr_b16 v[66:67], v11 offset:12288
  buffer_load_dwordx4 v4, s[20:23], s44 offen lds
  v_mfma_f32_16x16x32_bf16 v[248:251], v[216:219], v[216:219], v[248:251]
  ds_read_b128 v[224:227], v19 offset:40960
  v_mfma_f32_16x16x32_bf16 v[252:255], v[220:223], v[220:223], v[252:255]
  ds_read_b128 v[228:231], v19 offset:41984
  v_mfma_f32_16x16x32_bf16 v[80:83], v[48:51], v[208:211], v[80:83]
  ds_read_b128 v[232:235], v19 offset:43008
  buffer_load_dwordx4 v4, s[24:27], s44 offen offset:1024 lds
  v_mfma_f32_16x16x32_bf16 v[84:87], v[48:51], v[212:215], v[84:87]
  ds_read_b128 v[236:239], v19 offset:44032
  v_mfma_f32_16x16x32_bf16 v[88:91], v[48:51], v[216:219], v[88:91]
  ds_read_b64_tr_b16 v[68:69], v12 offset:8192
  v_mfma_f32_16x16x32_bf16 v[92:95], v[48:51], v[220:223], v[92:95]
  ds_read_b64_tr_b16 v[70:71], v12 offset:12288
  v_mfma_f32_16x16x32_bf16 v[96:99], v[52:55], v[208:211], v[96:99]
  ds_read_b64_tr_b16 v[72:73], v11 offset:9216
  v_mfma_f32_16x16x32_bf16 v[100:103], v[52:55], v[212:215], v[100:103]
  ds_read_b64_tr_b16 v[74:75], v11 offset:13312
  v_mfma_f32_16x16x32_bf16 v[104:107], v[52:55], v[216:219], v[104:107]
  ds_read_b64_tr_b16 v[76:77], v12 offset:9216
  v_mfma_f32_16x16x32_bf16 v[108:111], v[52:55], v[220:223], v[108:111]
  ds_read_b64_tr_b16 v[78:79], v12 offset:13312
  v_mfma_f32_16x16x32_bf16 v[112:115], v[56:59], v[208:211], v[112:115]
  v_mfma_f32_16x16x32_bf16 v[116:119], v[56:59], v[212:215], v[116:119]
  v_mfma_f32_16x16x32_bf16 v[120:123], v[56:59], v[216:219], v[120:123]
  v_mfma_f32_16x16x32_bf16 v[124:127], v[56:59], v[220:223], v[124:127]
  v_mfma_f32_16x16x32_bf16 v[128:131], v[60:63], v[208:211], v[128:131]
  v_mfma_f32_16x16x32_bf16 v[132:135], v[60:63], v[212:215], v[132:135]
  v_mfma_f32_16x16x32_bf16 v[136:139], v[60:63], v[216:219], v[136:139]
  v_mfma_f32_16x16x32_bf16 v[140:143], v[60:63], v[220:223], v[140:143]
  s_waitcnt lgkmcnt(0)
  v_mfma_f32_16x16x32_bf16 v[240:243], v[224:227], v[224:227], v[240:243]
  ds_read_b64_tr_b16 v[48:49], v11 offset:57344
  s_add_u32 m0, s67, 131072
  v_mfma_f32_16x16x32_bf16 v[244:247], v[228:231], v[228:231], v[244:247]
  ds_read_b64_tr_b16 v[50:51], v11 offset:61440
  buffer_load_dwordx4 v4, s[20:23], s45 offen lds
  v_mfma_f32_16x16x32_bf16 v[248:251], v[232:235], v[232:235], v[248:251]
  ds_read_b64_tr_b16 v[52:53], v12 offset:57344
  v_mfma_f32_16x16x32_bf16 v[252:255], v[236:239], v[236:239], v[252:255]
  ds_read_b64_tr_b16 v[54:55], v12 offset:61440
  v_mfma_f32_16x16x32_bf16 v[80:83], v[64:67], v[224:227], v[80:83]
  ds_read_b64_tr_b16 v[56:57], v11 offset:58368
  buffer_load_dwordx4 v4, s[24:27], s45 offen offset:1024 lds
  v_mfma_f32_16x16x32_bf16 v[84:87], v[64:67], v[228:231], v[84:87]
  ds_read_b64_tr_b16 v[58:59], v11 offset:62464
  v_mfma_f32_16x16x32_bf16 v[88:91], v[64:67], v[232:235], v[88:91]
  ds_read_b64_tr_b16 v[60:61], v12 offset:58368
  v_mfma_f32_16x16x32_bf16 v[92:95], v[64:67], v[236:239], v[92:95]
  ds_read_b64_tr_b16 v[62:63], v12 offset:62464
  v_cndmask_b32_e64 v240, v240, v241, s[76:77]
  v_mfma_f32_16x16x32_bf16 v[96:99], v[68:71], v[224:227], v[96:99]
  v_cndmask_b32_e64 v242, v242, v243, s[76:77]
  v_cndmask_b32_e64 v240, v240, v242, s[78:79]
  v_mfma_f32_16x16x32_bf16 v[100:103], v[68:71], v[228:231], v[100:103]
  v_cndmask_b32_e64 v31, 0, v240, s[80:81]
  v_mov_b32 v240, v31
  v_mfma_f32_16x16x32_bf16 v[104:107], v[68:71], v[232:235], v[104:107]
  s_nop 0
  v_permlane32_swap_b32 v31, v240
  v_add_f32 v31, v31, v240
  v_mfma_f32_16x16x32_bf16 v[108:111], v[68:71], v[236:239], v[108:111]
  v_mov_b32 v240, v31
  s_nop 1
  v_permlane16_swap_b32 v31, v240
  v_mfma_f32_16x16x32_bf16 v[112:115], v[72:75], v[224:227], v[112:115]
  v_add_f32 v31, v31, v240
  v_mul_f32 v31, 0x3ae38e39, v31
  v_mfma_f32_16x16x32_bf16 v[116:119], v[72:75], v[228:231], v[116:119]
  v_cvt_pk_bf16_f32 v31, v31, v31
  v_lshlrev_b32 v31, 16, v31
  v_mfma_f32_16x16x32_bf16 v[120:123], v[72:75], v[232:235], v[120:123]
  v_add_f32 v31, 0x3727c5ac, v31
  v_cvt_pk_bf16_f32 v31, v31, v31
  v_mfma_f32_16x16x32_bf16 v[124:127], v[72:75], v[236:239], v[124:127]
  v_lshlrev_b32 v31, 16, v31
  v_cndmask_b32_e64 v244, v244, v245, s[76:77]
  v_mfma_f32_16x16x32_bf16 v[128:131], v[76:79], v[224:227], v[128:131]
  v_sqrt_f32 v31, v31
  v_mfma_f32_16x16x32_bf16 v[132:135], v[76:79], v[228:231], v[132:135]
  v_cvt_pk_bf16_f32 v31, v31, v31
  v_lshlrev_b32 v31, 16, v31
  v_mfma_f32_16x16x32_bf16 v[136:139], v[76:79], v[232:235], v[136:139]
  v_rcp_f32 v27, v31
  v_mfma_f32_16x16x32_bf16 v[140:143], v[76:79], v[236:239], v[140:143]
  s_waitcnt vmcnt(4) lgkmcnt(0)
  s_barrier
  v_mfma_f32_16x16x32_bf16 v[144:147], v[48:51], a[0:3], 0
  ds_read_b64_tr_b16 v[64:65], v11 offset:49152
  s_add_u32 m0, s67, 122880
  v_mfma_f32_16x16x32_bf16 v[148:151], v[48:51], a[4:7], 0
  ds_read_b64_tr_b16 v[66:67], v11 offset:53248
  buffer_load_dwordx4 v4, s[20:23], s46 offen lds
  v_mfma_f32_16x16x32_bf16 v[152:155], v[48:51], a[8:11], 0
  ds_read_b64_tr_b16 v[68:69], v12 offset:49152
  v_mul_f32 v31, v31, v31
  v_mfma_f32_16x16x32_bf16 v[156:159], v[48:51], a[12:15], 0
  ds_read_b64_tr_b16 v[70:71], v12 offset:53248
  v_mul_f32 v27, 3216550459, v27
  v_mfma_f32_16x16x32_bf16 v[160:163], v[52:55], a[0:3], 0
  ds_read_b64_tr_b16 v[72:73], v11 offset:50176
  v_cndmask_b32_e64 v246, v246, v247, s[76:77]
  v_mfma_f32_16x16x32_bf16 v[164:167], v[52:55], a[4:7], 0
  ds_read_b64_tr_b16 v[74:75], v11 offset:54272
  v_cndmask_b32_e64 v244, v244, v246, s[78:79]
  v_mfma_f32_16x16x32_bf16 v[168:171], v[52:55], a[8:11], 0
  ds_read_b64_tr_b16 v[76:77], v12 offset:50176
  buffer_load_dwordx4 v4, s[24:27], s46 offen offset:1024 lds
  v_mfma_f32_16x16x32_bf16 v[172:175], v[52:55], a[12:15], 0
  ds_read_b64_tr_b16 v[78:79], v12 offset:54272
  v_cndmask_b32_e64 v32, 0, v244, s[80:81]
  v_mfma_f32_16x16x32_bf16 v[176:179], v[56:59], a[0:3], 0
  v_mov_b32 v244, v32
  s_nop 1
  v_permlane32_swap_b32 v32, v244
  v_mfma_f32_16x16x32_bf16 v[180:183], v[56:59], a[4:7], 0
  v_add_f32 v32, v32, v244
  v_mov_b32 v244, v32
  v_mfma_f32_16x16x32_bf16 v[184:187], v[56:59], a[8:11], 0
  s_add_u32 m0, s67, 106496
  v_permlane16_swap_b32 v32, v244
  v_mfma_f32_16x16x32_bf16 v[188:191], v[56:59], a[12:15], 0
  buffer_load_dwordx4 v4, s[20:23], s47 offen lds
  v_add_f32 v32, v32, v244
  v_mfma_f32_16x16x32_bf16 v[192:195], v[60:63], a[0:3], 0
  v_mul_f32 v32, 0x3ae38e39, v32
  v_cvt_pk_bf16_f32 v32, v32, v32
  v_mfma_f32_16x16x32_bf16 v[196:199], v[60:63], a[4:7], 0
  v_lshlrev_b32 v32, 16, v32
  v_add_f32 v32, 0x3727c5ac, v32
  v_mfma_f32_16x16x32_bf16 v[200:203], v[60:63], a[8:11], 0
  v_cvt_pk_bf16_f32 v32, v32, v32
  v_lshlrev_b32 v32, 16, v32
  v_mfma_f32_16x16x32_bf16 v[204:207], v[60:63], a[12:15], 0
  v_cndmask_b32_e64 v248, v248, v249, s[76:77]
  s_waitcnt lgkmcnt(0)
  v_mfma_f32_16x16x32_bf16 v[144:147], v[64:67], a[16:19], v[144:147]
  ds_read_b64_tr_b16 v[48:49], v13 offset:24576
  buffer_load_dwordx4 v4, s[24:27], s47 offen offset:1024 lds
  v_mfma_f32_16x16x32_bf16 v[148:151], v[64:67], a[20:23], v[148:151]
  ds_read_b64_tr_b16 v[50:51], v13 offset:28672
  v_cndmask_b32_e64 v250, v250, v251, s[76:77]
  v_mfma_f32_16x16x32_bf16 v[152:155], v[64:67], a[24:27], v[152:155]
  ds_read_b64_tr_b16 v[52:53], v14 offset:24576
  v_cndmask_b32_e64 v248, v248, v250, s[78:79]
  v_mfma_f32_16x16x32_bf16 v[156:159], v[64:67], a[28:31], v[156:159]
  ds_read_b64_tr_b16 v[54:55], v14 offset:28672
  v_cndmask_b32_e64 v33, 0, v248, s[80:81]
  v_mfma_f32_16x16x32_bf16 v[160:163], v[68:71], a[16:19], v[160:163]
  ds_read_b64_tr_b16 v[56:57], v13 offset:25600
  s_add_u32 m0, s67, 81920
  v_mfma_f32_16x16x32_bf16 v[164:167], v[68:71], a[20:23], v[164:167]
  ds_read_b64_tr_b16 v[58:59], v13 offset:29696
  buffer_load_dwordx4 v4, s[20:23], s48 offen lds
  v_mfma_f32_16x16x32_bf16 v[168:171], v[68:71], a[24:27], v[168:171]
  ds_read_b64_tr_b16 v[60:61], v14 offset:25600
  v_mov_b32 v248, v33
  v_mfma_f32_16x16x32_bf16 v[172:175], v[68:71], a[28:31], v[172:175]
  ds_read_b64_tr_b16 v[62:63], v14 offset:29696
  v_permlane32_swap_b32 v33, v248
  v_mfma_f32_16x16x32_bf16 v[176:179], v[72:75], a[16:19], v[176:179]
  v_sqrt_f32 v32, v32
  v_mfma_f32_16x16x32_bf16 v[180:183], v[72:75], a[20:23], v[180:183]
  v_cvt_pk_bf16_f32 v32, v32, v32
  v_lshlrev_b32 v32, 16, v32
  v_mfma_f32_16x16x32_bf16 v[184:187], v[72:75], a[24:27], v[184:187]
  buffer_load_dwordx4 v4, s[24:27], s48 offen offset:1024 lds
  v_add_f32 v33, v33, v248
  v_mfma_f32_16x16x32_bf16 v[188:191], v[72:75], a[28:31], v[188:191]
  v_rcp_f32 v28, v32
  v_mfma_f32_16x16x32_bf16 v[192:195], v[76:79], a[16:19], v[192:195]
  v_mul_f32 v32, v32, v32
  v_mul_f32 v28, 3216550459, v28
  v_mfma_f32_16x16x32_bf16 v[196:199], v[76:79], a[20:23], v[196:199]
  v_mov_b32 v248, v33
  s_nop 1
  v_permlane16_swap_b32 v33, v248
  v_mfma_f32_16x16x32_bf16 v[200:203], v[76:79], a[24:27], v[200:203]
  v_add_f32 v33, v33, v248
  v_mul_f32 v33, 0x3ae38e39, v33
  v_mfma_f32_16x16x32_bf16 v[204:207], v[76:79], a[28:31], v[204:207]
  v_cvt_pk_bf16_f32 v33, v33, v33
  s_waitcnt lgkmcnt(0)
  v_mfma_f32_16x16x32_bf16 v[144:147], v[48:51], a[32:35], v[144:147]
  ds_read_b64_tr_b16 v[64:65], v13 offset:16384
  s_add_u32 m0, s67, 73728
  v_mfma_f32_16x16x32_bf16 v[148:151], v[48:51], a[36:39], v[148:151]
  ds_read_b64_tr_b16 v[66:67], v13 offset:20480
  buffer_load_dwordx4 v4, s[20:23], s49 offen lds
  v_mfma_f32_16x16x32_bf16 v[152:155], v[48:51], a[40:43], v[152:155]
  ds_read_b64_tr_b16 v[68:69], v14 offset:16384
  v_lshlrev_b32 v33, 16, v33
  v_mfma_f32_16x16x32_bf16 v[156:159], v[48:51], a[44:47], v[156:159]
  ds_read_b64_tr_b16 v[70:71], v14 offset:20480
  v_add_f32 v33, 0x3727c5ac, v33
  v_mfma_f32_16x16x32_bf16 v[160:163], v[52:55], a[32:35], v[160:163]
  ds_read_b64_tr_b16 v[72:73], v13 offset:17408
  v_cvt_pk_bf16_f32 v33, v33, v33
  v_mfma_f32_16x16x32_bf16 v[164:167], v[52:55], a[36:39], v[164:167]
  ds_read_b64_tr_b16 v[74:75], v13 offset:21504
  v_lshlrev_b32 v33, 16, v33
  v_mfma_f32_16x16x32_bf16 v[168:171], v[52:55], a[40:43], v[168:171]
  ds_read_b64_tr_b16 v[76:77], v14 offset:17408
  buffer_load_dwordx4 v4, s[24:27], s49 offen offset:1024 lds
  v_mfma_f32_16x16x32_bf16 v[172:175], v[52:55], a[44:47], v[172:175]
  ds_read_b64_tr_b16 v[78:79], v14 offset:21504
  v_cndmask_b32_e64 v252, v252, v253, s[76:77]
  v_mfma_f32_16x16x32_bf16 v[176:179], v[56:59], a[32:35], v[176:179]
  v_sqrt_f32 v33, v33
  v_mfma_f32_16x16x32_bf16 v[180:183], v[56:59], a[36:39], v[180:183]
  v_cvt_pk_bf16_f32 v33, v33, v33
  v_lshlrev_b32 v33, 16, v33
  v_mfma_f32_16x16x32_bf16 v[184:187], v[56:59], a[40:43], v[184:187]
  s_add_u32 m0, s67, 65536
  v_cndmask_b32_e64 v254, v254, v255, s[76:77]
  v_mfma_f32_16x16x32_bf16 v[188:191], v[56:59], a[44:47], v[188:191]
  buffer_load_dwordx4 v4, s[20:23], s50 offen lds
  v_cndmask_b32_e64 v252, v252, v254, s[78:79]
  v_mfma_f32_16x16x32_bf16 v[192:195], v[60:63], a[32:35], v[192:195]
  v_rcp_f32 v29, v33
  v_mfma_f32_16x16x32_bf16 v[196:199], v[60:63], a[36:39], v[196:199]
  v_mul_f32 v33, v33, v33
  v_mul_f32 v29, 3216550459, v29
  v_mfma_f32_16x16x32_bf16 v[200:203], v[60:63], a[40:43], v[200:203]
  v_cndmask_b32_e64 v34, 0, v252, s[80:81]
  v_mov_b32 v252, v34
  v_mfma_f32_16x16x32_bf16 v[204:207], v[60:63], a[44:47], v[204:207]
  s_waitcnt vmcnt(7) lgkmcnt(0)
  s_barrier
  v_mfma_f32_16x16x32_bf16 v[144:147], v[64:67], a[48:51], v[144:147]
  ds_read_b64_tr_b16 v[48:49], v13 offset:8192
  buffer_load_dwordx4 v4, s[24:27], s50 offen offset:1024 lds
  v_mfma_f32_16x16x32_bf16 v[148:151], v[64:67], a[52:55], v[148:151]
  ds_read_b64_tr_b16 v[50:51], v13 offset:12288
  v_permlane32_swap_b32 v34, v252
  v_mfma_f32_16x16x32_bf16 v[152:155], v[64:67], a[56:59], v[152:155]
  ds_read_b64_tr_b16 v[52:53], v14 offset:8192
  v_add_f32 v34, v34, v252
  v_mfma_f32_16x16x32_bf16 v[156:159], v[64:67], a[60:63], v[156:159]
  ds_read_b64_tr_b16 v[54:55], v14 offset:12288
  v_mov_b32 v252, v34
  v_mfma_f32_16x16x32_bf16 v[160:163], v[68:71], a[48:51], v[160:163]
  ds_read_b64_tr_b16 v[56:57], v13 offset:9216
  s_add_u32 m0, s67, 155648
  v_mfma_f32_16x16x32_bf16 v[164:167], v[68:71], a[52:55], v[164:167]
  ds_read_b64_tr_b16 v[58:59], v13 offset:13312
  buffer_load_dwordx4 v4, s[20:23], s51 offen lds
  v_mfma_f32_16x16x32_bf16 v[168:171], v[68:71], a[56:59], v[168:171]
  ds_read_b64_tr_b16 v[60:61], v14 offset:9216
  v_permlane16_swap_b32 v34, v252
  v_mfma_f32_16x16x32_bf16 v[172:175], v[68:71], a[60:63], v[172:175]
  ds_read_b64_tr_b16 v[62:63], v14 offset:13312
  v_add_f32 v34, v34, v252
  v_mfma_f32_16x16x32_bf16 v[176:179], v[72:75], a[48:51], v[176:179]
  v_mul_f32 v34, 0x3ae38e39, v34
  v_cvt_pk_bf16_f32 v34, v34, v34
  v_mfma_f32_16x16x32_bf16 v[180:183], v[72:75], a[52:55], v[180:183]
  v_lshlrev_b32 v34, 16, v34
  v_add_f32 v34, 0x3727c5ac, v34
  v_mfma_f32_16x16x32_bf16 v[184:187], v[72:75], a[56:59], v[184:187]
  buffer_load_dwordx4 v4, s[24:27], s51 offen offset:1024 lds
  v_cvt_pk_bf16_f32 v34, v34, v34
  v_mfma_f32_16x16x32_bf16 v[188:191], v[72:75], a[60:63], v[188:191]
  v_lshlrev_b32 v34, 16, v34
  v_mul_f32 v112, v80, v112
  v_mfma_f32_16x16x32_bf16 v[192:195], v[76:79], a[48:51], v[192:195]
  v_sqrt_f32 v34, v34
  v_mfma_f32_16x16x32_bf16 v[196:199], v[76:79], a[52:55], v[196:199]
  v_cvt_pk_bf16_f32 v34, v34, v34
  v_lshlrev_b32 v34, 16, v34
  v_mfma_f32_16x16x32_bf16 v[200:203], v[76:79], a[56:59], v[200:203]
  v_rcp_f32 v30, v34
  v_mfma_f32_16x16x32_bf16 v[204:207], v[76:79], a[60:63], v[204:207]
  v_mul_f32 v34, v34, v34
  s_waitcnt lgkmcnt(0)
  v_mfma_f32_16x16x32_bf16 v[144:147], v[48:51], a[64:67], v[144:147]
  ds_read_b64_tr_b16 v[64:65], v13 offset:0
  s_add_u32 m0, s67, 147456
  v_mfma_f32_16x16x32_bf16 v[148:151], v[48:51], a[68:71], v[148:151]
  ds_read_b64_tr_b16 v[66:67], v13 offset:4096
  buffer_load_dwordx4 v4, s[20:23], s52 offen lds
  v_mfma_f32_16x16x32_bf16 v[152:155], v[48:51], a[72:75], v[152:155]
  ds_read_b64_tr_b16 v[68:69], v14 offset:0
  v_mul_f32 v30, 3216550459, v30
  v_mfma_f32_16x16x32_bf16 v[156:159], v[48:51], a[76:79], v[156:159]
  ds_read_b64_tr_b16 v[70:71], v14 offset:4096
  v_mul_f32 v80, v80, v27
  v_mfma_f32_16x16x32_bf16 v[160:163], v[52:55], a[64:67], v[160:163]
  ds_read_b64_tr_b16 v[72:73], v13 offset:1024
  v_mul_f32 v113, v81, v113
  v_mfma_f32_16x16x32_bf16 v[164:167], v[52:55], a[68:71], v[164:167]
  ds_read_b64_tr_b16 v[74:75], v13 offset:5120
  v_mul_f32 v81, v81, v27
  v_mfma_f32_16x16x32_bf16 v[168:171], v[52:55], a[72:75], v[168:171]
  ds_read_b64_tr_b16 v[76:77], v14 offset:1024
  buffer_load_dwordx4 v4, s[24:27], s52 offen offset:1024 lds
  v_mfma_f32_16x16x32_bf16 v[172:175], v[52:55], a[76:79], v[172:175]
  ds_read_b64_tr_b16 v[78:79], v14 offset:5120
  v_mul_f32 v114, v82, v114
  v_mfma_f32_16x16x32_bf16 v[176:179], v[56:59], a[64:67], v[176:179]
  v_mul_f32 v82, v82, v27
  v_mul_f32 v115, v83, v115
  v_mfma_f32_16x16x32_bf16 v[180:183], v[56:59], a[68:71], v[180:183]
  v_mul_f32 v83, v83, v27
  v_mul_f32 v128, v96, v128
  v_mfma_f32_16x16x32_bf16 v[184:187], v[56:59], a[72:75], v[184:187]
  s_add_u32 m0, s67, 114688
  v_mul_f32 v96, v96, v27
  v_mfma_f32_16x16x32_bf16 v[188:191], v[56:59], a[76:79], v[188:191]
  buffer_load_dwordx4 v4, s[20:23], s53 offen lds
  v_mul_f32 v129, v97, v129
  v_mfma_f32_16x16x32_bf16 v[192:195], v[60:63], a[64:67], v[192:195]
  v_exp_f32 v80, v80
  v_mfma_f32_16x16x32_bf16 v[196:199], v[60:63], a[68:71], v[196:199]
  v_exp_f32 v81, v81
  v_mfma_f32_16x16x32_bf16 v[200:203], v[60:63], a[72:75], v[200:203]
  v_exp_f32 v82, v82
  v_mfma_f32_16x16x32_bf16 v[204:207], v[60:63], a[76:79], v[204:207]
  v_fma_f32 v80, v80, v31, v31
  s_waitcnt lgkmcnt(0)
  v_mfma_f32_16x16x32_bf16 v[144:147], v[64:67], a[80:83], v[144:147]
  ds_read_b64_tr_b16 v[48:49], v11 offset:57344
  buffer_load_dwordx4 v4, s[24:27], s53 offen offset:1024 lds
  v_mfma_f32_16x16x32_bf16 v[148:151], v[64:67], a[84:87], v[148:151]
  ds_read_b64_tr_b16 v[50:51], v11 offset:61440
  v_fma_f32 v81, v81, v31, v31
  v_mfma_f32_16x16x32_bf16 v[152:155], v[64:67], a[88:91], v[152:155]
  ds_read_b64_tr_b16 v[52:53], v12 offset:57344
  v_fma_f32 v82, v82, v31, v31
  v_mfma_f32_16x16x32_bf16 v[156:159], v[64:67], a[92:95], v[156:159]
  ds_read_b64_tr_b16 v[54:55], v12 offset:61440
  v_mul_f32 v97, v97, v27
  v_mfma_f32_16x16x32_bf16 v[160:163], v[68:71], a[80:83], v[160:163]
  ds_read_b64_tr_b16 v[56:57], v11 offset:58368
  s_add_u32 m0, s67, 57344
  v_mfma_f32_16x16x32_bf16 v[164:167], v[68:71], a[84:87], v[164:167]
  ds_read_b64_tr_b16 v[58:59], v11 offset:62464
  buffer_load_dwordx4 v4, s[20:23], s54 offen lds
  v_mfma_f32_16x16x32_bf16 v[168:171], v[68:71], a[88:91], v[168:171]
  ds_read_b64_tr_b16 v[60:61], v12 offset:58368
  v_mul_f32 v130, v98, v130
  v_mfma_f32_16x16x32_bf16 v[172:175], v[68:71], a[92:95], v[172:175]
  ds_read_b64_tr_b16 v[62:63], v12 offset:62464
  v_mul_f32 v98, v98, v27
  v_mfma_f32_16x16x32_bf16 v[176:179], v[72:75], a[80:83], v[176:179]
  v_exp_f32 v83, v83
  v_mfma_f32_16x16x32_bf16 v[180:183], v[72:75], a[84:87], v[180:183]
  v_fma_f32 v83, v83, v31, v31
  v_mul_f32 v131, v99, v131
  v_mfma_f32_16x16x32_bf16 v[184:187], v[72:75], a[88:91], v[184:187]
  buffer_load_dwordx4 v4, s[24:27], s54 offen offset:1024 lds
  v_mul_f32 v99, v99, v27
  v_mfma_f32_16x16x32_bf16 v[188:191], v[72:75], a[92:95], v[188:191]
  v_rcp_f32 v80, v80
  v_mfma_f32_16x16x32_bf16 v[192:195], v[76:79], a[80:83], v[192:195]
  v_rcp_f32 v81, v81
  v_mfma_f32_16x16x32_bf16 v[196:199], v[76:79], a[84:87], v[196:199]
  v_rcp_f32 v82, v82
  v_mfma_f32_16x16x32_bf16 v[200:203], v[76:79], a[88:91], v[200:203]
  v_rcp_f32 v83, v83
  v_mfma_f32_16x16x32_bf16 v[204:207], v[76:79], a[92:95], v[204:207]
  s_waitcnt vmcnt(10) lgkmcnt(0)
  s_barrier
  v_mfma_f32_16x16x32_bf16 v[144:147], v[48:51], a[96:99], v[144:147]
  ds_read_b64_tr_b16 v[64:65], v11 offset:40960
  s_add_u32 m0, s67, 139264
  v_mfma_f32_16x16x32_bf16 v[148:151], v[48:51], a[100:103], v[148:151]
  ds_read_b64_tr_b16 v[66:67], v11 offset:45056
  buffer_load_dwordx4 v4, s[20:23], s55 offen lds
  v_mfma_f32_16x16x32_bf16 v[152:155], v[48:51], a[104:107], v[152:155]
  ds_read_b64_tr_b16 v[68:69], v12 offset:40960
  v_mul_f32 v112, v112, v80
  v_mfma_f32_16x16x32_bf16 v[156:159], v[48:51], a[108:111], v[156:159]
  ds_read_b64_tr_b16 v[70:71], v12 offset:45056
  v_mul_f32 v113, v113, v81
  v_mfma_f32_16x16x32_bf16 v[160:163], v[52:55], a[96:99], v[160:163]
  ds_read_b64_tr_b16 v[72:73], v11 offset:41984
  v_mul_f32 v114, v114, v82
  v_mfma_f32_16x16x32_bf16 v[164:167], v[52:55], a[100:103], v[164:167]
  ds_read_b64_tr_b16 v[74:75], v11 offset:46080
  v_mul_f32 v115, v115, v83
  v_mfma_f32_16x16x32_bf16 v[168:171], v[52:55], a[104:107], v[168:171]
  ds_read_b64_tr_b16 v[76:77], v12 offset:41984
  buffer_load_dwordx4 v4, s[24:27], s55 offen offset:1024 lds
  v_mfma_f32_16x16x32_bf16 v[172:175], v[52:55], a[108:111], v[172:175]
  ds_read_b64_tr_b16 v[78:79], v12 offset:46080
  v_cvt_pk_bf16_f32 v80, v112, v113
  v_mfma_f32_16x16x32_bf16 v[176:179], v[56:59], a[96:99], v[176:179]
  v_cvt_pk_bf16_f32 v81, v114, v115
  v_mul_f32 v116, v84, v116
  v_mfma_f32_16x16x32_bf16 v[180:183], v[56:59], a[100:103], v[180:183]
  v_exp_f32 v96, v96
  v_mfma_f32_16x16x32_bf16 v[184:187], v[56:59], a[104:107], v[184:187]
  s_add_u32 m0, s67, 131072
  v_fma_f32 v96, v96, v31, v31
  v_mfma_f32_16x16x32_bf16 v[188:191], v[56:59], a[108:111], v[188:191]
  buffer_load_dwordx4 v4, s[20:23], s56 offen lds
  v_mul_f32 v84, v84, v28
  v_mfma_f32_16x16x32_bf16 v[192:195], v[60:63], a[96:99], v[192:195]
  v_exp_f32 v97, v97
  v_mfma_f32_16x16x32_bf16 v[196:199], v[60:63], a[100:103], v[196:199]
  v_exp_f32 v98, v98
  v_mfma_f32_16x16x32_bf16 v[200:203], v[60:63], a[104:107], v[200:203]
  v_exp_f32 v99, v99
  v_mfma_f32_16x16x32_bf16 v[204:207], v[60:63], a[108:111], v[204:207]
  v_fma_f32 v97, v97, v31, v31
  s_waitcnt lgkmcnt(0)
  v_mfma_f32_16x16x32_bf16 v[144:147], v[64:67], a[112:115], v[144:147]
  ds_read_b64_tr_b16 v[48:49], v11 offset:16384
  buffer_load_dwordx4 v4, s[24:27], s56 offen offset:1024 lds
  v_mfma_f32_16x16x32_bf16 v[148:151], v[64:67], a[116:119], v[148:151]
  ds_read_b64_tr_b16 v[50:51], v11 offset:20480
  v_fma_f32 v98, v98, v31, v31
  v_mfma_f32_16x16x32_bf16 v[152:155], v[64:67], a[120:123], v[152:155]
  ds_read_b64_tr_b16 v[52:53], v12 offset:16384
  v_fma_f32 v99, v99, v31, v31
  v_mfma_f32_16x16x32_bf16 v[156:159], v[64:67], a[124:127], v[156:159]
  ds_read_b64_tr_b16 v[54:55], v12 offset:20480
  v_mul_f32 v117, v85, v117
  v_mfma_f32_16x16x32_bf16 v[160:163], v[68:71], a[112:115], v[160:163]
  ds_read_b64_tr_b16 v[56:57], v11 offset:17408
  s_add_u32 m0, s67, 122880
  v_mfma_f32_16x16x32_bf16 v[164:167], v[68:71], a[116:119], v[164:167]
  ds_read_b64_tr_b16 v[58:59], v11 offset:21504
  buffer_load_dwordx4 v4, s[20:23], s57 offen lds
  v_mfma_f32_16x16x32_bf16 v[168:171], v[68:71], a[120:123], v[168:171]
  ds_read_b64_tr_b16 v[60:61], v12 offset:17408
  v_mul_f32 v85, v85, v28
  v_mfma_f32_16x16x32_bf16 v[172:175], v[68:71], a[124:127], v[172:175]
  ds_read_b64_tr_b16 v[62:63], v12 offset:21504
  v_mul_f32 v118, v86, v118
  v_mfma_f32_16x16x32_bf16 v[176:179], v[72:75], a[112:115], v[176:179]
  v_rcp_f32 v96, v96
  v_mfma_f32_16x16x32_bf16 v[180:183], v[72:75], a[116:119], v[180:183]
  v_rcp_f32 v97, v97
  v_mfma_f32_16x16x32_bf16 v[184:187], v[72:75], a[120:123], v[184:187]
  buffer_load_dwordx4 v4, s[24:27], s57 offen offset:1024 lds
  v_mul_f32 v128, v128, v96
  v_mfma_f32_16x16x32_bf16 v[188:191], v[72:75], a[124:127], v[188:191]
  v_rcp_f32 v98, v98
  v_mfma_f32_16x16x32_bf16 v[192:195], v[76:79], a[112:115], v[192:195]
  v_rcp_f32 v99, v99
  v_mfma_f32_16x16x32_bf16 v[196:199], v[76:79], a[116:119], v[196:199]
  v_mul_f32 v129, v129, v97
  v_mul_f32 v130, v130, v98
  v_mfma_f32_16x16x32_bf16 v[200:203], v[76:79], a[120:123], v[200:203]
  v_mul_f32 v131, v131, v99
  v_cvt_pk_bf16_f32 v82, v128, v129
  v_mfma_f32_16x16x32_bf16 v[204:207], v[76:79], a[124:127], v[204:207]
  v_cvt_pk_bf16_f32 v83, v130, v131
  s_waitcnt lgkmcnt(0)
  v_mfma_f32_16x16x32_bf16 v[144:147], v[48:51], a[128:131], v[144:147]
  ds_read_b64_tr_b16 v[64:65], v11 offset:8192
  v_add_u32 v4, 128, v4
  v_mfma_f32_16x16x32_bf16 v[148:151], v[48:51], a[132:135], v[148:151]
  ds_read_b64_tr_b16 v[66:67], v11 offset:12288
  s_add_u32 m0, s67, 49152
  v_mfma_f32_16x16x32_bf16 v[152:155], v[48:51], a[136:139], v[152:155]
  ds_read_b64_tr_b16 v[68:69], v12 offset:8192
  buffer_load_dwordx4 v4, s[20:23], s40 offen lds
  v_mfma_f32_16x16x32_bf16 v[156:159], v[48:51], a[140:143], v[156:159]
  ds_read_b64_tr_b16 v[70:71], v12 offset:12288
  v_mul_f32 v86, v86, v28
  v_mfma_f32_16x16x32_bf16 v[160:163], v[52:55], a[128:131], v[160:163]
  ds_read_b64_tr_b16 v[72:73], v11 offset:9216
  v_mul_f32 v119, v87, v119
  v_mfma_f32_16x16x32_bf16 v[164:167], v[52:55], a[132:135], v[164:167]
  ds_read_b64_tr_b16 v[74:75], v11 offset:13312
  v_mul_f32 v87, v87, v28
  v_mfma_f32_16x16x32_bf16 v[168:171], v[52:55], a[136:139], v[168:171]
  ds_read_b64_tr_b16 v[76:77], v12 offset:9216
  v_mul_f32 v132, v100, v132
  v_mfma_f32_16x16x32_bf16 v[172:175], v[52:55], a[140:143], v[172:175]
  ds_read_b64_tr_b16 v[78:79], v12 offset:13312
  buffer_load_dwordx4 v4, s[24:27], s40 offen offset:1024 lds
  v_mfma_f32_16x16x32_bf16 v[176:179], v[56:59], a[128:131], v[176:179]
  ds_write_b128 v21, v[80:83] offset:0
  v_mul_f32 v100, v100, v28
  v_mfma_f32_16x16x32_bf16 v[180:183], v[56:59], a[132:135], v[180:183]
  v_exp_f32 v84, v84
  v_mfma_f32_16x16x32_bf16 v[184:187], v[56:59], a[136:139], v[184:187]
  v_exp_f32 v85, v85
  v_mfma_f32_16x16x32_bf16 v[188:191], v[56:59], a[140:143], v[188:191]
  s_add_u32 m0, s67, 40960
  v_fma_f32 v84, v84, v32, v32
  v_mfma_f32_16x16x32_bf16 v[192:195], v[60:63], a[128:131], v[192:195]
  buffer_load_dwordx4 v4, s[20:23], s41 offen lds
  v_fma_f32 v85, v85, v32, v32
  v_mfma_f32_16x16x32_bf16 v[196:199], v[60:63], a[132:135], v[196:199]
  v_exp_f32 v86, v86
  v_mfma_f32_16x16x32_bf16 v[200:203], v[60:63], a[136:139], v[200:203]
  v_exp_f32 v87, v87
  v_mfma_f32_16x16x32_bf16 v[204:207], v[60:63], a[140:143], v[204:207]
  s_waitcnt vmcnt(13) lgkmcnt(0)
  s_barrier
  v_mfma_f32_16x16x32_bf16 v[144:147], v[64:67], a[144:147], v[144:147]
  ds_read_b64_tr_b16 v[48:49], v11 offset:0
  v_fma_f32 v86, v86, v32, v32
  v_mfma_f32_16x16x32_bf16 v[148:151], v[64:67], a[148:151], v[148:151]
  ds_read_b64_tr_b16 v[50:51], v11 offset:4096
  buffer_load_dwordx4 v4, s[24:27], s41 offen offset:1024 lds
  v_mfma_f32_16x16x32_bf16 v[152:155], v[64:67], a[152:155], v[152:155]
  ds_read_b64_tr_b16 v[52:53], v12 offset:0
  v_fma_f32 v87, v87, v32, v32
  v_mfma_f32_16x16x32_bf16 v[156:159], v[64:67], a[156:159], v[156:159]
  ds_read_b64_tr_b16 v[54:55], v12 offset:4096
  v_mul_f32 v133, v101, v133
  v_mfma_f32_16x16x32_bf16 v[160:163], v[68:71], a[144:147], v[160:163]
  ds_read_b64_tr_b16 v[56:57], v11 offset:1024
  v_mul_f32 v101, v101, v28
  v_mfma_f32_16x16x32_bf16 v[164:167], v[68:71], a[148:151], v[164:167]
  ds_read_b64_tr_b16 v[58:59], v11 offset:5120
  s_add_u32 m0, s67, 81920
  v_mfma_f32_16x16x32_bf16 v[168:171], v[68:71], a[152:155], v[168:171]
  ds_read_b64_tr_b16 v[60:61], v12 offset:1024
  buffer_load_dwordx4 v4, s[20:23], s42 offen lds
  v_mfma_f32_16x16x32_bf16 v[172:175], v[68:71], a[156:159], v[172:175]
  ds_read_b64_tr_b16 v[62:63], v12 offset:5120
  v_mul_f32 v134, v102, v134
  v_mfma_f32_16x16x32_bf16 v[176:179], v[72:75], a[144:147], v[176:179]
  v_rcp_f32 v84, v84
  v_mfma_f32_16x16x32_bf16 v[180:183], v[72:75], a[148:151], v[180:183]
  v_rcp_f32 v85, v85
  v_mfma_f32_16x16x32_bf16 v[184:187], v[72:75], a[152:155], v[184:187]
  v_rcp_f32 v86, v86
  v_mfma_f32_16x16x32_bf16 v[188:191], v[72:75], a[156:159], v[188:191]
  buffer_load_dwordx4 v4, s[24:27], s42 offen offset:1024 lds
  v_mul_f32 v116, v116, v84
  v_mfma_f32_16x16x32_bf16 v[192:195], v[76:79], a[144:147], v[192:195]
  v_rcp_f32 v87, v87
  v_mfma_f32_16x16x32_bf16 v[196:199], v[76:79], a[148:151], v[196:199]
  v_mul_f32 v117, v117, v85
  v_mul_f32 v118, v118, v86
  v_mfma_f32_16x16x32_bf16 v[200:203], v[76:79], a[152:155], v[200:203]
  v_mul_f32 v119, v119, v87
  v_cvt_pk_bf16_f32 v84, v116, v117
  v_mfma_f32_16x16x32_bf16 v[204:207], v[76:79], a[156:159], v[204:207]
  v_cvt_pk_bf16_f32 v85, v118, v119
  s_waitcnt lgkmcnt(0)
  v_mfma_f32_16x16x32_bf16 v[144:147], v[48:51], a[160:163], v[144:147]
  ds_read_b64_tr_b16 v[64:65], v13 offset:24576
  s_add_u32 m0, s67, 73728
  v_mfma_f32_16x16x32_bf16 v[148:151], v[48:51], a[164:167], v[148:151]
  ds_read_b64_tr_b16 v[66:67], v13 offset:28672
  buffer_load_dwordx4 v4, s[20:23], s43 offen lds
  v_mfma_f32_16x16x32_bf16 v[152:155], v[48:51], a[168:171], v[152:155]
  ds_read_b64_tr_b16 v[68:69], v14 offset:24576
  v_mul_f32 v102, v102, v28
  v_mfma_f32_16x16x32_bf16 v[156:159], v[48:51], a[172:175], v[156:159]
  ds_read_b64_tr_b16 v[70:71], v14 offset:28672
  v_mul_f32 v135, v103, v135
  v_mfma_f32_16x16x32_bf16 v[160:163], v[52:55], a[160:163], v[160:163]
  ds_read_b64_tr_b16 v[72:73], v13 offset:25600
  v_mul_f32 v103, v103, v28
  v_mfma_f32_16x16x32_bf16 v[164:167], v[52:55], a[164:167], v[164:167]
  ds_read_b64_tr_b16 v[74:75], v13 offset:29696
  v_mul_f32 v120, v88, v120
  v_mfma_f32_16x16x32_bf16 v[168:171], v[52:55], a[168:171], v[168:171]
  ds_read_b64_tr_b16 v[76:77], v14 offset:25600
  buffer_load_dwordx4 v4, s[24:27], s43 offen offset:1024 lds
  v_mfma_f32_16x16x32_bf16 v[172:175], v[52:55], a[172:175], v[172:175]
  ds_read_b64_tr_b16 v[78:79], v14 offset:29696
  v_mul_f32 v88, v88, v29
  v_mfma_f32_16x16x32_bf16 v[176:179], v[56:59], a[160:163], v[176:179]
  v_exp_f32 v100, v100
  v_mfma_f32_16x16x32_bf16 v[180:183], v[56:59], a[164:167], v[180:183]
  v_exp_f32 v101, v101
  v_mfma_f32_16x16x32_bf16 v[184:187], v[56:59], a[168:171], v[184:187]
  s_add_u32 m0, s67, 32768
  v_fma_f32 v100, v100, v32, v32
  v_mfma_f32_16x16x32_bf16 v[188:191], v[56:59], a[172:175], v[188:191]
  buffer_load_dwordx4 v4, s[20:23], s44 offen lds
  v_fma_f32 v101, v101, v32, v32
  v_mfma_f32_16x16x32_bf16 v[192:195], v[60:63], a[160:163], v[192:195]
  v_exp_f32 v102, v102
  v_mfma_f32_16x16x32_bf16 v[196:199], v[60:63], a[164:167], v[196:199]
  v_exp_f32 v103, v103
  v_mfma_f32_16x16x32_bf16 v[200:203], v[60:63], a[168:171], v[200:203]
  v_fma_f32 v102, v102, v32, v32
  v_fma_f32 v103, v103, v32, v32
  v_mfma_f32_16x16x32_bf16 v[204:207], v[60:63], a[172:175], v[204:207]
  v_mul_f32 v121, v89, v121
  s_waitcnt lgkmcnt(0)
  v_mfma_f32_16x16x32_bf16 v[144:147], v[64:67], a[176:179], v[144:147]
  ds_read_b64_tr_b16 v[48:49], v13 offset:16384
  buffer_load_dwordx4 v4, s[24:27], s44 offen offset:1024 lds
  v_mfma_f32_16x16x32_bf16 v[148:151], v[64:67], a[180:183], v[148:151]
  ds_read_b64_tr_b16 v[50:51], v13 offset:20480
  v_mul_f32 v89, v89, v29
  v_mfma_f32_16x16x32_bf16 v[152:155], v[64:67], a[184:187], v[152:155]
  ds_read_b64_tr_b16 v[52:53], v14 offset:16384
  v_mul_f32 v122, v90, v122
  v_mfma_f32_16x16x32_bf16 v[156:159], v[64:67], a[188:191], v[156:159]
  ds_read_b64_tr_b16 v[54:55], v14 offset:20480
  v_mul_f32 v90, v90, v29
  v_mfma_f32_16x16x32_bf16 v[160:163], v[68:71], a[176:179], v[160:163]
  ds_read_b64_tr_b16 v[56:57], v13 offset:17408
  s_add_u32 m0, s67, 24576
  v_mfma_f32_16x16x32_bf16 v[164:167], v[68:71], a[180:183], v[164:167]
  ds_read_b64_tr_b16 v[58:59], v13 offset:21504
  buffer_load_dwordx4 v4, s[20:23], s45 offen lds
  v_mfma_f32_16x16x32_bf16 v[168:171], v[68:71], a[184:187], v[168:171]
  ds_read_b64_tr_b16 v[60:61], v14 offset:17408
  v_mul_f32 v123, v91, v123
  v_mfma_f32_16x16x32_bf16 v[172:175], v[68:71], a[188:191], v[172:175]
  ds_read_b64_tr_b16 v[62:63], v14 offset:21504
  v_mul_f32 v91, v91, v29
  v_mfma_f32_16x16x32_bf16 v[176:179], v[72:75], a[176:179], v[176:179]
  v_rcp_f32 v100, v100
  v_mfma_f32_16x16x32_bf16 v[180:183], v[72:75], a[180:183], v[180:183]
  v_rcp_f32 v101, v101
  v_mfma_f32_16x16x32_bf16 v[184:187], v[72:75], a[184:187], v[184:187]
  buffer_load_dwordx4 v4, s[24:27], s45 offen offset:1024 lds
  v_mul_f32 v132, v132, v100
  v_mfma_f32_16x16x32_bf16 v[188:191], v[72:75], a[188:191], v[188:191]
  v_rcp_f32 v102, v102
  v_mfma_f32_16x16x32_bf16 v[192:195], v[76:79], a[176:179], v[192:195]
  v_rcp_f32 v103, v103
  v_mfma_f32_16x16x32_bf16 v[196:199], v[76:79], a[180:183], v[196:199]
  v_mul_f32 v133, v133, v101
  v_mul_f32 v134, v134, v102
  v_mfma_f32_16x16x32_bf16 v[200:203], v[76:79], a[184:187], v[200:203]
  v_mul_f32 v135, v135, v103
  v_cvt_pk_bf16_f32 v86, v132, v133
  v_mfma_f32_16x16x32_bf16 v[204:207], v[76:79], a[188:191], v[204:207]
  s_waitcnt vmcnt(16) lgkmcnt(0)
  s_barrier
  v_mfma_f32_16x16x32_bf16 v[144:147], v[48:51], a[192:195], v[144:147]
  ds_read_b64_tr_b16 v[64:65], v11 offset:49152
  s_add_u32 m0, s67, 155648
  v_mfma_f32_16x16x32_bf16 v[148:151], v[48:51], a[196:199], v[148:151]
  ds_read_b64_tr_b16 v[66:67], v11 offset:53248
  buffer_load_dwordx4 v4, s[20:23], s46 offen lds
  v_mfma_f32_16x16x32_bf16 v[152:155], v[48:51], a[200:203], v[152:155]
  ds_read_b64_tr_b16 v[68:69], v12 offset:49152
  v_cvt_pk_bf16_f32 v87, v134, v135
  v_mfma_f32_16x16x32_bf16 v[156:159], v[48:51], a[204:207], v[156:159]
  ds_read_b64_tr_b16 v[70:71], v12 offset:53248
  v_mul_f32 v136, v104, v136
  v_mfma_f32_16x16x32_bf16 v[160:163], v[52:55], a[192:195], v[160:163]
  ds_read_b64_tr_b16 v[72:73], v11 offset:50176
  v_mul_f32 v104, v104, v29
  v_mfma_f32_16x16x32_bf16 v[164:167], v[52:55], a[196:199], v[164:167]
  ds_read_b64_tr_b16 v[74:75], v11 offset:54272
  v_mul_f32 v137, v105, v137
  v_mfma_f32_16x16x32_bf16 v[168:171], v[52:55], a[200:203], v[168:171]
  ds_read_b64_tr_b16 v[76:77], v12 offset:50176
  buffer_load_dwordx4 v4, s[24:27], s46 offen offset:1024 lds
  v_mfma_f32_16x16x32_bf16 v[172:175], v[52:55], a[204:207], v[172:175]
  ds_read_b64_tr_b16 v[78:79], v12 offset:54272
  v_mul_f32 v105, v105, v29
  v_mfma_f32_16x16x32_bf16 v[176:179], v[56:59], a[192:195], v[176:179]
  ds_write_b128 v21, v[84:87] offset:1024
  v_mul_f32 v138, v106, v138
  v_mfma_f32_16x16x32_bf16 v[180:183], v[56:59], a[196:199], v[180:183]
  v_exp_f32 v88, v88
  v_mfma_f32_16x16x32_bf16 v[184:187], v[56:59], a[200:203], v[184:187]
  s_add_u32 m0, s67, 147456
  v_fma_f32 v88, v88, v33, v33
  v_mfma_f32_16x16x32_bf16 v[188:191], v[56:59], a[204:207], v[188:191]
  buffer_load_dwordx4 v4, s[20:23], s47 offen lds
  v_mul_f32 v106, v106, v29
  v_mfma_f32_16x16x32_bf16 v[192:195], v[60:63], a[192:195], v[192:195]
  v_exp_f32 v89, v89
  v_mfma_f32_16x16x32_bf16 v[196:199], v[60:63], a[196:199], v[196:199]
  v_exp_f32 v90, v90
  v_mfma_f32_16x16x32_bf16 v[200:203], v[60:63], a[200:203], v[200:203]
  v_exp_f32 v91, v91
  v_mfma_f32_16x16x32_bf16 v[204:207], v[60:63], a[204:207], v[204:207]
  v_fma_f32 v89, v89, v33, v33
  s_waitcnt lgkmcnt(1)
  v_mfma_f32_16x16x32_bf16 v[144:147], v[64:67], a[208:211], v[144:147]
  ds_read_b64_tr_b16 v[48:49], v9 offset:57344
  buffer_load_dwordx4 v4, s[24:27], s47 offen offset:1024 lds
  v_mfma_f32_16x16x32_bf16 v[148:151], v[64:67], a[212:215], v[148:151]
  ds_read_b64_tr_b16 v[50:51], v9 offset:61440
  v_fma_f32 v90, v90, v33, v33
  v_mfma_f32_16x16x32_bf16 v[152:155], v[64:67], a[216:219], v[152:155]
  ds_read_b64_tr_b16 v[52:53], v10 offset:57344
  v_fma_f32 v91, v91, v33, v33
  v_mfma_f32_16x16x32_bf16 v[156:159], v[64:67], a[220:223], v[156:159]
  ds_read_b64_tr_b16 v[54:55], v10 offset:61440
  v_mul_f32 v139, v107, v139
  v_mfma_f32_16x16x32_bf16 v[160:163], v[68:71], a[208:211], v[160:163]
  ds_read_b64_tr_b16 v[56:57], v9 offset:58368
  s_add_u32 m0, s67, 65536
  v_mfma_f32_16x16x32_bf16 v[164:167], v[68:71], a[212:215], v[164:167]
  ds_read_b64_tr_b16 v[58:59], v9 offset:62464
  buffer_load_dwordx4 v4, s[20:23], s48 offen lds
  v_mfma_f32_16x16x32_bf16 v[168:171], v[68:71], a[216:219], v[168:171]
  ds_read_b64_tr_b16 v[60:61], v10 offset:58368
  v_mul_f32 v107, v107, v29
  v_mfma_f32_16x16x32_bf16 v[172:175], v[68:71], a[220:223], v[172:175]
  ds_read_b64_tr_b16 v[62:63], v10 offset:62464
  v_mfma_f32_16x16x32_bf16 v[176:179], v[72:75], a[208:211], v[176:179]
  v_rcp_f32 v88, v88
  v_mfma_f32_16x16x32_bf16 v[180:183], v[72:75], a[212:215], v[180:183]
  v_rcp_f32 v89, v89
  v_mfma_f32_16x16x32_bf16 v[184:187], v[72:75], a[216:219], v[184:187]
  buffer_load_dwordx4 v4, s[24:27], s48 offen offset:1024 lds
  v_mul_f32 v120, v120, v88
  v_mfma_f32_16x16x32_bf16 v[188:191], v[72:75], a[220:223], v[188:191]
  v_rcp_f32 v90, v90
  v_mfma_f32_16x16x32_bf16 v[192:195], v[76:79], a[208:211], v[192:195]
  v_rcp_f32 v91, v91
  v_mfma_f32_16x16x32_bf16 v[196:199], v[76:79], a[212:215], v[196:199]
  v_mul_f32 v121, v121, v89
  v_mul_f32 v122, v122, v90
  v_mfma_f32_16x16x32_bf16 v[200:203], v[76:79], a[216:219], v[200:203]
  v_mul_f32 v123, v123, v91
  v_cvt_pk_bf16_f32 v88, v120, v121
  v_mfma_f32_16x16x32_bf16 v[204:207], v[76:79], a[220:223], v[204:207]
  v_cvt_pk_bf16_f32 v89, v122, v123
  s_waitcnt lgkmcnt(0)
  v_mfma_f32_16x16x32_bf16 v[144:147], v[48:51], a[224:227], v[144:147]
  ds_read_b64_tr_b16 v[64:65], v13 offset:8192
  s_add_u32 m0, s67, 16384
  v_mfma_f32_16x16x32_bf16 v[148:151], v[48:51], a[228:231], v[148:151]
  ds_read_b64_tr_b16 v[66:67], v13 offset:12288
  buffer_load_dwordx4 v4, s[20:23], s49 offen lds
  v_mfma_f32_16x16x32_bf16 v[152:155], v[48:51], a[232:235], v[152:155]
  ds_read_b64_tr_b16 v[68:69], v14 offset:8192
  v_mul_f32 v124, v92, v124
  v_mfma_f32_16x16x32_bf16 v[156:159], v[48:51], a[236:239], v[156:159]
  ds_read_b64_tr_b16 v[70:71], v14 offset:12288
  v_mul_f32 v92, v92, v30
  v_mfma_f32_16x16x32_bf16 v[160:163], v[52:55], a[224:227], v[160:163]
  ds_read_b64_tr_b16 v[72:73], v13 offset:9216
  v_mul_f32 v125, v93, v125
  v_mfma_f32_16x16x32_bf16 v[164:167], v[52:55], a[228:231], v[164:167]
  ds_read_b64_tr_b16 v[74:75], v13 offset:13312
  v_mul_f32 v93, v93, v30
  v_mfma_f32_16x16x32_bf16 v[168:171], v[52:55], a[232:235], v[168:171]
  ds_read_b64_tr_b16 v[76:77], v14 offset:9216
  buffer_load_dwordx4 v4, s[24:27], s49 offen offset:1024 lds
  v_mfma_f32_16x16x32_bf16 v[172:175], v[52:55], a[236:239], v[172:175]
  ds_read_b64_tr_b16 v[78:79], v14 offset:13312
  v_mul_f32 v126, v94, v126
  v_mfma_f32_16x16x32_bf16 v[176:179], v[56:59], a[224:227], v[176:179]
  v_exp_f32 v104, v104
  v_mfma_f32_16x16x32_bf16 v[180:183], v[56:59], a[228:231], v[180:183]
  v_exp_f32 v105, v105
  v_mfma_f32_16x16x32_bf16 v[184:187], v[56:59], a[232:235], v[184:187]
  s_add_u32 m0, s67, 8192
  v_fma_f32 v104, v104, v33, v33
  v_mfma_f32_16x16x32_bf16 v[188:191], v[56:59], a[236:239], v[188:191]
  buffer_load_dwordx4 v4, s[20:23], s50 offen lds
  v_fma_f32 v105, v105, v33, v33
  v_mfma_f32_16x16x32_bf16 v[192:195], v[60:63], a[224:227], v[192:195]
  v_exp_f32 v106, v106
  v_mfma_f32_16x16x32_bf16 v[196:199], v[60:63], a[228:231], v[196:199]
  v_exp_f32 v107, v107
  v_mfma_f32_16x16x32_bf16 v[200:203], v[60:63], a[232:235], v[200:203]
  v_fma_f32 v106, v106, v33, v33
  v_fma_f32 v107, v107, v33, v33
  v_mfma_f32_16x16x32_bf16 v[204:207], v[60:63], a[236:239], v[204:207]
  s_waitcnt vmcnt(19) lgkmcnt(0)
  s_barrier
  v_mfma_f32_16x16x32_bf16 v[144:147], v[64:67], a[240:243], v[144:147]
  ds_read_b64_tr_b16 v[48:49], v13 offset:0
  buffer_load_dwordx4 v4, s[24:27], s50 offen offset:1024 lds
  v_mfma_f32_16x16x32_bf16 v[148:151], v[64:67], a[244:247], v[148:151]
  ds_read_b64_tr_b16 v[50:51], v13 offset:4096
  v_mul_f32 v94, v94, v30
  v_mfma_f32_16x16x32_bf16 v[152:155], v[64:67], a[248:251], v[152:155]
  ds_read_b64_tr_b16 v[52:53], v14 offset:0
  v_mul_f32 v127, v95, v127
  v_mfma_f32_16x16x32_bf16 v[156:159], v[64:67], a[252:255], v[156:159]
  ds_read_b64_tr_b16 v[54:55], v14 offset:4096
  v_mul_f32 v95, v95, v30
  v_mfma_f32_16x16x32_bf16 v[160:163], v[68:71], a[240:243], v[160:163]
  ds_read_b64_tr_b16 v[56:57], v13 offset:1024
  s_add_u32 m0, s67, 139264
  v_mfma_f32_16x16x32_bf16 v[164:167], v[68:71], a[244:247], v[164:167]
  ds_read_b64_tr_b16 v[58:59], v13 offset:5120
  buffer_load_dwordx4 v4, s[20:23], s51 offen lds
  v_mfma_f32_16x16x32_bf16 v[168:171], v[68:71], a[248:251], v[168:171]
  ds_read_b64_tr_b16 v[60:61], v14 offset:1024
  v_mfma_f32_16x16x32_bf16 v[172:175], v[68:71], a[252:255], v[172:175]
  ds_read_b64_tr_b16 v[62:63], v14 offset:5120
  v_mfma_f32_16x16x32_bf16 v[176:179], v[72:75], a[240:243], v[176:179]
  v_rcp_f32 v104, v104
  v_mfma_f32_16x16x32_bf16 v[180:183], v[72:75], a[244:247], v[180:183]
  v_rcp_f32 v105, v105
  v_mfma_f32_16x16x32_bf16 v[184:187], v[72:75], a[248:251], v[184:187]
  buffer_load_dwordx4 v4, s[24:27], s51 offen offset:1024 lds
  v_mul_f32 v136, v136, v104
  v_mfma_f32_16x16x32_bf16 v[188:191], v[72:75], a[252:255], v[188:191]
  v_rcp_f32 v106, v106
  v_mfma_f32_16x16x32_bf16 v[192:195], v[76:79], a[240:243], v[192:195]
  v_rcp_f32 v107, v107
  v_mfma_f32_16x16x32_bf16 v[196:199], v[76:79], a[244:247], v[196:199]
  v_mul_f32 v137, v137, v105
  v_mul_f32 v138, v138, v106
  v_mfma_f32_16x16x32_bf16 v[200:203], v[76:79], a[248:251], v[200:203]
  v_mul_f32 v139, v139, v107
  v_cvt_pk_bf16_f32 v90, v136, v137
  v_mfma_f32_16x16x32_bf16 v[204:207], v[76:79], a[252:255], v[204:207]
  v_cvt_pk_bf16_f32 v91, v138, v139
  s_waitcnt lgkmcnt(0)
  v_mfma_f32_16x16x32_bf16 v[144:147], v[48:51], v[208:211], v[144:147]
  ds_read_b64_tr_b16 v[64:65], v11 offset:57344
  s_add_u32 m0, s67, 57344
  v_mfma_f32_16x16x32_bf16 v[148:151], v[48:51], v[212:215], v[148:151]
  ds_read_b64_tr_b16 v[66:67], v11 offset:61440
  buffer_load_dwordx4 v4, s[20:23], s52 offen lds
  v_mfma_f32_16x16x32_bf16 v[152:155], v[48:51], v[216:219], v[152:155]
  ds_read_b64_tr_b16 v[68:69], v12 offset:57344
  v_mul_f32 v140, v108, v140
  v_mfma_f32_16x16x32_bf16 v[156:159], v[48:51], v[220:223], v[156:159]
  ds_read_b64_tr_b16 v[70:71], v12 offset:61440
  v_mul_f32 v108, v108, v30
  v_mfma_f32_16x16x32_bf16 v[160:163], v[52:55], v[208:211], v[160:163]
  ds_read_b64_tr_b16 v[72:73], v11 offset:58368
  v_mul_f32 v141, v109, v141
  v_mfma_f32_16x16x32_bf16 v[164:167], v[52:55], v[212:215], v[164:167]
  ds_read_b64_tr_b16 v[74:75], v11 offset:62464
  v_mul_f32 v109, v109, v30
  v_mfma_f32_16x16x32_bf16 v[168:171], v[52:55], v[216:219], v[168:171]
  ds_read_b64_tr_b16 v[76:77], v12 offset:58368
  buffer_load_dwordx4 v4, s[24:27], s52 offen offset:1024 lds
  v_mfma_f32_16x16x32_bf16 v[172:175], v[52:55], v[220:223], v[172:175]
  ds_read_b64_tr_b16 v[78:79], v12 offset:62464
  v_mul_f32 v142, v110, v142
  v_mfma_f32_16x16x32_bf16 v[176:179], v[56:59], v[208:211], v[176:179]
  ds_write_b128 v21, v[88:91] offset:2048
  v_mul_f32 v110, v110, v30
  v_mfma_f32_16x16x32_bf16 v[180:183], v[56:59], v[212:215], v[180:183]
  v_exp_f32 v92, v92
  v_mfma_f32_16x16x32_bf16 v[184:187], v[56:59], v[216:219], v[184:187]
  s_add_u32 m0, s67, 0
  v_fma_f32 v92, v92, v34, v34
  v_mfma_f32_16x16x32_bf16 v[188:191], v[56:59], v[220:223], v[188:191]
  buffer_load_dwordx4 v4, s[20:23], s53 offen lds
  v_mul_f32 v143, v111, v143
  v_mfma_f32_16x16x32_bf16 v[192:195], v[60:63], v[208:211], v[192:195]
  v_exp_f32 v93, v93
  v_mfma_f32_16x16x32_bf16 v[196:199], v[60:63], v[212:215], v[196:199]
  v_exp_f32 v94, v94
  v_mfma_f32_16x16x32_bf16 v[200:203], v[60:63], v[216:219], v[200:203]
  v_exp_f32 v95, v95
  v_mfma_f32_16x16x32_bf16 v[204:207], v[60:63], v[220:223], v[204:207]
  v_fma_f32 v93, v93, v34, v34
  s_waitcnt lgkmcnt(1)
  v_mfma_f32_16x16x32_bf16 v[144:147], v[64:67], v[224:227], v[144:147]
  ds_read_b64_tr_b16 v[48:49], v9 offset:49152
  buffer_load_dwordx4 v4, s[24:27], s53 offen offset:1024 lds
  v_mfma_f32_16x16x32_bf16 v[148:151], v[64:67], v[228:231], v[148:151]
  ds_read_b64_tr_b16 v[50:51], v9 offset:53248
  v_fma_f32 v94, v94, v34, v34
  v_mfma_f32_16x16x32_bf16 v[152:155], v[64:67], v[232:235], v[152:155]
  ds_read_b64_tr_b16 v[52:53], v10 offset:49152
  v_fma_f32 v95, v95, v34, v34
  v_mfma_f32_16x16x32_bf16 v[156:159], v[64:67], v[236:239], v[156:159]
  ds_read_b64_tr_b16 v[54:55], v10 offset:53248
  v_mul_f32 v111, v111, v30
  v_mfma_f32_16x16x32_bf16 v[160:163], v[68:71], v[224:227], v[160:163]
  ds_read_b64_tr_b16 v[56:57], v9 offset:50176
  v_mfma_f32_16x16x32_bf16 v[164:167], v[68:71], v[228:231], v[164:167]
  ds_read_b64_tr_b16 v[58:59], v9 offset:54272
  v_mfma_f32_16x16x32_bf16 v[168:171], v[68:71], v[232:235], v[168:171]
  ds_read_b64_tr_b16 v[60:61], v10 offset:50176
  v_mfma_f32_16x16x32_bf16 v[172:175], v[68:71], v[236:239], v[172:175]
  ds_read_b64_tr_b16 v[62:63], v10 offset:54272
  v_mfma_f32_16x16x32_bf16 v[176:179], v[72:75], v[224:227], v[176:179]
  v_rcp_f32 v92, v92
  v_mfma_f32_16x16x32_bf16 v[180:183], v[72:75], v[228:231], v[180:183]
  v_rcp_f32 v93, v93
  v_mfma_f32_16x16x32_bf16 v[184:187], v[72:75], v[232:235], v[184:187]
  v_rcp_f32 v94, v94
  v_mfma_f32_16x16x32_bf16 v[188:191], v[72:75], v[236:239], v[188:191]
  v_rcp_f32 v95, v95
  v_mfma_f32_16x16x32_bf16 v[192:195], v[76:79], v[224:227], v[192:195]
  v_mul_f32 v124, v124, v92
  v_mul_f32 v125, v125, v93
  v_mfma_f32_16x16x32_bf16 v[196:199], v[76:79], v[228:231], v[196:199]
  v_mul_f32 v126, v126, v94
  v_mul_f32 v127, v127, v95
  v_mfma_f32_16x16x32_bf16 v[200:203], v[76:79], v[232:235], v[200:203]
  v_cvt_pk_bf16_f32 v92, v124, v125
  v_cvt_pk_bf16_f32 v93, v126, v127
  v_mfma_f32_16x16x32_bf16 v[204:207], v[76:79], v[236:239], v[204:207]
  v_exp_f32 v108, v108
  v_exp_f32 v109, v109
  v_exp_f32 v110, v110
  v_exp_f32 v111, v111
  v_fma_f32 v108, v108, v34, v34
  v_fma_f32 v109, v109, v34, v34
  v_fma_f32 v110, v110, v34, v34
  v_fma_f32 v111, v111, v34, v34
  v_rcp_f32 v108, v108
  v_rcp_f32 v109, v109
  v_rcp_f32 v110, v110
  v_rcp_f32 v111, v111
  v_mul_f32 v140, v140, v108
  v_mul_f32 v141, v141, v109
  v_mul_f32 v142, v142, v110
  v_mul_f32 v143, v143, v111
  v_cvt_pk_bf16_f32 v94, v140, v141
  v_cvt_pk_bf16_f32 v95, v142, v143
  ds_write_b128 v21, v[92:95] offset:3072
  s_waitcnt vmcnt(20) lgkmcnt(0)
  s_barrier
  v_mfma_f32_16x16x32_bf16 v[80:83], v[48:51], a[0:3], 0
  ds_read_b64_tr_b16 v[64:65], v9 offset:40960
  s_add_u32 m0, s67, 131072
  v_mfma_f32_16x16x32_bf16 v[84:87], v[48:51], a[4:7], 0
  ds_read_b64_tr_b16 v[66:67], v9 offset:45056
  buffer_load_dwordx4 v4, s[20:23], s54 offen lds
  v_mfma_f32_16x16x32_bf16 v[88:91], v[48:51], a[8:11], 0
  ds_read_b64_tr_b16 v[68:69], v10 offset:40960
  v_mul_f32 v176, v144, v176
  v_mfma_f32_16x16x32_bf16 v[92:95], v[48:51], a[12:15], 0
  ds_read_b64_tr_b16 v[70:71], v10 offset:45056
  v_mul_f32 v144, v144, v27
  v_mfma_f32_16x16x32_bf16 v[96:99], v[52:55], a[0:3], 0
  ds_read_b64_tr_b16 v[72:73], v9 offset:41984
  v_mul_f32 v177, v145, v177
  v_mfma_f32_16x16x32_bf16 v[100:103], v[52:55], a[4:7], 0
  ds_read_b64_tr_b16 v[74:75], v9 offset:46080
  v_mul_f32 v145, v145, v27
  v_mfma_f32_16x16x32_bf16 v[104:107], v[52:55], a[8:11], 0
  ds_read_b64_tr_b16 v[76:77], v10 offset:41984
  buffer_load_dwordx4 v4, s[24:27], s54 offen offset:1024 lds
  v_mfma_f32_16x16x32_bf16 v[108:111], v[52:55], a[12:15], 0
  ds_read_b64_tr_b16 v[78:79], v10 offset:46080
  v_mul_f32 v178, v146, v178
  v_mfma_f32_16x16x32_bf16 v[112:115], v[56:59], a[0:3], 0
  v_mul_f32 v146, v146, v27
  v_mul_f32 v179, v147, v179
  v_mfma_f32_16x16x32_bf16 v[116:119], v[56:59], a[4:7], 0
  v_mul_f32 v147, v147, v27
  v_mul_f32 v192, v160, v192
  v_mfma_f32_16x16x32_bf16 v[120:123], v[56:59], a[8:11], 0
  s_add_u32 m0, s67, 122880
  v_mul_f32 v160, v160, v27
  v_mfma_f32_16x16x32_bf16 v[124:127], v[56:59], a[12:15], 0
  buffer_load_dwordx4 v4, s[20:23], s55 offen lds
  v_mul_f32 v193, v161, v193
  v_mfma_f32_16x16x32_bf16 v[128:131], v[60:63], a[0:3], 0
  v_exp_f32 v144, v144
  v_mfma_f32_16x16x32_bf16 v[132:135], v[60:63], a[4:7], 0
  v_exp_f32 v145, v145
  v_mfma_f32_16x16x32_bf16 v[136:139], v[60:63], a[8:11], 0
  v_exp_f32 v146, v146
  v_mfma_f32_16x16x32_bf16 v[140:143], v[60:63], a[12:15], 0
  v_fma_f32 v144, v144, v31, v31
  s_waitcnt lgkmcnt(0)
  v_mfma_f32_16x16x32_bf16 v[80:83], v[64:67], a[16:19], v[80:83]
  ds_read_b64_tr_b16 v[48:49], v11 offset:16384
  buffer_load_dwordx4 v4, s[24:27], s55 offen offset:1024 lds
  v_mfma_f32_16x16x32_bf16 v[84:87], v[64:67], a[20:23], v[84:87]
  ds_read_b64_tr_b16 v[50:51], v11 offset:20480
  v_fma_f32 v145, v145, v31, v31
  v_mfma_f32_16x16x32_bf16 v[88:91], v[64:67], a[24:27], v[88:91]
  ds_read_b64_tr_b16 v[52:53], v12 offset:16384
  v_fma_f32 v146, v146, v31, v31
  v_mfma_f32_16x16x32_bf16 v[92:95], v[64:67], a[28:31], v[92:95]
  ds_read_b64_tr_b16 v[54:55], v12 offset:20480
  v_mul_f32 v161, v161, v27
  v_mfma_f32_16x16x32_bf16 v[96:99], v[68:71], a[16:19], v[96:99]
  ds_read_b64_tr_b16 v[56:57], v11 offset:17408
  s_add_u32 m0, s67, 49152
  v_mfma_f32_16x16x32_bf16 v[100:103], v[68:71], a[20:23], v[100:103]
  ds_read_b64_tr_b16 v[58:59], v11 offset:21504
  buffer_load_dwordx4 v4, s[20:23], s56 offen lds
  v_mfma_f32_16x16x32_bf16 v[104:107], v[68:71], a[24:27], v[104:107]
  ds_read_b64_tr_b16 v[60:61], v12 offset:17408
  v_mul_f32 v194, v162, v194
  v_mfma_f32_16x16x32_bf16 v[108:111], v[68:71], a[28:31], v[108:111]
  ds_read_b64_tr_b16 v[62:63], v12 offset:21504
  v_mul_f32 v162, v162, v27
  v_mfma_f32_16x16x32_bf16 v[112:115], v[72:75], a[16:19], v[112:115]
  v_exp_f32 v147, v147
  v_mfma_f32_16x16x32_bf16 v[116:119], v[72:75], a[20:23], v[116:119]
  v_fma_f32 v147, v147, v31, v31
  v_mul_f32 v195, v163, v195
  v_mfma_f32_16x16x32_bf16 v[120:123], v[72:75], a[24:27], v[120:123]
  buffer_load_dwordx4 v4, s[24:27], s56 offen offset:1024 lds
  v_mul_f32 v163, v163, v27
  v_mfma_f32_16x16x32_bf16 v[124:127], v[72:75], a[28:31], v[124:127]
  v_rcp_f32 v144, v144
  v_mfma_f32_16x16x32_bf16 v[128:131], v[76:79], a[16:19], v[128:131]
  v_rcp_f32 v145, v145
  v_mfma_f32_16x16x32_bf16 v[132:135], v[76:79], a[20:23], v[132:135]
  v_rcp_f32 v146, v146
  v_mfma_f32_16x16x32_bf16 v[136:139], v[76:79], a[24:27], v[136:139]
  v_rcp_f32 v147, v147
  v_mfma_f32_16x16x32_bf16 v[140:143], v[76:79], a[28:31], v[140:143]
  v_mul_f32 v176, v176, v144
  s_waitcnt lgkmcnt(0)
  v_mfma_f32_16x16x32_bf16 v[80:83], v[48:51], a[32:35], v[80:83]
  ds_read_b64_tr_b16 v[64:65], v11 offset:8192
  buffer_load_dword v43, v45, s[32:35], s12 offen
  v_mfma_f32_16x16x32_bf16 v[84:87], v[48:51], a[36:39], v[84:87]
  ds_read_b64_tr_b16 v[66:67], v11 offset:12288
  v_mul_f32 v177, v177, v145
  v_mfma_f32_16x16x32_bf16 v[88:91], v[48:51], a[40:43], v[88:91]
  ds_read_b64_tr_b16 v[68:69], v12 offset:8192
  v_mul_f32 v178, v178, v146
  v_mfma_f32_16x16x32_bf16 v[92:95], v[48:51], a[44:47], v[92:95]
  ds_read_b64_tr_b16 v[70:71], v12 offset:12288
  v_mul_f32 v179, v179, v147
  v_mfma_f32_16x16x32_bf16 v[96:99], v[52:55], a[32:35], v[96:99]
  ds_read_b64_tr_b16 v[72:73], v11 offset:9216
  v_cvt_pk_bf16_f32 v144, v176, v177
  v_mfma_f32_16x16x32_bf16 v[100:103], v[52:55], a[36:39], v[100:103]
  ds_read_b64_tr_b16 v[74:75], v11 offset:13312
  v_cvt_pk_bf16_f32 v145, v178, v179
  v_mfma_f32_16x16x32_bf16 v[104:107], v[52:55], a[40:43], v[104:107]
  ds_read_b64_tr_b16 v[76:77], v12 offset:9216
  v_mul_f32 v180, v148, v180
  v_mfma_f32_16x16x32_bf16 v[108:111], v[52:55], a[44:47], v[108:111]
  ds_read_b64_tr_b16 v[78:79], v12 offset:13312
  v_mul_f32 v148, v148, v28
  v_mfma_f32_16x16x32_bf16 v[112:115], v[56:59], a[32:35], v[112:115]
  v_exp_f32 v160, v160
  v_mfma_f32_16x16x32_bf16 v[116:119], v[56:59], a[36:39], v[116:119]
  v_exp_f32 v161, v161
  v_mfma_f32_16x16x32_bf16 v[120:123], v[56:59], a[40:43], v[120:123]
  v_exp_f32 v162, v162
  v_mfma_f32_16x16x32_bf16 v[124:127], v[56:59], a[44:47], v[124:127]
  v_exp_f32 v163, v163
  v_mfma_f32_16x16x32_bf16 v[128:131], v[60:63], a[32:35], v[128:131]
  v_fma_f32 v160, v160, v31, v31
  v_fma_f32 v161, v161, v31, v31
  v_mfma_f32_16x16x32_bf16 v[132:135], v[60:63], a[36:39], v[132:135]
  v_fma_f32 v162, v162, v31, v31
  v_fma_f32 v163, v163, v31, v31
  v_mfma_f32_16x16x32_bf16 v[136:139], v[60:63], a[40:43], v[136:139]
  v_rcp_f32 v160, v160
  v_mfma_f32_16x16x32_bf16 v[140:143], v[60:63], a[44:47], v[140:143]
  s_waitcnt vmcnt(21) lgkmcnt(0)
  s_barrier
  v_mfma_f32_16x16x32_bf16 v[80:83], v[64:67], a[48:51], v[80:83]
  ds_read_b64_tr_b16 v[48:49], v9 offset:32768
  v_mul_f32 v192, v192, v160
  v_mfma_f32_16x16x32_bf16 v[84:87], v[64:67], a[52:55], v[84:87]
  ds_read_b64_tr_b16 v[50:51], v9 offset:36864
  v_mul_f32 v181, v149, v181
  v_mfma_f32_16x16x32_bf16 v[88:91], v[64:67], a[56:59], v[88:91]
  ds_read_b64_tr_b16 v[52:53], v10 offset:32768
  v_mul_f32 v149, v149, v28
  v_mfma_f32_16x16x32_bf16 v[92:95], v[64:67], a[60:63], v[92:95]
  ds_read_b64_tr_b16 v[54:55], v10 offset:36864
  v_mul_f32 v182, v150, v182
  v_mfma_f32_16x16x32_bf16 v[96:99], v[68:71], a[48:51], v[96:99]
  ds_read_b64_tr_b16 v[56:57], v9 offset:33792
  v_mul_f32 v150, v150, v28
  v_mfma_f32_16x16x32_bf16 v[100:103], v[68:71], a[52:55], v[100:103]
  ds_read_b64_tr_b16 v[58:59], v9 offset:37888
  v_mul_f32 v183, v151, v183
  v_mfma_f32_16x16x32_bf16 v[104:107], v[68:71], a[56:59], v[104:107]
  ds_read_b64_tr_b16 v[60:61], v10 offset:33792
  v_mul_f32 v151, v151, v28
  v_mfma_f32_16x16x32_bf16 v[108:111], v[68:71], a[60:63], v[108:111]
  ds_read_b64_tr_b16 v[62:63], v10 offset:37888
  v_mul_f32 v196, v164, v196
  v_mfma_f32_16x16x32_bf16 v[112:115], v[72:75], a[48:51], v[112:115]
  v_rcp_f32 v161, v161
  v_mfma_f32_16x16x32_bf16 v[116:119], v[72:75], a[52:55], v[116:119]
  v_rcp_f32 v162, v162
  v_mfma_f32_16x16x32_bf16 v[120:123], v[72:75], a[56:59], v[120:123]
  v_rcp_f32 v163, v163
  v_mfma_f32_16x16x32_bf16 v[124:127], v[72:75], a[60:63], v[124:127]
  v_mul_f32 v193, v193, v161
  v_mul_f32 v194, v194, v162
  v_mfma_f32_16x16x32_bf16 v[128:131], v[76:79], a[48:51], v[128:131]
  v_mul_f32 v195, v195, v163
  v_cvt_pk_bf16_f32 v146, v192, v193
  v_mfma_f32_16x16x32_bf16 v[132:135], v[76:79], a[52:55], v[132:135]
  v_cvt_pk_bf16_f32 v147, v194, v195
  v_mul_f32 v164, v164, v28
  v_mfma_f32_16x16x32_bf16 v[136:139], v[76:79], a[56:59], v[136:139]
  v_exp_f32 v148, v148
  v_mfma_f32_16x16x32_bf16 v[140:143], v[76:79], a[60:63], v[140:143]
  v_fma_f32 v148, v148, v32, v32
  s_waitcnt lgkmcnt(0)
  v_mfma_f32_16x16x32_bf16 v[80:83], v[48:51], a[64:67], v[80:83]
  ds_read_b64_tr_b16 v[64:65], v9 offset:24576
  v_mul_f32 v197, v165, v197
  v_mfma_f32_16x16x32_bf16 v[84:87], v[48:51], a[68:71], v[84:87]
  ds_read_b64_tr_b16 v[66:67], v9 offset:28672
  v_mul_f32 v165, v165, v28
  v_mfma_f32_16x16x32_bf16 v[88:91], v[48:51], a[72:75], v[88:91]
  ds_read_b64_tr_b16 v[68:69], v10 offset:24576
  v_mul_f32 v198, v166, v198
  v_mfma_f32_16x16x32_bf16 v[92:95], v[48:51], a[76:79], v[92:95]
  ds_read_b64_tr_b16 v[70:71], v10 offset:28672
  v_mul_f32 v166, v166, v28
  v_mfma_f32_16x16x32_bf16 v[96:99], v[52:55], a[64:67], v[96:99]
  ds_read_b64_tr_b16 v[72:73], v9 offset:25600
  v_mul_f32 v199, v167, v199
  v_mfma_f32_16x16x32_bf16 v[100:103], v[52:55], a[68:71], v[100:103]
  ds_read_b64_tr_b16 v[74:75], v9 offset:29696
  v_mul_f32 v167, v167, v28
  v_mfma_f32_16x16x32_bf16 v[104:107], v[52:55], a[72:75], v[104:107]
  ds_read_b64_tr_b16 v[76:77], v10 offset:25600
  v_mfma_f32_16x16x32_bf16 v[108:111], v[52:55], a[76:79], v[108:111]
  ds_read_b64_tr_b16 v[78:79], v10 offset:29696
  v_mfma_f32_16x16x32_bf16 v[112:115], v[56:59], a[64:67], v[112:115]
  ds_write_b128 v21, v[144:147] offset:16384
  v_mfma_f32_16x16x32_bf16 v[116:119], v[56:59], a[68:71], v[116:119]
  v_exp_f32 v149, v149
  v_mfma_f32_16x16x32_bf16 v[120:123], v[56:59], a[72:75], v[120:123]
  v_exp_f32 v150, v150
  v_mfma_f32_16x16x32_bf16 v[124:127], v[56:59], a[76:79], v[124:127]
  v_exp_f32 v151, v151
  v_mfma_f32_16x16x32_bf16 v[128:131], v[60:63], a[64:67], v[128:131]
  v_fma_f32 v149, v149, v32, v32
  v_fma_f32 v150, v150, v32, v32
  v_mfma_f32_16x16x32_bf16 v[132:135], v[60:63], a[68:71], v[132:135]
  v_fma_f32 v151, v151, v32, v32
  v_mfma_f32_16x16x32_bf16 v[136:139], v[60:63], a[72:75], v[136:139]
  v_rcp_f32 v148, v148
  v_mfma_f32_16x16x32_bf16 v[140:143], v[60:63], a[76:79], v[140:143]
  v_mul_f32 v180, v180, v148
  s_waitcnt lgkmcnt(1)
  v_mfma_f32_16x16x32_bf16 v[80:83], v[64:67], a[80:83], v[80:83]
  ds_read_b64_tr_b16 v[48:49], v13 offset:24576
  v_mul_f32 v184, v152, v184
  v_mfma_f32_16x16x32_bf16 v[84:87], v[64:67], a[84:87], v[84:87]
  ds_read_b64_tr_b16 v[50:51], v13 offset:28672
  v_mul_f32 v152, v152, v29
  v_mfma_f32_16x16x32_bf16 v[88:91], v[64:67], a[88:91], v[88:91]
  ds_read_b64_tr_b16 v[52:53], v14 offset:24576
  v_mul_f32 v185, v153, v185
  v_mfma_f32_16x16x32_bf16 v[92:95], v[64:67], a[92:95], v[92:95]
  ds_read_b64_tr_b16 v[54:55], v14 offset:28672
  v_mul_f32 v153, v153, v29
  v_mfma_f32_16x16x32_bf16 v[96:99], v[68:71], a[80:83], v[96:99]
  ds_read_b64_tr_b16 v[56:57], v13 offset:25600
  v_mul_f32 v186, v154, v186
  v_mfma_f32_16x16x32_bf16 v[100:103], v[68:71], a[84:87], v[100:103]
  ds_read_b64_tr_b16 v[58:59], v13 offset:29696
  v_mul_f32 v154, v154, v29
  v_mfma_f32_16x16x32_bf16 v[104:107], v[68:71], a[88:91], v[104:107]
  ds_read_b64_tr_b16 v[60:61], v14 offset:25600
  v_mul_f32 v187, v155, v187
  v_mfma_f32_16x16x32_bf16 v[108:111], v[68:71], a[92:95], v[108:111]
  ds_read_b64_tr_b16 v[62:63], v14 offset:29696
  v_mul_f32 v155, v155, v29
  v_mfma_f32_16x16x32_bf16 v[112:115], v[72:75], a[80:83], v[112:115]
  v_rcp_f32 v149, v149
  v_mfma_f32_16x16x32_bf16 v[116:119], v[72:75], a[84:87], v[116:119]
  v_rcp_f32 v150, v150
  v_mfma_f32_16x16x32_bf16 v[120:123], v[72:75], a[88:91], v[120:123]
  v_rcp_f32 v151, v151
  v_mfma_f32_16x16x32_bf16 v[124:127], v[72:75], a[92:95], v[124:127]
  v_mul_f32 v181, v181, v149
  v_mul_f32 v182, v182, v150
  v_mfma_f32_16x16x32_bf16 v[128:131], v[76:79], a[80:83], v[128:131]
  v_mul_f32 v183, v183, v151
  v_cvt_pk_bf16_f32 v148, v180, v181
  v_mfma_f32_16x16x32_bf16 v[132:135], v[76:79], a[84:87], v[132:135]
  v_cvt_pk_bf16_f32 v149, v182, v183
  v_mfma_f32_16x16x32_bf16 v[136:139], v[76:79], a[88:91], v[136:139]
  v_exp_f32 v164, v164
  v_mfma_f32_16x16x32_bf16 v[140:143], v[76:79], a[92:95], v[140:143]
  s_waitcnt vmcnt(15) lgkmcnt(0)
  s_barrier
  v_mfma_f32_16x16x32_bf16 v[80:83], v[48:51], a[96:99], v[80:83]
  ds_read_b64_tr_b16 v[64:65], v13 offset:16384
  v_fma_f32 v164, v164, v32, v32
  v_mfma_f32_16x16x32_bf16 v[84:87], v[48:51], a[100:103], v[84:87]
  ds_read_b64_tr_b16 v[66:67], v13 offset:20480
  v_mfma_f32_16x16x32_bf16 v[88:91], v[48:51], a[104:107], v[88:91]
  ds_read_b64_tr_b16 v[68:69], v14 offset:16384
  v_mfma_f32_16x16x32_bf16 v[92:95], v[48:51], a[108:111], v[92:95]
  ds_read_b64_tr_b16 v[70:71], v14 offset:20480
  v_mfma_f32_16x16x32_bf16 v[96:99], v[52:55], a[96:99], v[96:99]
  ds_read_b64_tr_b16 v[72:73], v13 offset:17408
  v_mfma_f32_16x16x32_bf16 v[100:103], v[52:55], a[100:103], v[100:103]
  ds_read_b64_tr_b16 v[74:75], v13 offset:21504
  v_mfma_f32_16x16x32_bf16 v[104:107], v[52:55], a[104:107], v[104:107]
  ds_read_b64_tr_b16 v[76:77], v14 offset:17408
  v_mfma_f32_16x16x32_bf16 v[108:111], v[52:55], a[108:111], v[108:111]
  ds_read_b64_tr_b16 v[78:79], v14 offset:21504
  v_mfma_f32_16x16x32_bf16 v[112:115], v[56:59], a[96:99], v[112:115]
  v_exp_f32 v165, v165
  v_mfma_f32_16x16x32_bf16 v[116:119], v[56:59], a[100:103], v[116:119]
  v_exp_f32 v166, v166
  v_mfma_f32_16x16x32_bf16 v[120:123], v[56:59], a[104:107], v[120:123]
  v_exp_f32 v167, v167
  v_mfma_f32_16x16x32_bf16 v[124:127], v[56:59], a[108:111], v[124:127]
  v_fma_f32 v165, v165, v32, v32
  v_fma_f32 v166, v166, v32, v32
  v_mfma_f32_16x16x32_bf16 v[128:131], v[60:63], a[96:99], v[128:131]
  v_fma_f32 v167, v167, v32, v32
  v_mfma_f32_16x16x32_bf16 v[132:135], v[60:63], a[100:103], v[132:135]
  v_rcp_f32 v164, v164
  v_mfma_f32_16x16x32_bf16 v[136:139], v[60:63], a[104:107], v[136:139]
  v_rcp_f32 v165, v165
  v_mfma_f32_16x16x32_bf16 v[140:143], v[60:63], a[108:111], v[140:143]
  v_mul_f32 v196, v196, v164
  s_waitcnt lgkmcnt(0)
  v_mfma_f32_16x16x32_bf16 v[80:83], v[64:67], a[112:115], v[80:83]
  ds_read_b64_tr_b16 v[48:49], v11 offset:0
  v_mul_f32 v197, v197, v165
  v_mfma_f32_16x16x32_bf16 v[84:87], v[64:67], a[116:119], v[84:87]
  ds_read_b64_tr_b16 v[50:51], v11 offset:4096
  v_cvt_pk_bf16_f32 v150, v196, v197
  v_mfma_f32_16x16x32_bf16 v[88:91], v[64:67], a[120:123], v[88:91]
  ds_read_b64_tr_b16 v[52:53], v12 offset:0
  v_mul_f32 v200, v168, v200
  v_mfma_f32_16x16x32_bf16 v[92:95], v[64:67], a[124:127], v[92:95]
  ds_read_b64_tr_b16 v[54:55], v12 offset:4096
  v_mul_f32 v168, v168, v29
  v_mfma_f32_16x16x32_bf16 v[96:99], v[68:71], a[112:115], v[96:99]
  ds_read_b64_tr_b16 v[56:57], v11 offset:1024
  v_mul_f32 v201, v169, v201
  v_mfma_f32_16x16x32_bf16 v[100:103], v[68:71], a[116:119], v[100:103]
  ds_read_b64_tr_b16 v[58:59], v11 offset:5120
  v_mul_f32 v169, v169, v29
  v_mfma_f32_16x16x32_bf16 v[104:107], v[68:71], a[120:123], v[104:107]
  ds_read_b64_tr_b16 v[60:61], v12 offset:1024
  v_mul_f32 v202, v170, v202
  v_mfma_f32_16x16x32_bf16 v[108:111], v[68:71], a[124:127], v[108:111]
  ds_read_b64_tr_b16 v[62:63], v12 offset:5120
  v_mul_f32 v170, v170, v29
  v_mfma_f32_16x16x32_bf16 v[112:115], v[72:75], a[112:115], v[112:115]
  v_rcp_f32 v166, v166
  v_mfma_f32_16x16x32_bf16 v[116:119], v[72:75], a[116:119], v[116:119]
  v_rcp_f32 v167, v167
  v_mfma_f32_16x16x32_bf16 v[120:123], v[72:75], a[120:123], v[120:123]
  v_mul_f32 v198, v198, v166
  v_mul_f32 v199, v199, v167
  v_mfma_f32_16x16x32_bf16 v[124:127], v[72:75], a[124:127], v[124:127]
  v_cvt_pk_bf16_f32 v151, v198, v199
  ds_write_b128 v21, v[148:151] offset:17408
  v_mfma_f32_16x16x32_bf16 v[128:131], v[76:79], a[112:115], v[128:131]
  v_exp_f32 v152, v152
  v_mfma_f32_16x16x32_bf16 v[132:135], v[76:79], a[116:119], v[132:135]
  v_exp_f32 v153, v153
  v_mfma_f32_16x16x32_bf16 v[136:139], v[76:79], a[120:123], v[136:139]
  v_exp_f32 v154, v154
  v_mfma_f32_16x16x32_bf16 v[140:143], v[76:79], a[124:127], v[140:143]
  v_fma_f32 v152, v152, v33, v33
  s_waitcnt lgkmcnt(1)
  v_mfma_f32_16x16x32_bf16 v[80:83], v[48:51], a[128:131], v[80:83]
  ds_read_b64_tr_b16 v[64:65], v9 offset:16384
  v_fma_f32 v153, v153, v33, v33
  v_mfma_f32_16x16x32_bf16 v[84:87], v[48:51], a[132:135], v[84:87]
  ds_read_b64_tr_b16 v[66:67], v9 offset:20480
  v_fma_f32 v154, v154, v33, v33
  v_mfma_f32_16x16x32_bf16 v[88:91], v[48:51], a[136:139], v[88:91]
  ds_read_b64_tr_b16 v[68:69], v10 offset:16384
  v_mul_f32 v203, v171, v203
  v_mfma_f32_16x16x32_bf16 v[92:95], v[48:51], a[140:143], v[92:95]
  ds_read_b64_tr_b16 v[70:71], v10 offset:20480
  v_mul_f32 v171, v171, v29
  v_mfma_f32_16x16x32_bf16 v[96:99], v[52:55], a[128:131], v[96:99]
  ds_read_b64_tr_b16 v[72:73], v9 offset:17408
  v_mfma_f32_16x16x32_bf16 v[100:103], v[52:55], a[132:135], v[100:103]
  ds_read_b64_tr_b16 v[74:75], v9 offset:21504
  v_mfma_f32_16x16x32_bf16 v[104:107], v[52:55], a[136:139], v[104:107]
  ds_read_b64_tr_b16 v[76:77], v10 offset:17408
  v_mfma_f32_16x16x32_bf16 v[108:111], v[52:55], a[140:143], v[108:111]
  ds_read_b64_tr_b16 v[78:79], v10 offset:21504
  v_mfma_f32_16x16x32_bf16 v[112:115], v[56:59], a[128:131], v[112:115]
  v_exp_f32 v155, v155
  v_mfma_f32_16x16x32_bf16 v[116:119], v[56:59], a[132:135], v[116:119]
  v_fma_f32 v155, v155, v33, v33
  v_mfma_f32_16x16x32_bf16 v[120:123], v[56:59], a[136:139], v[120:123]
  v_rcp_f32 v152, v152
  v_mfma_f32_16x16x32_bf16 v[124:127], v[56:59], a[140:143], v[124:127]
  v_rcp_f32 v153, v153
  v_mfma_f32_16x16x32_bf16 v[128:131], v[60:63], a[128:131], v[128:131]
  v_rcp_f32 v154, v154
  v_mfma_f32_16x16x32_bf16 v[132:135], v[60:63], a[132:135], v[132:135]
  v_rcp_f32 v155, v155
  v_mfma_f32_16x16x32_bf16 v[136:139], v[60:63], a[136:139], v[136:139]
  v_mul_f32 v184, v184, v152
  v_mul_f32 v185, v185, v153
  v_mfma_f32_16x16x32_bf16 v[140:143], v[60:63], a[140:143], v[140:143]
  s_waitcnt vmcnt(9) lgkmcnt(0)
  s_barrier
  v_mfma_f32_16x16x32_bf16 v[80:83], v[64:67], a[144:147], v[80:83]
  ds_read_b64_tr_b16 v[48:49], v9 offset:8192
  v_mul_f32 v186, v186, v154
  v_mfma_f32_16x16x32_bf16 v[84:87], v[64:67], a[148:151], v[84:87]
  ds_read_b64_tr_b16 v[50:51], v9 offset:12288
  v_mul_f32 v187, v187, v155
  v_mfma_f32_16x16x32_bf16 v[88:91], v[64:67], a[152:155], v[88:91]
  ds_read_b64_tr_b16 v[52:53], v10 offset:8192
  v_cvt_pk_bf16_f32 v152, v184, v185
  v_mfma_f32_16x16x32_bf16 v[92:95], v[64:67], a[156:159], v[92:95]
  ds_read_b64_tr_b16 v[54:55], v10 offset:12288
  v_cvt_pk_bf16_f32 v153, v186, v187
  v_mfma_f32_16x16x32_bf16 v[96:99], v[68:71], a[144:147], v[96:99]
  ds_read_b64_tr_b16 v[56:57], v9 offset:9216
  v_mul_f32 v188, v156, v188
  v_mfma_f32_16x16x32_bf16 v[100:103], v[68:71], a[148:151], v[100:103]
  ds_read_b64_tr_b16 v[58:59], v9 offset:13312
  v_mul_f32 v156, v156, v30
  v_mfma_f32_16x16x32_bf16 v[104:107], v[68:71], a[152:155], v[104:107]
  ds_read_b64_tr_b16 v[60:61], v10 offset:9216
  v_mul_f32 v189, v157, v189
  v_mfma_f32_16x16x32_bf16 v[108:111], v[68:71], a[156:159], v[108:111]
  ds_read_b64_tr_b16 v[62:63], v10 offset:13312
  v_mul_f32 v157, v157, v30
  v_mfma_f32_16x16x32_bf16 v[112:115], v[72:75], a[144:147], v[112:115]
  v_exp_f32 v168, v168
  v_mfma_f32_16x16x32_bf16 v[116:119], v[72:75], a[148:151], v[116:119]
  v_exp_f32 v169, v169
  v_mfma_f32_16x16x32_bf16 v[120:123], v[72:75], a[152:155], v[120:123]
  v_exp_f32 v170, v170
  v_mfma_f32_16x16x32_bf16 v[124:127], v[72:75], a[156:159], v[124:127]
  v_exp_f32 v171, v171
  v_mfma_f32_16x16x32_bf16 v[128:131], v[76:79], a[144:147], v[128:131]
  v_fma_f32 v168, v168, v33, v33
  v_fma_f32 v169, v169, v33, v33
  v_mfma_f32_16x16x32_bf16 v[132:135], v[76:79], a[148:151], v[132:135]
  v_fma_f32 v170, v170, v33, v33
  v_fma_f32 v171, v171, v33, v33
  v_mfma_f32_16x16x32_bf16 v[136:139], v[76:79], a[152:155], v[136:139]
  v_rcp_f32 v168, v168
  v_mfma_f32_16x16x32_bf16 v[140:143], v[76:79], a[156:159], v[140:143]
  v_mul_f32 v200, v200, v168
  s_waitcnt lgkmcnt(0)
  v_mfma_f32_16x16x32_bf16 v[80:83], v[48:51], a[160:163], v[80:83]
  ds_read_b64_tr_b16 v[64:65], v13 offset:8192
  v_mul_f32 v190, v158, v190
  v_mfma_f32_16x16x32_bf16 v[84:87], v[48:51], a[164:167], v[84:87]
  ds_read_b64_tr_b16 v[66:67], v13 offset:12288
  v_mul_f32 v158, v158, v30
  v_mfma_f32_16x16x32_bf16 v[88:91], v[48:51], a[168:171], v[88:91]
  ds_read_b64_tr_b16 v[68:69], v14 offset:8192
  v_mul_f32 v191, v159, v191
  v_mfma_f32_16x16x32_bf16 v[92:95], v[48:51], a[172:175], v[92:95]
  ds_read_b64_tr_b16 v[70:71], v14 offset:12288
  v_mul_f32 v159, v159, v30
  v_mfma_f32_16x16x32_bf16 v[96:99], v[52:55], a[160:163], v[96:99]
  ds_read_b64_tr_b16 v[72:73], v13 offset:9216
  v_mul_f32 v204, v172, v204
  v_mfma_f32_16x16x32_bf16 v[100:103], v[52:55], a[164:167], v[100:103]
  ds_read_b64_tr_b16 v[74:75], v13 offset:13312
  v_mul_f32 v172, v172, v30
  v_mfma_f32_16x16x32_bf16 v[104:107], v[52:55], a[168:171], v[104:107]
  ds_read_b64_tr_b16 v[76:77], v14 offset:9216
  v_mul_f32 v205, v173, v205
  v_mfma_f32_16x16x32_bf16 v[108:111], v[52:55], a[172:175], v[108:111]
  ds_read_b64_tr_b16 v[78:79], v14 offset:13312
  v_mul_f32 v173, v173, v30
  v_mfma_f32_16x16x32_bf16 v[112:115], v[56:59], a[160:163], v[112:115]
  v_rcp_f32 v169, v169
  v_mfma_f32_16x16x32_bf16 v[116:119], v[56:59], a[164:167], v[116:119]
  v_rcp_f32 v170, v170
  v_mfma_f32_16x16x32_bf16 v[120:123], v[56:59], a[168:171], v[120:123]
  v_rcp_f32 v171, v171
  v_mfma_f32_16x16x32_bf16 v[124:127], v[56:59], a[172:175], v[124:127]
  v_mul_f32 v201, v201, v169
  v_mul_f32 v202, v202, v170
  v_mfma_f32_16x16x32_bf16 v[128:131], v[60:63], a[160:163], v[128:131]
  v_mul_f32 v203, v203, v171
  v_cvt_pk_bf16_f32 v154, v200, v201
  v_mfma_f32_16x16x32_bf16 v[132:135], v[60:63], a[164:167], v[132:135]
  v_cvt_pk_bf16_f32 v155, v202, v203
  v_mul_f32 v206, v174, v206
  v_mfma_f32_16x16x32_bf16 v[136:139], v[60:63], a[168:171], v[136:139]
  v_exp_f32 v156, v156
  v_mfma_f32_16x16x32_bf16 v[140:143], v[60:63], a[172:175], v[140:143]
  v_fma_f32 v156, v156, v34, v34
  s_waitcnt lgkmcnt(0)
  v_mfma_f32_16x16x32_bf16 v[80:83], v[64:67], a[176:179], v[80:83]
  ds_read_b64_tr_b16 v[48:49], v9 offset:57344
  s_add_u32 m0, s67, 155648
  v_mfma_f32_16x16x32_bf16 v[84:87], v[64:67], a[180:183], v[84:87]
  ds_read_b64_tr_b16 v[50:51], v9 offset:61440
  buffer_load_dwordx4 v4, s[20:23], s57 offen lds
  v_mfma_f32_16x16x32_bf16 v[88:91], v[64:67], a[184:187], v[88:91]
  ds_read_b64_tr_b16 v[52:53], v10 offset:57344
  v_mul_f32 v174, v174, v30
  v_mfma_f32_16x16x32_bf16 v[92:95], v[64:67], a[188:191], v[92:95]
  ds_read_b64_tr_b16 v[54:55], v10 offset:61440
  v_mul_f32 v207, v175, v207
  v_mfma_f32_16x16x32_bf16 v[96:99], v[68:71], a[176:179], v[96:99]
  ds_read_b64_tr_b16 v[56:57], v9 offset:58368
  v_mul_f32 v175, v175, v30
  v_mfma_f32_16x16x32_bf16 v[100:103], v[68:71], a[180:183], v[100:103]
  ds_read_b64_tr_b16 v[58:59], v9 offset:62464
  v_mfma_f32_16x16x32_bf16 v[104:107], v[68:71], a[184:187], v[104:107]
  ds_read_b64_tr_b16 v[60:61], v10 offset:58368
  buffer_load_dwordx4 v4, s[24:27], s57 offen offset:1024 lds
  v_mfma_f32_16x16x32_bf16 v[108:111], v[68:71], a[188:191], v[108:111]
  ds_read_b64_tr_b16 v[62:63], v10 offset:62464
  v_mfma_f32_16x16x32_bf16 v[112:115], v[72:75], a[176:179], v[112:115]
  ds_write_b128 v21, v[152:155] offset:18432
  v_mfma_f32_16x16x32_bf16 v[116:119], v[72:75], a[180:183], v[116:119]
  v_exp_f32 v157, v157
  v_mfma_f32_16x16x32_bf16 v[120:123], v[72:75], a[184:187], v[120:123]
  v_add_u32 v4, 128, v4
  s_add_u32 m0, s67, 147456
  v_mfma_f32_16x16x32_bf16 v[124:127], v[72:75], a[188:191], v[124:127]
  buffer_load_dwordx4 v4, s[20:23], s40 offen lds
  v_fma_f32 v157, v157, v34, v34
  v_mfma_f32_16x16x32_bf16 v[128:131], v[76:79], a[176:179], v[128:131]
  v_exp_f32 v158, v158
  v_mfma_f32_16x16x32_bf16 v[132:135], v[76:79], a[180:183], v[132:135]
  v_exp_f32 v159, v159
  v_mfma_f32_16x16x32_bf16 v[136:139], v[76:79], a[184:187], v[136:139]
  v_fma_f32 v158, v158, v34, v34
  v_fma_f32 v159, v159, v34, v34
  v_mfma_f32_16x16x32_bf16 v[140:143], v[76:79], a[188:191], v[140:143]
  s_waitcnt vmcnt(6) lgkmcnt(0)
  s_barrier
  v_mfma_f32_16x16x32_bf16 v[80:83], v[48:51], a[192:195], v[80:83]
  ds_read_b64_tr_b16 v[64:65], v9 offset:0
  buffer_load_dwordx4 v4, s[24:27], s40 offen offset:1024 lds
  v_mfma_f32_16x16x32_bf16 v[84:87], v[48:51], a[196:199], v[84:87]
  ds_read_b64_tr_b16 v[66:67], v9 offset:4096
  v_mfma_f32_16x16x32_bf16 v[88:91], v[48:51], a[200:203], v[88:91]
  ds_read_b64_tr_b16 v[68:69], v10 offset:0
  v_mfma_f32_16x16x32_bf16 v[92:95], v[48:51], a[204:207], v[92:95]
  ds_read_b64_tr_b16 v[70:71], v10 offset:4096
  v_mfma_f32_16x16x32_bf16 v[96:99], v[52:55], a[192:195], v[96:99]
  ds_read_b64_tr_b16 v[72:73], v9 offset:1024
  s_add_u32 m0, s67, 139264
  v_mfma_f32_16x16x32_bf16 v[100:103], v[52:55], a[196:199], v[100:103]
  ds_read_b64_tr_b16 v[74:75], v9 offset:5120
  buffer_load_dwordx4 v4, s[20:23], s41 offen lds
  v_mfma_f32_16x16x32_bf16 v[104:107], v[52:55], a[200:203], v[104:107]
  ds_read_b64_tr_b16 v[76:77], v10 offset:1024
  v_mfma_f32_16x16x32_bf16 v[108:111], v[52:55], a[204:207], v[108:111]
  ds_read_b64_tr_b16 v[78:79], v10 offset:5120
  v_mfma_f32_16x16x32_bf16 v[112:115], v[56:59], a[192:195], v[112:115]
  v_rcp_f32 v156, v156
  v_mfma_f32_16x16x32_bf16 v[116:119], v[56:59], a[196:199], v[116:119]
  v_rcp_f32 v157, v157
  v_mfma_f32_16x16x32_bf16 v[120:123], v[56:59], a[200:203], v[120:123]
  buffer_load_dwordx4 v4, s[24:27], s41 offen offset:1024 lds
  v_mul_f32 v188, v188, v156
  v_mfma_f32_16x16x32_bf16 v[124:127], v[56:59], a[204:207], v[124:127]
  v_rcp_f32 v158, v158
  v_mfma_f32_16x16x32_bf16 v[128:131], v[60:63], a[192:195], v[128:131]
  v_rcp_f32 v159, v159
  v_mfma_f32_16x16x32_bf16 v[132:135], v[60:63], a[196:199], v[132:135]
  v_mul_f32 v189, v189, v157
  v_mul_f32 v190, v190, v158
  v_mfma_f32_16x16x32_bf16 v[136:139], v[60:63], a[200:203], v[136:139]
  v_mul_f32 v191, v191, v159
  v_cvt_pk_bf16_f32 v156, v188, v189
  v_mfma_f32_16x16x32_bf16 v[140:143], v[60:63], a[204:207], v[140:143]
  v_cvt_pk_bf16_f32 v157, v190, v191
  s_waitcnt lgkmcnt(0)
  v_mfma_f32_16x16x32_bf16 v[80:83], v[64:67], a[208:211], v[80:83]
  ds_read_b64_tr_b16 v[48:49], v13 offset:0
  s_add_u32 m0, s67, 81920
  v_mfma_f32_16x16x32_bf16 v[84:87], v[64:67], a[212:215], v[84:87]
  ds_read_b64_tr_b16 v[50:51], v13 offset:4096
  buffer_load_dwordx4 v4, s[20:23], s42 offen lds
  v_mfma_f32_16x16x32_bf16 v[88:91], v[64:67], a[216:219], v[88:91]
  ds_read_b64_tr_b16 v[52:53], v14 offset:0
  v_mfma_f32_16x16x32_bf16 v[92:95], v[64:67], a[220:223], v[92:95]
  ds_read_b64_tr_b16 v[54:55], v14 offset:4096
  v_mfma_f32_16x16x32_bf16 v[96:99], v[68:71], a[208:211], v[96:99]
  ds_read_b64_tr_b16 v[56:57], v13 offset:1024
  v_mfma_f32_16x16x32_bf16 v[100:103], v[68:71], a[212:215], v[100:103]
  ds_read_b64_tr_b16 v[58:59], v13 offset:5120
  v_mfma_f32_16x16x32_bf16 v[104:107], v[68:71], a[216:219], v[104:107]
  ds_read_b64_tr_b16 v[60:61], v14 offset:1024
  buffer_load_dwordx4 v4, s[24:27], s42 offen offset:1024 lds
  v_mfma_f32_16x16x32_bf16 v[108:111], v[68:71], a[220:223], v[108:111]
  ds_read_b64_tr_b16 v[62:63], v14 offset:5120
  v_mfma_f32_16x16x32_bf16 v[112:115], v[72:75], a[208:211], v[112:115]
  v_exp_f32 v172, v172
  v_mfma_f32_16x16x32_bf16 v[116:119], v[72:75], a[212:215], v[116:119]
  v_exp_f32 v173, v173
  v_mfma_f32_16x16x32_bf16 v[120:123], v[72:75], a[216:219], v[120:123]
  s_add_u32 m0, s67, 73728
  v_fma_f32 v172, v172, v34, v34
  v_mfma_f32_16x16x32_bf16 v[124:127], v[72:75], a[220:223], v[124:127]
  buffer_load_dwordx4 v4, s[20:23], s43 offen lds
  v_fma_f32 v173, v173, v34, v34
  v_mfma_f32_16x16x32_bf16 v[128:131], v[76:79], a[208:211], v[128:131]
  v_exp_f32 v174, v174
  v_mfma_f32_16x16x32_bf16 v[132:135], v[76:79], a[212:215], v[132:135]
  v_exp_f32 v175, v175
  v_mfma_f32_16x16x32_bf16 v[136:139], v[76:79], a[216:219], v[136:139]
  v_fma_f32 v174, v174, v34, v34
  v_fma_f32 v175, v175, v34, v34
  v_mfma_f32_16x16x32_bf16 v[140:143], v[76:79], a[220:223], v[140:143]
  s_waitcnt lgkmcnt(0)
  v_mfma_f32_16x16x32_bf16 v[80:83], v[48:51], a[224:227], v[80:83]
  ds_read_b64_tr_b16 v[64:65], v11 offset:57344
  buffer_load_dwordx4 v4, s[24:27], s43 offen offset:1024 lds
  v_mfma_f32_16x16x32_bf16 v[84:87], v[48:51], a[228:231], v[84:87]
  ds_read_b64_tr_b16 v[66:67], v11 offset:61440
  v_mfma_f32_16x16x32_bf16 v[88:91], v[48:51], a[232:235], v[88:91]
  ds_read_b64_tr_b16 v[68:69], v12 offset:57344
  v_mfma_f32_16x16x32_bf16 v[92:95], v[48:51], a[236:239], v[92:95]
  ds_read_b64_tr_b16 v[70:71], v12 offset:61440
  v_mfma_f32_16x16x32_bf16 v[96:99], v[52:55], a[224:227], v[96:99]
  ds_read_b64_tr_b16 v[72:73], v11 offset:58368
  s_add_u32 m0, s67, 65536
  v_mfma_f32_16x16x32_bf16 v[100:103], v[52:55], a[228:231], v[100:103]
  ds_read_b64_tr_b16 v[74:75], v11 offset:62464
  buffer_load_dwordx4 v4, s[20:23], s44 offen lds
  v_mfma_f32_16x16x32_bf16 v[104:107], v[52:55], a[232:235], v[104:107]
  ds_read_b64_tr_b16 v[76:77], v12 offset:58368
  v_mfma_f32_16x16x32_bf16 v[108:111], v[52:55], a[236:239], v[108:111]
  ds_read_b64_tr_b16 v[78:79], v12 offset:62464
  v_mfma_f32_16x16x32_bf16 v[112:115], v[56:59], a[224:227], v[112:115]
  v_rcp_f32 v172, v172
  v_mfma_f32_16x16x32_bf16 v[116:119], v[56:59], a[228:231], v[116:119]
  v_rcp_f32 v173, v173
  v_mfma_f32_16x16x32_bf16 v[120:123], v[56:59], a[232:235], v[120:123]
  buffer_load_dwordx4 v4, s[24:27], s44 offen offset:1024 lds
  v_mul_f32 v204, v204, v172
  v_mfma_f32_16x16x32_bf16 v[124:127], v[56:59], a[236:239], v[124:127]
  v_rcp_f32 v174, v174
  v_mfma_f32_16x16x32_bf16 v[128:131], v[60:63], a[224:227], v[128:131]
  v_rcp_f32 v175, v175
  v_mfma_f32_16x16x32_bf16 v[132:135], v[60:63], a[228:231], v[132:135]
  v_mul_f32 v205, v205, v173
  v_mul_f32 v206, v206, v174
  v_mfma_f32_16x16x32_bf16 v[136:139], v[60:63], a[232:235], v[136:139]
  v_mul_f32 v207, v207, v175
  v_cvt_pk_bf16_f32 v158, v204, v205
  v_mfma_f32_16x16x32_bf16 v[140:143], v[60:63], a[236:239], v[140:143]
  s_waitcnt vmcnt(8) lgkmcnt(0)
  s_barrier
  v_mfma_f32_16x16x32_bf16 v[80:83], v[64:67], a[240:243], v[80:83]
  ds_read_b64_tr_b16 v[48:49], v9 offset:49152
  s_add_u32 m0, s67, 57344
  v_mfma_f32_16x16x32_bf16 v[84:87], v[64:67], a[244:247], v[84:87]
  ds_read_b64_tr_b16 v[50:51], v9 offset:53248
  buffer_load_dwordx4 v4, s[20:23], s45 offen lds
  v_mfma_f32_16x16x32_bf16 v[88:91], v[64:67], a[248:251], v[88:91]
  ds_read_b64_tr_b16 v[52:53], v10 offset:49152
  v_cvt_pk_bf16_f32 v159, v206, v207
  v_mfma_f32_16x16x32_bf16 v[92:95], v[64:67], a[252:255], v[92:95]
  ds_read_b64_tr_b16 v[54:55], v10 offset:53248
  v_mfma_f32_16x16x32_bf16 v[96:99], v[68:71], a[240:243], v[96:99]
  ds_read_b64_tr_b16 v[56:57], v9 offset:50176
  v_mfma_f32_16x16x32_bf16 v[100:103], v[68:71], a[244:247], v[100:103]
  ds_read_b64_tr_b16 v[58:59], v9 offset:54272
  v_mfma_f32_16x16x32_bf16 v[104:107], v[68:71], a[248:251], v[104:107]
  ds_read_b64_tr_b16 v[60:61], v10 offset:50176
  buffer_load_dwordx4 v4, s[24:27], s45 offen offset:1024 lds
  v_mfma_f32_16x16x32_bf16 v[108:111], v[68:71], a[252:255], v[108:111]
  ds_read_b64_tr_b16 v[62:63], v10 offset:54272
  v_mfma_f32_16x16x32_bf16 v[112:115], v[72:75], a[240:243], v[112:115]
  ds_write_b128 v21, v[156:159] offset:19456
  v_mfma_f32_16x16x32_bf16 v[116:119], v[72:75], a[244:247], v[116:119]
  v_mfma_f32_16x16x32_bf16 v[120:123], v[72:75], a[248:251], v[120:123]
  s_add_u32 m0, s67, 40960
  v_mfma_f32_16x16x32_bf16 v[124:127], v[72:75], a[252:255], v[124:127]
  buffer_load_dwordx4 v4, s[20:23], s46 offen lds
  v_mfma_f32_16x16x32_bf16 v[128:131], v[76:79], a[240:243], v[128:131]
  v_mfma_f32_16x16x32_bf16 v[132:135], v[76:79], a[244:247], v[132:135]
  v_mfma_f32_16x16x32_bf16 v[136:139], v[76:79], a[248:251], v[136:139]
  v_mfma_f32_16x16x32_bf16 v[140:143], v[76:79], a[252:255], v[140:143]
  s_waitcnt lgkmcnt(1)
  v_mfma_f32_16x16x32_bf16 v[80:83], v[48:51], v[208:211], v[80:83]
  ds_read_b64_tr_b16 v[64:65], v13 offset:24576
  buffer_load_dwordx4 v4, s[24:27], s46 offen offset:1024 lds
  v_mfma_f32_16x16x32_bf16 v[84:87], v[48:51], v[212:215], v[84:87]
  ds_read_b64_tr_b16 v[66:67], v13 offset:28672
  v_mfma_f32_16x16x32_bf16 v[88:91], v[48:51], v[216:219], v[88:91]
  ds_read_b64_tr_b16 v[68:69], v14 offset:24576
  v_mfma_f32_16x16x32_bf16 v[92:95], v[48:51], v[220:223], v[92:95]
  ds_read_b64_tr_b16 v[70:71], v14 offset:28672
  v_mfma_f32_16x16x32_bf16 v[96:99], v[52:55], v[208:211], v[96:99]
  ds_read_b64_tr_b16 v[72:73], v13 offset:25600
  s_add_u32 m0, s67, 32768
  v_mfma_f32_16x16x32_bf16 v[100:103], v[52:55], v[212:215], v[100:103]
  ds_read_b64_tr_b16 v[74:75], v13 offset:29696
  buffer_load_dwordx4 v4, s[20:23], s47 offen lds
  v_mfma_f32_16x16x32_bf16 v[104:107], v[52:55], v[216:219], v[104:107]
  ds_read_b64_tr_b16 v[76:77], v14 offset:25600
  v_mfma_f32_16x16x32_bf16 v[108:111], v[52:55], v[220:223], v[108:111]
  ds_read_b64_tr_b16 v[78:79], v14 offset:29696
  v_mfma_f32_16x16x32_bf16 v[112:115], v[56:59], v[208:211], v[112:115]
  v_mfma_f32_16x16x32_bf16 v[116:119], v[56:59], v[212:215], v[116:119]
  v_mfma_f32_16x16x32_bf16 v[120:123], v[56:59], v[216:219], v[120:123]
  buffer_load_dwordx4 v4, s[24:27], s47 offen offset:1024 lds
  v_mfma_f32_16x16x32_bf16 v[124:127], v[56:59], v[220:223], v[124:127]
  v_mfma_f32_16x16x32_bf16 v[128:131], v[60:63], v[208:211], v[128:131]
  v_mfma_f32_16x16x32_bf16 v[132:135], v[60:63], v[212:215], v[132:135]
  v_mfma_f32_16x16x32_bf16 v[136:139], v[60:63], v[216:219], v[136:139]
  v_mfma_f32_16x16x32_bf16 v[140:143], v[60:63], v[220:223], v[140:143]
  s_waitcnt lgkmcnt(0)
  v_mfma_f32_16x16x32_bf16 v[80:83], v[64:67], v[224:227], v[80:83]
  ds_read_b64_tr_b16 v[48:49], v13 offset:16384
  s_add_u32 m0, s67, 24576
  v_mfma_f32_16x16x32_bf16 v[84:87], v[64:67], v[228:231], v[84:87]
  ds_read_b64_tr_b16 v[50:51], v13 offset:20480
  buffer_load_dwordx4 v4, s[20:23], s48 offen lds
  v_mfma_f32_16x16x32_bf16 v[88:91], v[64:67], v[232:235], v[88:91]
  ds_read_b64_tr_b16 v[52:53], v14 offset:16384
  v_mfma_f32_16x16x32_bf16 v[92:95], v[64:67], v[236:239], v[92:95]
  ds_read_b64_tr_b16 v[54:55], v14 offset:20480
  v_mfma_f32_16x16x32_bf16 v[96:99], v[68:71], v[224:227], v[96:99]
  ds_read_b64_tr_b16 v[56:57], v13 offset:17408
  v_mfma_f32_16x16x32_bf16 v[100:103], v[68:71], v[228:231], v[100:103]
  ds_read_b64_tr_b16 v[58:59], v13 offset:21504
  v_mfma_f32_16x16x32_bf16 v[104:107], v[68:71], v[232:235], v[104:107]
  ds_read_b64_tr_b16 v[60:61], v14 offset:17408
  buffer_load_dwordx4 v4, s[24:27], s48 offen offset:1024 lds
  v_mfma_f32_16x16x32_bf16 v[108:111], v[68:71], v[236:239], v[108:111]
  ds_read_b64_tr_b16 v[62:63], v14 offset:21504
  v_mfma_f32_16x16x32_bf16 v[112:115], v[72:75], v[224:227], v[112:115]
  v_mfma_f32_16x16x32_bf16 v[116:119], v[72:75], v[228:231], v[116:119]
  v_mfma_f32_16x16x32_bf16 v[120:123], v[72:75], v[232:235], v[120:123]
  s_add_u32 m0, s67, 16384
  v_mfma_f32_16x16x32_bf16 v[124:127], v[72:75], v[236:239], v[124:127]
  buffer_load_dwordx4 v4, s[20:23], s49 offen lds
  v_mfma_f32_16x16x32_bf16 v[128:131], v[76:79], v[224:227], v[128:131]
  v_mfma_f32_16x16x32_bf16 v[132:135], v[76:79], v[228:231], v[132:135]
  v_mfma_f32_16x16x32_bf16 v[136:139], v[76:79], v[232:235], v[136:139]
  v_mfma_f32_16x16x32_bf16 v[140:143], v[76:79], v[236:239], v[140:143]
  s_waitcnt vmcnt(11) lgkmcnt(0)
  s_barrier
  v_mfma_f32_16x16x32_bf16 v[144:147], v[48:51], a[0:3], 0
  ds_read_b64_tr_b16 v[64:65], v13 offset:8192
  buffer_load_dwordx4 v4, s[24:27], s49 offen offset:1024 lds
  v_mfma_f32_16x16x32_bf16 v[148:151], v[48:51], a[4:7], 0
  ds_read_b64_tr_b16 v[66:67], v13 offset:12288
  v_mul_f32 v112, v80, v112
  v_mfma_f32_16x16x32_bf16 v[152:155], v[48:51], a[8:11], 0
  ds_read_b64_tr_b16 v[68:69], v14 offset:8192
  v_mul_f32 v80, v80, v27
  v_mfma_f32_16x16x32_bf16 v[156:159], v[48:51], a[12:15], 0
  ds_read_b64_tr_b16 v[70:71], v14 offset:12288
  v_mul_f32 v113, v81, v113
  v_mfma_f32_16x16x32_bf16 v[160:163], v[52:55], a[0:3], 0
  ds_read_b64_tr_b16 v[72:73], v13 offset:9216
  s_add_u32 m0, s67, 155648
  v_mfma_f32_16x16x32_bf16 v[164:167], v[52:55], a[4:7], 0
  ds_read_b64_tr_b16 v[74:75], v13 offset:13312
  buffer_load_dwordx4 v4, s[20:23], s50 offen lds
  v_mfma_f32_16x16x32_bf16 v[168:171], v[52:55], a[8:11], 0
  ds_read_b64_tr_b16 v[76:77], v14 offset:9216
  v_mul_f32 v81, v81, v27
  v_mfma_f32_16x16x32_bf16 v[172:175], v[52:55], a[12:15], 0
  ds_read_b64_tr_b16 v[78:79], v14 offset:13312
  v_mul_f32 v114, v82, v114
  v_mfma_f32_16x16x32_bf16 v[176:179], v[56:59], a[0:3], 0
  v_mul_f32 v82, v82, v27
  v_mul_f32 v115, v83, v115
  v_mfma_f32_16x16x32_bf16 v[180:183], v[56:59], a[4:7], 0
  v_mul_f32 v83, v83, v27
  v_mul_f32 v128, v96, v128
  v_mfma_f32_16x16x32_bf16 v[184:187], v[56:59], a[8:11], 0
  buffer_load_dwordx4 v4, s[24:27], s50 offen offset:1024 lds
  v_mul_f32 v96, v96, v27
  v_mfma_f32_16x16x32_bf16 v[188:191], v[56:59], a[12:15], 0
  v_exp_f32 v80, v80
  v_mfma_f32_16x16x32_bf16 v[192:195], v[60:63], a[0:3], 0
  v_exp_f32 v81, v81
  v_mfma_f32_16x16x32_bf16 v[196:199], v[60:63], a[4:7], 0
  v_exp_f32 v82, v82
  v_mfma_f32_16x16x32_bf16 v[200:203], v[60:63], a[8:11], 0
  v_exp_f32 v83, v83
  v_mfma_f32_16x16x32_bf16 v[204:207], v[60:63], a[12:15], 0
  v_fma_f32 v80, v80, v31, v31
  s_waitcnt lgkmcnt(0)
  v_mfma_f32_16x16x32_bf16 v[144:147], v[64:67], a[16:19], v[144:147]
  ds_read_b64_tr_b16 v[48:49], v11 offset:16384
  s_add_u32 m0, s67, 147456
  v_mfma_f32_16x16x32_bf16 v[148:151], v[64:67], a[20:23], v[148:151]
  ds_read_b64_tr_b16 v[50:51], v11 offset:20480
  buffer_load_dwordx4 v4, s[20:23], s51 offen lds
  v_mfma_f32_16x16x32_bf16 v[152:155], v[64:67], a[24:27], v[152:155]
  ds_read_b64_tr_b16 v[52:53], v12 offset:16384
  v_fma_f32 v81, v81, v31, v31
  v_mfma_f32_16x16x32_bf16 v[156:159], v[64:67], a[28:31], v[156:159]
  ds_read_b64_tr_b16 v[54:55], v12 offset:20480
  v_fma_f32 v82, v82, v31, v31
  v_mfma_f32_16x16x32_bf16 v[160:163], v[68:71], a[16:19], v[160:163]
  ds_read_b64_tr_b16 v[56:57], v11 offset:17408
  v_fma_f32 v83, v83, v31, v31
  v_mfma_f32_16x16x32_bf16 v[164:167], v[68:71], a[20:23], v[164:167]
  ds_read_b64_tr_b16 v[58:59], v11 offset:21504
  v_mul_f32 v129, v97, v129
  v_mfma_f32_16x16x32_bf16 v[168:171], v[68:71], a[24:27], v[168:171]
  ds_read_b64_tr_b16 v[60:61], v12 offset:17408
  buffer_load_dwordx4 v4, s[24:27], s51 offen offset:1024 lds
  v_mfma_f32_16x16x32_bf16 v[172:175], v[68:71], a[28:31], v[172:175]
  ds_read_b64_tr_b16 v[62:63], v12 offset:21504
  v_mul_f32 v97, v97, v27
  v_mfma_f32_16x16x32_bf16 v[176:179], v[72:75], a[16:19], v[176:179]
  v_rcp_f32 v80, v80
  v_mfma_f32_16x16x32_bf16 v[180:183], v[72:75], a[20:23], v[180:183]
  v_rcp_f32 v81, v81
  v_mfma_f32_16x16x32_bf16 v[184:187], v[72:75], a[24:27], v[184:187]
  s_add_u32 m0, s67, 49152
  v_mul_f32 v112, v112, v80
  v_mfma_f32_16x16x32_bf16 v[188:191], v[72:75], a[28:31], v[188:191]
  buffer_load_dwordx4 v4, s[20:23], s52 offen lds
  v_mul_f32 v113, v113, v81
  v_mfma_f32_16x16x32_bf16 v[192:195], v[76:79], a[16:19], v[192:195]
  v_rcp_f32 v82, v82
  v_mfma_f32_16x16x32_bf16 v[196:199], v[76:79], a[20:23], v[196:199]
  v_rcp_f32 v83, v83
  v_mfma_f32_16x16x32_bf16 v[200:203], v[76:79], a[24:27], v[200:203]
  v_mul_f32 v114, v114, v82
  v_mul_f32 v115, v115, v83
  v_mfma_f32_16x16x32_bf16 v[204:207], v[76:79], a[28:31], v[204:207]
  v_cvt_pk_bf16_f32 v80, v112, v113
  s_waitcnt lgkmcnt(0)
  v_mfma_f32_16x16x32_bf16 v[144:147], v[48:51], a[32:35], v[144:147]
  ds_read_b64_tr_b16 v[64:65], v11 offset:8192
  buffer_load_dwordx4 v4, s[24:27], s52 offen offset:1024 lds
  v_mfma_f32_16x16x32_bf16 v[148:151], v[48:51], a[36:39], v[148:151]
  ds_read_b64_tr_b16 v[66:67], v11 offset:12288
  v_cvt_pk_bf16_f32 v81, v114, v115
  v_mfma_f32_16x16x32_bf16 v[152:155], v[48:51], a[40:43], v[152:155]
  ds_read_b64_tr_b16 v[68:69], v12 offset:8192
  v_mul_f32 v130, v98, v130
  v_mfma_f32_16x16x32_bf16 v[156:159], v[48:51], a[44:47], v[156:159]
  ds_read_b64_tr_b16 v[70:71], v12 offset:12288
  v_mul_f32 v98, v98, v27
  v_mfma_f32_16x16x32_bf16 v[160:163], v[52:55], a[32:35], v[160:163]
  ds_read_b64_tr_b16 v[72:73], v11 offset:9216
  s_add_u32 m0, s67, 8192
  v_mfma_f32_16x16x32_bf16 v[164:167], v[52:55], a[36:39], v[164:167]
  ds_read_b64_tr_b16 v[74:75], v11 offset:13312
  buffer_load_dwordx4 v4, s[20:23], s53 offen lds
  v_mfma_f32_16x16x32_bf16 v[168:171], v[52:55], a[40:43], v[168:171]
  ds_read_b64_tr_b16 v[76:77], v12 offset:9216
  v_mul_f32 v131, v99, v131
  v_mfma_f32_16x16x32_bf16 v[172:175], v[52:55], a[44:47], v[172:175]
  ds_read_b64_tr_b16 v[78:79], v12 offset:13312
  v_mul_f32 v99, v99, v27
  v_mfma_f32_16x16x32_bf16 v[176:179], v[56:59], a[32:35], v[176:179]
  v_exp_f32 v96, v96
  v_mfma_f32_16x16x32_bf16 v[180:183], v[56:59], a[36:39], v[180:183]
  v_exp_f32 v97, v97
  v_mfma_f32_16x16x32_bf16 v[184:187], v[56:59], a[40:43], v[184:187]
  buffer_load_dwordx4 v4, s[24:27], s53 offen offset:1024 lds
  v_fma_f32 v96, v96, v31, v31
  v_mfma_f32_16x16x32_bf16 v[188:191], v[56:59], a[44:47], v[188:191]
  v_exp_f32 v98, v98
  v_mfma_f32_16x16x32_bf16 v[192:195], v[60:63], a[32:35], v[192:195]
  v_exp_f32 v99, v99
  v_mfma_f32_16x16x32_bf16 v[196:199], v[60:63], a[36:39], v[196:199]
  v_fma_f32 v97, v97, v31, v31
  v_fma_f32 v98, v98, v31, v31
  v_mfma_f32_16x16x32_bf16 v[200:203], v[60:63], a[40:43], v[200:203]
  v_fma_f32 v99, v99, v31, v31
  v_mul_f32 v116, v84, v116
  v_mfma_f32_16x16x32_bf16 v[204:207], v[60:63], a[44:47], v[204:207]
  s_waitcnt vmcnt(14) lgkmcnt(0)
  s_barrier
  v_mfma_f32_16x16x32_bf16 v[144:147], v[64:67], a[48:51], v[144:147]
  ds_read_b64_tr_b16 v[48:49], v11 offset:0
  s_add_u32 m0, s67, 139264
  v_mfma_f32_16x16x32_bf16 v[148:151], v[64:67], a[52:55], v[148:151]
  ds_read_b64_tr_b16 v[50:51], v11 offset:4096
  buffer_load_dwordx4 v4, s[20:23], s54 offen lds
  v_mfma_f32_16x16x32_bf16 v[152:155], v[64:67], a[56:59], v[152:155]
  ds_read_b64_tr_b16 v[52:53], v12 offset:0
  v_mul_f32 v84, v84, v28
  v_mfma_f32_16x16x32_bf16 v[156:159], v[64:67], a[60:63], v[156:159]
  ds_read_b64_tr_b16 v[54:55], v12 offset:4096
  v_mul_f32 v117, v85, v117
  v_mfma_f32_16x16x32_bf16 v[160:163], v[68:71], a[48:51], v[160:163]
  ds_read_b64_tr_b16 v[56:57], v11 offset:1024
  v_mul_f32 v85, v85, v28
  v_mfma_f32_16x16x32_bf16 v[164:167], v[68:71], a[52:55], v[164:167]
  ds_read_b64_tr_b16 v[58:59], v11 offset:5120
  v_mul_f32 v118, v86, v118
  v_mfma_f32_16x16x32_bf16 v[168:171], v[68:71], a[56:59], v[168:171]
  ds_read_b64_tr_b16 v[60:61], v12 offset:1024
  buffer_load_dwordx4 v4, s[24:27], s54 offen offset:1024 lds
  v_mfma_f32_16x16x32_bf16 v[172:175], v[68:71], a[60:63], v[172:175]
  ds_read_b64_tr_b16 v[62:63], v12 offset:5120
  v_mul_f32 v86, v86, v28
  v_mfma_f32_16x16x32_bf16 v[176:179], v[72:75], a[48:51], v[176:179]
  v_rcp_f32 v96, v96
  v_mfma_f32_16x16x32_bf16 v[180:183], v[72:75], a[52:55], v[180:183]
  v_rcp_f32 v97, v97
  v_mfma_f32_16x16x32_bf16 v[184:187], v[72:75], a[56:59], v[184:187]
  s_add_u32 m0, s67, 81920
  v_mul_f32 v128, v128, v96
  v_mfma_f32_16x16x32_bf16 v[188:191], v[72:75], a[60:63], v[188:191]
  buffer_load_dwordx4 v4, s[20:23], s55 offen lds
  v_mul_f32 v129, v129, v97
  v_mfma_f32_16x16x32_bf16 v[192:195], v[76:79], a[48:51], v[192:195]
  v_rcp_f32 v98, v98
  v_mfma_f32_16x16x32_bf16 v[196:199], v[76:79], a[52:55], v[196:199]
  v_rcp_f32 v99, v99
  v_mfma_f32_16x16x32_bf16 v[200:203], v[76:79], a[56:59], v[200:203]
  v_mul_f32 v130, v130, v98
  v_mul_f32 v131, v131, v99
  v_mfma_f32_16x16x32_bf16 v[204:207], v[76:79], a[60:63], v[204:207]
  v_cvt_pk_bf16_f32 v82, v128, v129
  s_waitcnt lgkmcnt(0)
  v_mfma_f32_16x16x32_bf16 v[144:147], v[48:51], a[64:67], v[144:147]
  ds_read_b64_tr_b16 v[64:65], v9 offset:57344
  buffer_load_dwordx4 v4, s[24:27], s55 offen offset:1024 lds
  v_mfma_f32_16x16x32_bf16 v[148:151], v[48:51], a[68:71], v[148:151]
  ds_read_b64_tr_b16 v[66:67], v9 offset:61440
  v_cvt_pk_bf16_f32 v83, v130, v131
  v_mfma_f32_16x16x32_bf16 v[152:155], v[48:51], a[72:75], v[152:155]
  ds_read_b64_tr_b16 v[68:69], v10 offset:57344
  v_mul_f32 v119, v87, v119
  v_mfma_f32_16x16x32_bf16 v[156:159], v[48:51], a[76:79], v[156:159]
  ds_read_b64_tr_b16 v[70:71], v10 offset:61440
  v_mul_f32 v87, v87, v28
  v_mfma_f32_16x16x32_bf16 v[160:163], v[52:55], a[64:67], v[160:163]
  ds_read_b64_tr_b16 v[72:73], v9 offset:58368
  s_add_u32 m0, s67, 73728
  v_mfma_f32_16x16x32_bf16 v[164:167], v[52:55], a[68:71], v[164:167]
  ds_read_b64_tr_b16 v[74:75], v9 offset:62464
  buffer_load_dwordx4 v4, s[20:23], s56 offen lds
  v_mfma_f32_16x16x32_bf16 v[168:171], v[52:55], a[72:75], v[168:171]
  ds_read_b64_tr_b16 v[76:77], v10 offset:58368
  v_mul_f32 v132, v100, v132
  v_mfma_f32_16x16x32_bf16 v[172:175], v[52:55], a[76:79], v[172:175]
  ds_read_b64_tr_b16 v[78:79], v10 offset:62464
  v_mul_f32 v100, v100, v28
  v_mfma_f32_16x16x32_bf16 v[176:179], v[56:59], a[64:67], v[176:179]
  ds_write_b128 v21, v[80:83] offset:32768
  v_mul_f32 v133, v101, v133
  v_mfma_f32_16x16x32_bf16 v[180:183], v[56:59], a[68:71], v[180:183]
  v_exp_f32 v84, v84
  v_mfma_f32_16x16x32_bf16 v[184:187], v[56:59], a[72:75], v[184:187]
  buffer_load_dwordx4 v4, s[24:27], s56 offen offset:1024 lds
  v_fma_f32 v84, v84, v32, v32
  v_mfma_f32_16x16x32_bf16 v[188:191], v[56:59], a[76:79], v[188:191]
  v_exp_f32 v85, v85
  v_mfma_f32_16x16x32_bf16 v[192:195], v[60:63], a[64:67], v[192:195]
  v_exp_f32 v86, v86
  v_mfma_f32_16x16x32_bf16 v[196:199], v[60:63], a[68:71], v[196:199]
  v_exp_f32 v87, v87
  v_mfma_f32_16x16x32_bf16 v[200:203], v[60:63], a[72:75], v[200:203]
  v_fma_f32 v85, v85, v32, v32
  v_fma_f32 v86, v86, v32, v32
  v_mfma_f32_16x16x32_bf16 v[204:207], v[60:63], a[76:79], v[204:207]
  v_fma_f32 v87, v87, v32, v32
  s_waitcnt lgkmcnt(1)
  v_mfma_f32_16x16x32_bf16 v[144:147], v[64:67], a[80:83], v[144:147]
  ds_read_b64_tr_b16 v[48:49], v9 offset:40960
  s_add_u32 m0, s67, 0
  v_mfma_f32_16x16x32_bf16 v[148:151], v[64:67], a[84:87], v[148:151]
  ds_read_b64_tr_b16 v[50:51], v9 offset:45056
  buffer_load_dwordx4 v4, s[20:23], s57 offen lds
  v_mfma_f32_16x16x32_bf16 v[152:155], v[64:67], a[88:91], v[152:155]
  ds_read_b64_tr_b16 v[52:53], v10 offset:40960
  v_mul_f32 v101, v101, v28
  v_mfma_f32_16x16x32_bf16 v[156:159], v[64:67], a[92:95], v[156:159]
  ds_read_b64_tr_b16 v[54:55], v10 offset:45056
  v_mul_f32 v134, v102, v134
  v_mfma_f32_16x16x32_bf16 v[160:163], v[68:71], a[80:83], v[160:163]
  ds_read_b64_tr_b16 v[56:57], v9 offset:41984
  v_mul_f32 v102, v102, v28
  v_mfma_f32_16x16x32_bf16 v[164:167], v[68:71], a[84:87], v[164:167]
  ds_read_b64_tr_b16 v[58:59], v9 offset:46080
  v_mul_f32 v135, v103, v135
  v_mfma_f32_16x16x32_bf16 v[168:171], v[68:71], a[88:91], v[168:171]
  ds_read_b64_tr_b16 v[60:61], v10 offset:41984
  buffer_load_dwordx4 v4, s[24:27], s57 offen offset:1024 lds
  v_mfma_f32_16x16x32_bf16 v[172:175], v[68:71], a[92:95], v[172:175]
  ds_read_b64_tr_b16 v[62:63], v10 offset:46080
  v_mul_f32 v103, v103, v28
  v_mfma_f32_16x16x32_bf16 v[176:179], v[72:75], a[80:83], v[176:179]
  v_rcp_f32 v84, v84
  v_mfma_f32_16x16x32_bf16 v[180:183], v[72:75], a[84:87], v[180:183]
  v_rcp_f32 v85, v85
  v_mfma_f32_16x16x32_bf16 v[184:187], v[72:75], a[88:91], v[184:187]
  v_rcp_f32 v86, v86
  v_mfma_f32_16x16x32_bf16 v[188:191], v[72:75], a[92:95], v[188:191]
  v_rcp_f32 v87, v87
  v_mfma_f32_16x16x32_bf16 v[192:195], v[76:79], a[80:83], v[192:195]
  v_mul_f32 v116, v116, v84
  v_mul_f32 v117, v117, v85
  v_mfma_f32_16x16x32_bf16 v[196:199], v[76:79], a[84:87], v[196:199]
  v_mul_f32 v118, v118, v86
  v_mul_f32 v119, v119, v87
  v_mfma_f32_16x16x32_bf16 v[200:203], v[76:79], a[88:91], v[200:203]
  v_cvt_pk_bf16_f32 v84, v116, v117
  v_cvt_pk_bf16_f32 v85, v118, v119
  v_mfma_f32_16x16x32_bf16 v[204:207], v[76:79], a[92:95], v[204:207]
  s_waitcnt vmcnt(16) lgkmcnt(0)
  s_barrier
  v_mfma_f32_16x16x32_bf16 v[144:147], v[48:51], a[96:99], v[144:147]
  ds_read_b64_tr_b16 v[64:65], v9 offset:32768
  s_add_u32 m0, s68, 65536
  v_mfma_f32_16x16x32_bf16 v[148:151], v[48:51], a[100:103], v[148:151]
  ds_read_b64_tr_b16 v[66:67], v9 offset:36864
  buffer_load_dwordx4 v5, s[28:31], s40 offen lds
  v_mfma_f32_16x16x32_bf16 v[152:155], v[48:51], a[104:107], v[152:155]
  ds_read_b64_tr_b16 v[68:69], v10 offset:32768
  v_mul_f32 v120, v88, v120
  v_mfma_f32_16x16x32_bf16 v[156:159], v[48:51], a[108:111], v[156:159]
  ds_read_b64_tr_b16 v[70:71], v10 offset:36864
  v_mul_f32 v88, v88, v29
  v_mfma_f32_16x16x32_bf16 v[160:163], v[52:55], a[96:99], v[160:163]
  ds_read_b64_tr_b16 v[72:73], v9 offset:33792
  v_mul_f32 v121, v89, v121
  v_mfma_f32_16x16x32_bf16 v[164:167], v[52:55], a[100:103], v[164:167]
  ds_read_b64_tr_b16 v[74:75], v9 offset:37888
  s_add_u32 m0, s68, 69632
  v_mfma_f32_16x16x32_bf16 v[168:171], v[52:55], a[104:107], v[168:171]
  ds_read_b64_tr_b16 v[76:77], v10 offset:33792
  buffer_load_dwordx4 v5, s[28:31], s41 offen lds
  v_mfma_f32_16x16x32_bf16 v[172:175], v[52:55], a[108:111], v[172:175]
  ds_read_b64_tr_b16 v[78:79], v10 offset:37888
  v_mul_f32 v89, v89, v29
  v_mfma_f32_16x16x32_bf16 v[176:179], v[56:59], a[96:99], v[176:179]
  v_exp_f32 v100, v100
  v_mfma_f32_16x16x32_bf16 v[180:183], v[56:59], a[100:103], v[180:183]
  v_exp_f32 v101, v101
  v_mfma_f32_16x16x32_bf16 v[184:187], v[56:59], a[104:107], v[184:187]
  s_add_u32 m0, s68, 57344
  v_fma_f32 v100, v100, v32, v32
  v_mfma_f32_16x16x32_bf16 v[188:191], v[56:59], a[108:111], v[188:191]
  buffer_load_dwordx4 v5, s[28:31], s42 offen lds
  v_fma_f32 v101, v101, v32, v32
  v_mfma_f32_16x16x32_bf16 v[192:195], v[60:63], a[96:99], v[192:195]
  v_exp_f32 v102, v102
  v_mfma_f32_16x16x32_bf16 v[196:199], v[60:63], a[100:103], v[196:199]
  v_exp_f32 v103, v103
  v_mfma_f32_16x16x32_bf16 v[200:203], v[60:63], a[104:107], v[200:203]
  v_fma_f32 v102, v102, v32, v32
  v_fma_f32 v103, v103, v32, v32
  v_mfma_f32_16x16x32_bf16 v[204:207], v[60:63], a[108:111], v[204:207]
  s_add_u32 m0, s68, 61440
  s_waitcnt lgkmcnt(0)
  v_mfma_f32_16x16x32_bf16 v[144:147], v[64:67], a[112:115], v[144:147]
  ds_read_b64_tr_b16 v[48:49], v9 offset:24576
  buffer_load_dwordx4 v5, s[28:31], s43 offen lds
  v_mfma_f32_16x16x32_bf16 v[148:151], v[64:67], a[116:119], v[148:151]
  ds_read_b64_tr_b16 v[50:51], v9 offset:28672
  v_mul_f32 v122, v90, v122
  v_mfma_f32_16x16x32_bf16 v[152:155], v[64:67], a[120:123], v[152:155]
  ds_read_b64_tr_b16 v[52:53], v10 offset:24576
  v_mul_f32 v90, v90, v29
  v_mfma_f32_16x16x32_bf16 v[156:159], v[64:67], a[124:127], v[156:159]
  ds_read_b64_tr_b16 v[54:55], v10 offset:28672
  v_mul_f32 v123, v91, v123
  v_mfma_f32_16x16x32_bf16 v[160:163], v[68:71], a[112:115], v[160:163]
  ds_read_b64_tr_b16 v[56:57], v9 offset:25600
  s_add_u32 m0, s68, 40960
  v_mfma_f32_16x16x32_bf16 v[164:167], v[68:71], a[116:119], v[164:167]
  ds_read_b64_tr_b16 v[58:59], v9 offset:29696
  buffer_load_dwordx4 v5, s[28:31], s44 offen lds
  v_mfma_f32_16x16x32_bf16 v[168:171], v[68:71], a[120:123], v[168:171]
  ds_read_b64_tr_b16 v[60:61], v10 offset:25600
  v_mul_f32 v91, v91, v29
  v_mfma_f32_16x16x32_bf16 v[172:175], v[68:71], a[124:127], v[172:175]
  ds_read_b64_tr_b16 v[62:63], v10 offset:29696
  v_mfma_f32_16x16x32_bf16 v[176:179], v[72:75], a[112:115], v[176:179]
  v_rcp_f32 v100, v100
  v_mfma_f32_16x16x32_bf16 v[180:183], v[72:75], a[116:119], v[180:183]
  s_add_u32 m0, s68, 45056
  v_mul_f32 v132, v132, v100
  v_mfma_f32_16x16x32_bf16 v[184:187], v[72:75], a[120:123], v[184:187]
  buffer_load_dwordx4 v5, s[28:31], s45 offen lds
  v_mul_f32 v136, v104, v136
  v_mfma_f32_16x16x32_bf16 v[188:191], v[72:75], a[124:127], v[188:191]
  v_rcp_f32 v101, v101
  v_mfma_f32_16x16x32_bf16 v[192:195], v[76:79], a[112:115], v[192:195]
  v_rcp_f32 v102, v102
  v_mfma_f32_16x16x32_bf16 v[196:199], v[76:79], a[116:119], v[196:199]
  v_rcp_f32 v103, v103
  v_mfma_f32_16x16x32_bf16 v[200:203], v[76:79], a[120:123], v[200:203]
  v_mul_f32 v133, v133, v101
  v_mul_f32 v134, v134, v102
  v_mfma_f32_16x16x32_bf16 v[204:207], v[76:79], a[124:127], v[204:207]
  v_mul_f32 v135, v135, v103
  s_waitcnt lgkmcnt(0)
  v_mfma_f32_16x16x32_bf16 v[144:147], v[48:51], a[128:131], v[144:147]
  ds_read_b64_tr_b16 v[64:65], v9 offset:16384
  v_cvt_pk_bf16_f32 v86, v132, v133
  v_mfma_f32_16x16x32_bf16 v[148:151], v[48:51], a[132:135], v[148:151]
  ds_read_b64_tr_b16 v[66:67], v9 offset:20480
  v_cvt_pk_bf16_f32 v87, v134, v135
  v_mfma_f32_16x16x32_bf16 v[152:155], v[48:51], a[136:139], v[152:155]
  ds_read_b64_tr_b16 v[68:69], v10 offset:16384
  v_mul_f32 v104, v104, v29
  v_mfma_f32_16x16x32_bf16 v[156:159], v[48:51], a[140:143], v[156:159]
  ds_read_b64_tr_b16 v[70:71], v10 offset:20480
  v_mul_f32 v137, v105, v137
  v_mfma_f32_16x16x32_bf16 v[160:163], v[52:55], a[128:131], v[160:163]
  ds_read_b64_tr_b16 v[72:73], v9 offset:17408
  v_mul_f32 v105, v105, v29
  v_mfma_f32_16x16x32_bf16 v[164:167], v[52:55], a[132:135], v[164:167]
  ds_read_b64_tr_b16 v[74:75], v9 offset:21504
  v_mul_f32 v138, v106, v138
  v_mfma_f32_16x16x32_bf16 v[168:171], v[52:55], a[136:139], v[168:171]
  ds_read_b64_tr_b16 v[76:77], v10 offset:17408
  v_mul_f32 v106, v106, v29
  v_mfma_f32_16x16x32_bf16 v[172:175], v[52:55], a[140:143], v[172:175]
  ds_read_b64_tr_b16 v[78:79], v10 offset:21504
  v_mul_f32 v139, v107, v139
  v_mfma_f32_16x16x32_bf16 v[176:179], v[56:59], a[128:131], v[176:179]
  ds_write_b128 v21, v[84:87] offset:33792
  v_mul_f32 v107, v107, v29
  v_mfma_f32_16x16x32_bf16 v[180:183], v[56:59], a[132:135], v[180:183]
  v_exp_f32 v88, v88
  v_mfma_f32_16x16x32_bf16 v[184:187], v[56:59], a[136:139], v[184:187]
  v_exp_f32 v89, v89
  v_mfma_f32_16x16x32_bf16 v[188:191], v[56:59], a[140:143], v[188:191]
  v_exp_f32 v90, v90
  v_mfma_f32_16x16x32_bf16 v[192:195], v[60:63], a[128:131], v[192:195]
  v_exp_f32 v91, v91
  v_mfma_f32_16x16x32_bf16 v[196:199], v[60:63], a[132:135], v[196:199]
  v_fma_f32 v88, v88, v33, v33
  v_fma_f32 v89, v89, v33, v33
  v_mfma_f32_16x16x32_bf16 v[200:203], v[60:63], a[136:139], v[200:203]
  v_fma_f32 v90, v90, v33, v33
  v_fma_f32 v91, v91, v33, v33
  v_mfma_f32_16x16x32_bf16 v[204:207], v[60:63], a[140:143], v[204:207]
  s_waitcnt vmcnt(16) lgkmcnt(0)
  s_barrier
  v_mfma_f32_16x16x32_bf16 v[144:147], v[64:67], a[144:147], v[144:147]
  ds_read_b64_tr_b16 v[48:49], v13 offset:24576
  s_add_u32 m0, s68, 32768
  v_mfma_f32_16x16x32_bf16 v[148:151], v[64:67], a[148:151], v[148:151]
  ds_read_b64_tr_b16 v[50:51], v13 offset:28672
  buffer_load_dwordx4 v5, s[28:31], s46 offen lds
  v_mfma_f32_16x16x32_bf16 v[152:155], v[64:67], a[152:155], v[152:155]
  ds_read_b64_tr_b16 v[52:53], v14 offset:24576
  v_mfma_f32_16x16x32_bf16 v[156:159], v[64:67], a[156:159], v[156:159]
  ds_read_b64_tr_b16 v[54:55], v14 offset:28672
  v_mfma_f32_16x16x32_bf16 v[160:163], v[68:71], a[144:147], v[160:163]
  ds_read_b64_tr_b16 v[56:57], v13 offset:25600
  v_mfma_f32_16x16x32_bf16 v[164:167], v[68:71], a[148:151], v[164:167]
  ds_read_b64_tr_b16 v[58:59], v13 offset:29696
  s_add_u32 m0, s68, 36864
  v_mfma_f32_16x16x32_bf16 v[168:171], v[68:71], a[152:155], v[168:171]
  ds_read_b64_tr_b16 v[60:61], v14 offset:25600
  buffer_load_dwordx4 v5, s[28:31], s47 offen lds
  v_mfma_f32_16x16x32_bf16 v[172:175], v[68:71], a[156:159], v[172:175]
  ds_read_b64_tr_b16 v[62:63], v14 offset:29696
  v_mfma_f32_16x16x32_bf16 v[176:179], v[72:75], a[144:147], v[176:179]
  v_rcp_f32 v88, v88
  v_mfma_f32_16x16x32_bf16 v[180:183], v[72:75], a[148:151], v[180:183]
  v_rcp_f32 v89, v89
  v_mfma_f32_16x16x32_bf16 v[184:187], v[72:75], a[152:155], v[184:187]
  s_add_u32 m0, s68, 24576
  v_mul_f32 v120, v120, v88
  v_mfma_f32_16x16x32_bf16 v[188:191], v[72:75], a[156:159], v[188:191]
  buffer_load_dwordx4 v5, s[28:31], s48 offen lds
  v_mul_f32 v121, v121, v89
  v_mfma_f32_16x16x32_bf16 v[192:195], v[76:79], a[144:147], v[192:195]
  v_rcp_f32 v90, v90
  v_mfma_f32_16x16x32_bf16 v[196:199], v[76:79], a[148:151], v[196:199]
  v_rcp_f32 v91, v91
  v_mfma_f32_16x16x32_bf16 v[200:203], v[76:79], a[152:155], v[200:203]
  v_mul_f32 v122, v122, v90
  v_mul_f32 v123, v123, v91
  v_mfma_f32_16x16x32_bf16 v[204:207], v[76:79], a[156:159], v[204:207]
  s_add_u32 m0, s68, 28672
  s_waitcnt lgkmcnt(0)
  v_mfma_f32_16x16x32_bf16 v[144:147], v[48:51], a[160:163], v[144:147]
  ds_read_b64_tr_b16 v[64:65], v13 offset:16384
  buffer_load_dwordx4 v5, s[28:31], s49 offen lds
  v_mfma_f32_16x16x32_bf16 v[148:151], v[48:51], a[164:167], v[148:151]
  ds_read_b64_tr_b16 v[66:67], v13 offset:20480
  v_cvt_pk_bf16_f32 v88, v120, v121
  v_mfma_f32_16x16x32_bf16 v[152:155], v[48:51], a[168:171], v[152:155]
  ds_read_b64_tr_b16 v[68:69], v14 offset:16384
  v_cvt_pk_bf16_f32 v89, v122, v123
  v_mfma_f32_16x16x32_bf16 v[156:159], v[48:51], a[172:175], v[156:159]
  ds_read_b64_tr_b16 v[70:71], v14 offset:20480
  v_mul_f32 v124, v92, v124
  v_mfma_f32_16x16x32_bf16 v[160:163], v[52:55], a[160:163], v[160:163]
  ds_read_b64_tr_b16 v[72:73], v13 offset:17408
  s_add_u32 m0, s68, 16384
  v_mfma_f32_16x16x32_bf16 v[164:167], v[52:55], a[164:167], v[164:167]
  ds_read_b64_tr_b16 v[74:75], v13 offset:21504
  buffer_load_dwordx4 v5, s[28:31], s50 offen lds
  v_mfma_f32_16x16x32_bf16 v[168:171], v[52:55], a[168:171], v[168:171]
  ds_read_b64_tr_b16 v[76:77], v14 offset:17408
  v_mul_f32 v92, v92, v30
  v_mfma_f32_16x16x32_bf16 v[172:175], v[52:55], a[172:175], v[172:175]
  ds_read_b64_tr_b16 v[78:79], v14 offset:21504
  v_mul_f32 v125, v93, v125
  v_mfma_f32_16x16x32_bf16 v[176:179], v[56:59], a[160:163], v[176:179]
  v_exp_f32 v104, v104
  v_mfma_f32_16x16x32_bf16 v[180:183], v[56:59], a[164:167], v[180:183]
  s_add_u32 m0, s68, 20480
  v_fma_f32 v104, v104, v33, v33
  v_mfma_f32_16x16x32_bf16 v[184:187], v[56:59], a[168:171], v[184:187]
  buffer_load_dwordx4 v5, s[28:31], s51 offen lds
  v_mul_f32 v93, v93, v30
  v_mfma_f32_16x16x32_bf16 v[188:191], v[56:59], a[172:175], v[188:191]
  v_exp_f32 v105, v105
  v_mfma_f32_16x16x32_bf16 v[192:195], v[60:63], a[160:163], v[192:195]
  v_exp_f32 v106, v106
  v_mfma_f32_16x16x32_bf16 v[196:199], v[60:63], a[164:167], v[196:199]
  v_exp_f32 v107, v107
  v_mfma_f32_16x16x32_bf16 v[200:203], v[60:63], a[168:171], v[200:203]
  v_fma_f32 v105, v105, v33, v33
  v_fma_f32 v106, v106, v33, v33
  v_mfma_f32_16x16x32_bf16 v[204:207], v[60:63], a[172:175], v[204:207]
  v_fma_f32 v107, v107, v33, v33
  s_waitcnt lgkmcnt(0)
  v_mfma_f32_16x16x32_bf16 v[144:147], v[64:67], a[176:179], v[144:147]
  ds_read_b64_tr_b16 v[48:49], v9 offset:49152
  v_mul_f32 v126, v94, v126
  v_mfma_f32_16x16x32_bf16 v[148:151], v[64:67], a[180:183], v[148:151]
  ds_read_b64_tr_b16 v[50:51], v9 offset:53248
  v_mul_f32 v94, v94, v30
  v_mfma_f32_16x16x32_bf16 v[152:155], v[64:67], a[184:187], v[152:155]
  ds_read_b64_tr_b16 v[52:53], v10 offset:49152
  v_mul_f32 v127, v95, v127
  v_mfma_f32_16x16x32_bf16 v[156:159], v[64:67], a[188:191], v[156:159]
  ds_read_b64_tr_b16 v[54:55], v10 offset:53248
  v_mul_f32 v95, v95, v30
  v_mfma_f32_16x16x32_bf16 v[160:163], v[68:71], a[176:179], v[160:163]
  ds_read_b64_tr_b16 v[56:57], v9 offset:50176
  v_mfma_f32_16x16x32_bf16 v[164:167], v[68:71], a[180:183], v[164:167]
  ds_read_b64_tr_b16 v[58:59], v9 offset:54272
  v_mfma_f32_16x16x32_bf16 v[168:171], v[68:71], a[184:187], v[168:171]
  ds_read_b64_tr_b16 v[60:61], v10 offset:50176
  v_mfma_f32_16x16x32_bf16 v[172:175], v[68:71], a[188:191], v[172:175]
  ds_read_b64_tr_b16 v[62:63], v10 offset:54272
  v_mfma_f32_16x16x32_bf16 v[176:179], v[72:75], a[176:179], v[176:179]
  v_rcp_f32 v104, v104
  v_mfma_f32_16x16x32_bf16 v[180:183], v[72:75], a[180:183], v[180:183]
  v_rcp_f32 v105, v105
  v_mfma_f32_16x16x32_bf16 v[184:187], v[72:75], a[184:187], v[184:187]
  v_rcp_f32 v106, v106
  v_mfma_f32_16x16x32_bf16 v[188:191], v[72:75], a[188:191], v[188:191]
  v_rcp_f32 v107, v107
  v_mfma_f32_16x16x32_bf16 v[192:195], v[76:79], a[176:179], v[192:195]
  v_mul_f32 v136, v136, v104
  v_mul_f32 v137, v137, v105
  v_mfma_f32_16x16x32_bf16 v[196:199], v[76:79], a[180:183], v[196:199]
  v_mul_f32 v138, v138, v106
  v_mul_f32 v139, v139, v107
  v_mfma_f32_16x16x32_bf16 v[200:203], v[76:79], a[184:187], v[200:203]
  v_cvt_pk_bf16_f32 v90, v136, v137
  v_cvt_pk_bf16_f32 v91, v138, v139
  v_mfma_f32_16x16x32_bf16 v[204:207], v[76:79], a[188:191], v[204:207]
  s_waitcnt vmcnt(16) lgkmcnt(0)
  s_barrier
  v_mfma_f32_16x16x32_bf16 v[144:147], v[48:51], a[192:195], v[144:147]
  ds_read_b64_tr_b16 v[64:65], v9 offset:8192
  s_add_u32 m0, s68, 155648
  v_mfma_f32_16x16x32_bf16 v[148:151], v[48:51], a[196:199], v[148:151]
  ds_read_b64_tr_b16 v[66:67], v9 offset:12288
  buffer_load_dwordx4 v5, s[28:31], s52 offen lds
  v_mfma_f32_16x16x32_bf16 v[152:155], v[48:51], a[200:203], v[152:155]
  ds_read_b64_tr_b16 v[68:69], v10 offset:8192
  v_mul_f32 v140, v108, v140
  v_mfma_f32_16x16x32_bf16 v[156:159], v[48:51], a[204:207], v[156:159]
  ds_read_b64_tr_b16 v[70:71], v10 offset:12288
  v_mul_f32 v108, v108, v30
  v_mfma_f32_16x16x32_bf16 v[160:163], v[52:55], a[192:195], v[160:163]
  ds_read_b64_tr_b16 v[72:73], v9 offset:9216
  v_mul_f32 v141, v109, v141
  v_mfma_f32_16x16x32_bf16 v[164:167], v[52:55], a[196:199], v[164:167]
  ds_read_b64_tr_b16 v[74:75], v9 offset:13312
  s_add_u32 m0, s68, 159744
  v_mfma_f32_16x16x32_bf16 v[168:171], v[52:55], a[200:203], v[168:171]
  ds_read_b64_tr_b16 v[76:77], v10 offset:9216
  buffer_load_dwordx4 v5, s[28:31], s53 offen lds
  v_mfma_f32_16x16x32_bf16 v[172:175], v[52:55], a[204:207], v[172:175]
  ds_read_b64_tr_b16 v[78:79], v10 offset:13312
  v_mul_f32 v109, v109, v30
  v_mfma_f32_16x16x32_bf16 v[176:179], v[56:59], a[192:195], v[176:179]
  ds_write_b128 v21, v[88:91] offset:34816
  v_mul_f32 v142, v110, v142
  v_mfma_f32_16x16x32_bf16 v[180:183], v[56:59], a[196:199], v[180:183]
  v_exp_f32 v92, v92
  v_mfma_f32_16x16x32_bf16 v[184:187], v[56:59], a[200:203], v[184:187]
  s_add_u32 m0, s68, 49152
  v_fma_f32 v92, v92, v34, v34
  v_mfma_f32_16x16x32_bf16 v[188:191], v[56:59], a[204:207], v[188:191]
  buffer_load_dwordx4 v5, s[28:31], s54 offen lds
  v_mul_f32 v110, v110, v30
  v_mfma_f32_16x16x32_bf16 v[192:195], v[60:63], a[192:195], v[192:195]
  v_exp_f32 v93, v93
  v_mfma_f32_16x16x32_bf16 v[196:199], v[60:63], a[196:199], v[196:199]
  v_exp_f32 v94, v94
  v_mfma_f32_16x16x32_bf16 v[200:203], v[60:63], a[200:203], v[200:203]
  v_exp_f32 v95, v95
  v_mfma_f32_16x16x32_bf16 v[204:207], v[60:63], a[204:207], v[204:207]
  s_add_u32 m0, s68, 53248
  s_waitcnt lgkmcnt(1)
  v_mfma_f32_16x16x32_bf16 v[144:147], v[64:67], a[208:211], v[144:147]
  ds_read_b64_tr_b16 v[48:49], v13 offset:8192
  buffer_load_dwordx4 v5, s[28:31], s55 offen lds
  v_mfma_f32_16x16x32_bf16 v[148:151], v[64:67], a[212:215], v[148:151]
  ds_read_b64_tr_b16 v[50:51], v13 offset:12288
  v_fma_f32 v93, v93, v34, v34
  v_mfma_f32_16x16x32_bf16 v[152:155], v[64:67], a[216:219], v[152:155]
  ds_read_b64_tr_b16 v[52:53], v14 offset:8192
  v_fma_f32 v94, v94, v34, v34
  v_mfma_f32_16x16x32_bf16 v[156:159], v[64:67], a[220:223], v[156:159]
  ds_read_b64_tr_b16 v[54:55], v14 offset:12288
  v_fma_f32 v95, v95, v34, v34
  v_mfma_f32_16x16x32_bf16 v[160:163], v[68:71], a[208:211], v[160:163]
  ds_read_b64_tr_b16 v[56:57], v13 offset:9216
  v_mul_f32 v143, v111, v143
  v_mfma_f32_16x16x32_bf16 v[164:167], v[68:71], a[212:215], v[164:167]
  ds_read_b64_tr_b16 v[58:59], v13 offset:13312
  v_mul_f32 v111, v111, v30
  v_mfma_f32_16x16x32_bf16 v[168:171], v[68:71], a[216:219], v[168:171]
  ds_read_b64_tr_b16 v[60:61], v14 offset:9216
  v_mfma_f32_16x16x32_bf16 v[172:175], v[68:71], a[220:223], v[172:175]
  ds_read_b64_tr_b16 v[62:63], v14 offset:13312
  v_mfma_f32_16x16x32_bf16 v[176:179], v[72:75], a[208:211], v[176:179]
  v_rcp_f32 v92, v92
  v_mfma_f32_16x16x32_bf16 v[180:183], v[72:75], a[212:215], v[180:183]
  v_rcp_f32 v93, v93
  v_mfma_f32_16x16x32_bf16 v[184:187], v[72:75], a[216:219], v[184:187]
  v_rcp_f32 v94, v94
  v_mfma_f32_16x16x32_bf16 v[188:191], v[72:75], a[220:223], v[188:191]
  v_rcp_f32 v95, v95
  v_mfma_f32_16x16x32_bf16 v[192:195], v[76:79], a[208:211], v[192:195]
  v_mul_f32 v124, v124, v92
  v_mul_f32 v125, v125, v93
  v_mfma_f32_16x16x32_bf16 v[196:199], v[76:79], a[212:215], v[196:199]
  v_mul_f32 v126, v126, v94
  v_mul_f32 v127, v127, v95
  v_mfma_f32_16x16x32_bf16 v[200:203], v[76:79], a[216:219], v[200:203]
  v_cvt_pk_bf16_f32 v92, v124, v125
  v_cvt_pk_bf16_f32 v93, v126, v127
  v_mfma_f32_16x16x32_bf16 v[204:207], v[76:79], a[220:223], v[204:207]
  s_waitcnt lgkmcnt(0)
  v_mfma_f32_16x16x32_bf16 v[144:147], v[48:51], a[224:227], v[144:147]
  ds_read_b64_tr_b16 v[64:65], v11 offset:16384
  v_mfma_f32_16x16x32_bf16 v[148:151], v[48:51], a[228:231], v[148:151]
  ds_read_b64_tr_b16 v[66:67], v11 offset:20480
  v_mfma_f32_16x16x32_bf16 v[152:155], v[48:51], a[232:235], v[152:155]
  ds_read_b64_tr_b16 v[68:69], v12 offset:16384
  v_mfma_f32_16x16x32_bf16 v[156:159], v[48:51], a[236:239], v[156:159]
  ds_read_b64_tr_b16 v[70:71], v12 offset:20480
  v_mfma_f32_16x16x32_bf16 v[160:163], v[52:55], a[224:227], v[160:163]
  ds_read_b64_tr_b16 v[72:73], v11 offset:17408
  v_mfma_f32_16x16x32_bf16 v[164:167], v[52:55], a[228:231], v[164:167]
  ds_read_b64_tr_b16 v[74:75], v11 offset:21504
  v_mfma_f32_16x16x32_bf16 v[168:171], v[52:55], a[232:235], v[168:171]
  ds_read_b64_tr_b16 v[76:77], v12 offset:17408
  v_mfma_f32_16x16x32_bf16 v[172:175], v[52:55], a[236:239], v[172:175]
  ds_read_b64_tr_b16 v[78:79], v12 offset:21504
  v_mfma_f32_16x16x32_bf16 v[176:179], v[56:59], a[224:227], v[176:179]
  v_exp_f32 v108, v108
  v_mfma_f32_16x16x32_bf16 v[180:183], v[56:59], a[228:231], v[180:183]
  v_exp_f32 v109, v109
  v_mfma_f32_16x16x32_bf16 v[184:187], v[56:59], a[232:235], v[184:187]
  v_exp_f32 v110, v110
  v_mfma_f32_16x16x32_bf16 v[188:191], v[56:59], a[236:239], v[188:191]
  v_exp_f32 v111, v111
  v_mfma_f32_16x16x32_bf16 v[192:195], v[60:63], a[224:227], v[192:195]
  v_fma_f32 v108, v108, v34, v34
  v_fma_f32 v109, v109, v34, v34
  v_mfma_f32_16x16x32_bf16 v[196:199], v[60:63], a[228:231], v[196:199]
  v_fma_f32 v110, v110, v34, v34
  v_fma_f32 v111, v111, v34, v34
  v_mfma_f32_16x16x32_bf16 v[200:203], v[60:63], a[232:235], v[200:203]
  v_rcp_f32 v108, v108
  v_mfma_f32_16x16x32_bf16 v[204:207], v[60:63], a[236:239], v[204:207]
  s_waitcnt vmcnt(14) lgkmcnt(0)
  s_barrier
  v_mfma_f32_16x16x32_bf16 v[144:147], v[64:67], a[240:243], v[144:147]
  ds_read_b64_tr_b16 v[48:49], v11 offset:8192
  s_add_u32 m0, s68, 81920
  v_mfma_f32_16x16x32_bf16 v[148:151], v[64:67], a[244:247], v[148:151]
  ds_read_b64_tr_b16 v[50:51], v11 offset:12288
  buffer_load_dwordx4 v5, s[28:31], s56 offen lds
  v_mfma_f32_16x16x32_bf16 v[152:155], v[64:67], a[248:251], v[152:155]
  ds_read_b64_tr_b16 v[52:53], v12 offset:8192
  v_mul_f32 v140, v140, v108
  v_mfma_f32_16x16x32_bf16 v[156:159], v[64:67], a[252:255], v[156:159]
  ds_read_b64_tr_b16 v[54:55], v12 offset:12288
  v_mfma_f32_16x16x32_bf16 v[160:163], v[68:71], a[240:243], v[160:163]
  ds_read_b64_tr_b16 v[56:57], v11 offset:9216
  v_mfma_f32_16x16x32_bf16 v[164:167], v[68:71], a[244:247], v[164:167]
  ds_read_b64_tr_b16 v[58:59], v11 offset:13312
  s_add_u32 m0, s68, 86016
  v_mfma_f32_16x16x32_bf16 v[168:171], v[68:71], a[248:251], v[168:171]
  ds_read_b64_tr_b16 v[60:61], v12 offset:9216
  buffer_load_dwordx4 v5, s[28:31], s57 offen lds
  v_mfma_f32_16x16x32_bf16 v[172:175], v[68:71], a[252:255], v[172:175]
  ds_read_b64_tr_b16 v[62:63], v12 offset:13312
  v_mfma_f32_16x16x32_bf16 v[176:179], v[72:75], a[240:243], v[176:179]
  v_rcp_f32 v109, v109
  v_mfma_f32_16x16x32_bf16 v[180:183], v[72:75], a[244:247], v[180:183]
  v_rcp_f32 v110, v110
  v_mfma_f32_16x16x32_bf16 v[184:187], v[72:75], a[248:251], v[184:187]
  s_add_u32 m0, s67, 8192
  v_mul_f32 v141, v141, v109
  v_mfma_f32_16x16x32_bf16 v[188:191], v[72:75], a[252:255], v[188:191]
  buffer_load_dwordx4 v6, s[32:35], s58 offen lds
  v_mul_f32 v142, v142, v110
  v_mfma_f32_16x16x32_bf16 v[192:195], v[76:79], a[240:243], v[192:195]
  v_rcp_f32 v111, v111
  v_mfma_f32_16x16x32_bf16 v[196:199], v[76:79], a[244:247], v[196:199]
  v_mul_f32 v143, v143, v111
  v_cvt_pk_bf16_f32 v94, v140, v141
  v_mfma_f32_16x16x32_bf16 v[200:203], v[76:79], a[248:251], v[200:203]
  v_cvt_pk_bf16_f32 v95, v142, v143
  v_mfma_f32_16x16x32_bf16 v[204:207], v[76:79], a[252:255], v[204:207]
  s_waitcnt lgkmcnt(0)
  v_mfma_f32_16x16x32_bf16 v[144:147], v[48:51], v[208:211], v[144:147]
  ds_read_b64_tr_b16 v[64:65], v9 offset:0
  buffer_load_dwordx4 v6, s[36:39], s59 offen offset:1024 lds
  v_mfma_f32_16x16x32_bf16 v[148:151], v[48:51], v[212:215], v[148:151]
  ds_read_b64_tr_b16 v[66:67], v9 offset:4096
  v_mfma_f32_16x16x32_bf16 v[152:155], v[48:51], v[216:219], v[152:155]
  ds_read_b64_tr_b16 v[68:69], v10 offset:0
  v_mfma_f32_16x16x32_bf16 v[156:159], v[48:51], v[220:223], v[156:159]
  ds_read_b64_tr_b16 v[70:71], v10 offset:4096
  v_mfma_f32_16x16x32_bf16 v[160:163], v[52:55], v[208:211], v[160:163]
  ds_read_b64_tr_b16 v[72:73], v9 offset:1024
  v_mfma_f32_16x16x32_bf16 v[164:167], v[52:55], v[212:215], v[164:167]
  ds_read_b64_tr_b16 v[74:75], v9 offset:5120
  v_mfma_f32_16x16x32_bf16 v[168:171], v[52:55], v[216:219], v[168:171]
  ds_read_b64_tr_b16 v[76:77], v10 offset:1024
  v_mfma_f32_16x16x32_bf16 v[172:175], v[52:55], v[220:223], v[172:175]
  ds_read_b64_tr_b16 v[78:79], v10 offset:5120
  v_mfma_f32_16x16x32_bf16 v[176:179], v[56:59], v[208:211], v[176:179]
  ds_write_b128 v21, v[92:95] offset:35840
  v_mfma_f32_16x16x32_bf16 v[180:183], v[56:59], v[212:215], v[180:183]
  v_mfma_f32_16x16x32_bf16 v[184:187], v[56:59], v[216:219], v[184:187]
  v_mfma_f32_16x16x32_bf16 v[188:191], v[56:59], v[220:223], v[188:191]
  v_mfma_f32_16x16x32_bf16 v[192:195], v[60:63], v[208:211], v[192:195]
  v_mfma_f32_16x16x32_bf16 v[196:199], v[60:63], v[212:215], v[196:199]
  v_mfma_f32_16x16x32_bf16 v[200:203], v[60:63], v[216:219], v[200:203]
  v_mfma_f32_16x16x32_bf16 v[204:207], v[60:63], v[220:223], v[204:207]
  s_waitcnt lgkmcnt(1)
  v_mfma_f32_16x16x32_bf16 v[144:147], v[64:67], v[224:227], v[144:147]
  ds_read_b64_tr_b16 v[48:49], v16 offset:0
  v_mfma_f32_16x16x32_bf16 v[148:151], v[64:67], v[228:231], v[148:151]
  ds_read_b64_tr_b16 v[50:51], v16 offset:1024
  v_mfma_f32_16x16x32_bf16 v[152:155], v[64:67], v[232:235], v[152:155]
  ds_read_b64_tr_b16 v[52:53], v16 offset:2048
  v_mfma_f32_16x16x32_bf16 v[156:159], v[64:67], v[236:239], v[156:159]
  ds_read_b64_tr_b16 v[54:55], v16 offset:3072
  v_mfma_f32_16x16x32_bf16 v[160:163], v[68:71], v[224:227], v[160:163]
  ds_read_b64_tr_b16 v[56:57], v16 offset:4096
  v_mfma_f32_16x16x32_bf16 v[164:167], v[68:71], v[228:231], v[164:167]
  ds_read_b64_tr_b16 v[58:59], v16 offset:5120
  v_mfma_f32_16x16x32_bf16 v[168:171], v[68:71], v[232:235], v[168:171]
  ds_read_b64_tr_b16 v[60:61], v16 offset:6144
  v_mfma_f32_16x16x32_bf16 v[172:175], v[68:71], v[236:239], v[172:175]
  ds_read_b64_tr_b16 v[62:63], v16 offset:7168
  v_mfma_f32_16x16x32_bf16 v[176:179], v[72:75], v[224:227], v[176:179]
  v_mfma_f32_16x16x32_bf16 v[180:183], v[72:75], v[228:231], v[180:183]
  v_mfma_f32_16x16x32_bf16 v[184:187], v[72:75], v[232:235], v[184:187]
  v_mfma_f32_16x16x32_bf16 v[188:191], v[72:75], v[236:239], v[188:191]
  v_mfma_f32_16x16x32_bf16 v[192:195], v[76:79], v[224:227], v[192:195]
  v_mfma_f32_16x16x32_bf16 v[196:199], v[76:79], v[228:231], v[196:199]
  v_mfma_f32_16x16x32_bf16 v[200:203], v[76:79], v[232:235], v[200:203]
  v_mfma_f32_16x16x32_bf16 v[204:207], v[76:79], v[236:239], v[204:207]
  s_waitcnt vmcnt(12) lgkmcnt(0)
  s_barrier
  v_mfma_f32_16x16x32_bf16 v[80:83], v[48:51], a[0:3], 0
  ds_read_b64_tr_b16 v[64:65], v15 offset:57344
  s_add_u32 m0, s67, 73728
  v_mfma_f32_16x16x32_bf16 v[84:87], v[48:51], a[4:7], 0
  ds_read_b64_tr_b16 v[66:67], v15 offset:58368
  buffer_load_dwordx4 v6, s[32:35], s60 offen lds
  v_mfma_f32_16x16x32_bf16 v[88:91], v[48:51], a[8:11], 0
  ds_read_b64_tr_b16 v[68:69], v15 offset:59392
  v_mul_f32 v176, v144, v176
  v_mfma_f32_16x16x32_bf16 v[92:95], v[48:51], a[12:15], 0
  ds_read_b64_tr_b16 v[70:71], v15 offset:60416
  v_mul_f32 v144, v144, v27
  v_mfma_f32_16x16x32_bf16 v[96:99], v[52:55], a[0:3], 0
  ds_read_b64_tr_b16 v[72:73], v15 offset:61440
  v_mul_f32 v177, v145, v177
  v_mfma_f32_16x16x32_bf16 v[100:103], v[52:55], a[4:7], 0
  ds_read_b64_tr_b16 v[74:75], v15 offset:62464
  v_mul_f32 v145, v145, v27
  v_mfma_f32_16x16x32_bf16 v[104:107], v[52:55], a[8:11], 0
  ds_read_b64_tr_b16 v[76:77], v15 offset:63488
  buffer_load_dwordx4 v6, s[36:39], s61 offen offset:1024 lds
  v_mfma_f32_16x16x32_bf16 v[108:111], v[52:55], a[12:15], 0
  ds_read_b64_tr_b16 v[78:79], v15 offset:64512
  v_mul_f32 v178, v146, v178
  v_mfma_f32_16x16x32_bf16 v[80:83], v[56:59], a[16:19], v[80:83]
  v_mul_f32 v146, v146, v27
  v_mul_f32 v179, v147, v179
  v_mfma_f32_16x16x32_bf16 v[84:87], v[56:59], a[20:23], v[84:87]
  v_mul_f32 v147, v147, v27
  v_mul_f32 v192, v160, v192
  v_mfma_f32_16x16x32_bf16 v[88:91], v[56:59], a[24:27], v[88:91]
  s_add_u32 m0, s67, 65536
  v_mul_f32 v160, v160, v27
  v_mfma_f32_16x16x32_bf16 v[92:95], v[56:59], a[28:31], v[92:95]
  buffer_load_dwordx4 v6, s[32:35], s62 offen lds
  v_mul_f32 v193, v161, v193
  v_mfma_f32_16x16x32_bf16 v[96:99], v[60:63], a[16:19], v[96:99]
  v_exp_f32 v144, v144
  v_mfma_f32_16x16x32_bf16 v[100:103], v[60:63], a[20:23], v[100:103]
  v_exp_f32 v145, v145
  v_mfma_f32_16x16x32_bf16 v[104:107], v[60:63], a[24:27], v[104:107]
  v_exp_f32 v146, v146
  v_mfma_f32_16x16x32_bf16 v[108:111], v[60:63], a[28:31], v[108:111]
  v_fma_f32 v144, v144, v31, v31
  s_waitcnt lgkmcnt(0)
  v_mfma_f32_16x16x32_bf16 v[80:83], v[64:67], a[32:35], v[80:83]
  ds_read_b64_tr_b16 v[48:49], v15 offset:40960
  ds_read_b64_tr_b16 v[50:51], v15 offset:41984
  v_mfma_f32_16x16x32_bf16 v[84:87], v[64:67], a[36:39], v[84:87]
  ds_read_b64_tr_b16 v[52:53], v15 offset:43008
  buffer_load_dwordx4 v6, s[36:39], s63 offen offset:1024 lds
  v_mfma_f32_16x16x32_bf16 v[88:91], v[64:67], a[40:43], v[88:91]
  ds_read_b64_tr_b16 v[54:55], v15 offset:44032
  v_fma_f32 v145, v145, v31, v31
  v_mfma_f32_16x16x32_bf16 v[92:95], v[64:67], a[44:47], v[92:95]
  ds_read_b64_tr_b16 v[56:57], v15 offset:45056
  v_fma_f32 v146, v146, v31, v31
  v_mfma_f32_16x16x32_bf16 v[96:99], v[68:71], a[32:35], v[96:99]
  ds_read_b64_tr_b16 v[58:59], v15 offset:46080
  v_mul_f32 v161, v161, v27
  v_mfma_f32_16x16x32_bf16 v[100:103], v[68:71], a[36:39], v[100:103]
  ds_read_b64_tr_b16 v[60:61], v15 offset:47104
  s_add_u32 m0, s67, 0
  v_mfma_f32_16x16x32_bf16 v[104:107], v[68:71], a[40:43], v[104:107]
  ds_read_b64_tr_b16 v[62:63], v15 offset:48128
  v_add_u32 v6, 128, v6
  v_mfma_f32_16x16x32_bf16 v[108:111], v[68:71], a[44:47], v[108:111]
  ds_read_b128 a[0:3], v19 offset:24576
  buffer_load_dwordx4 v6, s[32:35], s58 offen lds
  v_mfma_f32_16x16x32_bf16 v[80:83], v[72:75], a[48:51], v[80:83]
  ds_read_b128 a[4:7], v19 offset:25600
  v_mul_f32 v194, v162, v194
  v_mfma_f32_16x16x32_bf16 v[84:87], v[72:75], a[52:55], v[84:87]
  ds_read_b128 a[8:11], v19 offset:26624
  v_mul_f32 v162, v162, v27
  v_mfma_f32_16x16x32_bf16 v[88:91], v[72:75], a[56:59], v[88:91]
  ds_read_b128 a[12:15], v19 offset:27648
  v_mul_f32 v195, v163, v195
  v_mfma_f32_16x16x32_bf16 v[92:95], v[72:75], a[60:63], v[92:95]
  v_exp_f32 v147, v147
  v_mfma_f32_16x16x32_bf16 v[96:99], v[76:79], a[48:51], v[96:99]
  buffer_load_dwordx4 v6, s[36:39], s59 offen offset:1024 lds
  v_fma_f32 v147, v147, v31, v31
  v_mfma_f32_16x16x32_bf16 v[100:103], v[76:79], a[52:55], v[100:103]
  v_rcp_f32 v144, v144
  v_mfma_f32_16x16x32_bf16 v[104:107], v[76:79], a[56:59], v[104:107]
  v_rcp_f32 v145, v145
  v_mfma_f32_16x16x32_bf16 v[108:111], v[76:79], a[60:63], v[108:111]
  v_mul_f32 v176, v176, v144
  s_waitcnt lgkmcnt(0)
  v_mfma_f32_16x16x32_bf16 v[80:83], v[48:51], a[64:67], v[80:83]
  ds_read_b64_tr_b16 v[64:65], v15 offset:32768
  ds_read_b64_tr_b16 v[66:67], v15 offset:33792
  v_mfma_f32_16x16x32_bf16 v[84:87], v[48:51], a[68:71], v[84:87]
  ds_read_b64_tr_b16 v[68:69], v15 offset:34816
  v_mul_f32 v177, v177, v145
  v_mfma_f32_16x16x32_bf16 v[88:91], v[48:51], a[72:75], v[88:91]
  ds_read_b64_tr_b16 v[70:71], v15 offset:35840
  v_cvt_pk_bf16_f32 v144, v176, v177
  v_mfma_f32_16x16x32_bf16 v[92:95], v[48:51], a[76:79], v[92:95]
  ds_read_b64_tr_b16 v[72:73], v15 offset:36864
  v_mul_f32 v163, v163, v27
  v_mfma_f32_16x16x32_bf16 v[96:99], v[52:55], a[64:67], v[96:99]
  ds_read_b64_tr_b16 v[74:75], v15 offset:37888
  v_mul_f32 v180, v148, v180
  v_mfma_f32_16x16x32_bf16 v[100:103], v[52:55], a[68:71], v[100:103]
  ds_read_b64_tr_b16 v[76:77], v15 offset:38912
  v_mul_f32 v148, v148, v28
  v_mfma_f32_16x16x32_bf16 v[104:107], v[52:55], a[72:75], v[104:107]
  ds_read_b64_tr_b16 v[78:79], v15 offset:39936
  v_mul_f32 v181, v149, v181
  v_mfma_f32_16x16x32_bf16 v[108:111], v[52:55], a[76:79], v[108:111]
  ds_read_b128 a[16:19], v19 offset:32768
  v_mul_f32 v149, v149, v28
  v_mfma_f32_16x16x32_bf16 v[80:83], v[56:59], a[80:83], v[80:83]
  ds_read_b128 a[20:23], v19 offset:33792
  v_mul_f32 v182, v150, v182
  v_mfma_f32_16x16x32_bf16 v[84:87], v[56:59], a[84:87], v[84:87]
  ds_read_b128 a[24:27], v19 offset:34816
  v_mul_f32 v150, v150, v28
  v_mfma_f32_16x16x32_bf16 v[88:91], v[56:59], a[88:91], v[88:91]
  ds_read_b128 a[28:31], v19 offset:35840
  v_mul_f32 v183, v151, v183
  v_mfma_f32_16x16x32_bf16 v[92:95], v[56:59], a[92:95], v[92:95]
  v_rcp_f32 v146, v146
  v_mfma_f32_16x16x32_bf16 v[96:99], v[60:63], a[80:83], v[96:99]
  v_rcp_f32 v147, v147
  v_mfma_f32_16x16x32_bf16 v[100:103], v[60:63], a[84:87], v[100:103]
  v_mul_f32 v178, v178, v146
  v_mul_f32 v179, v179, v147
  v_mfma_f32_16x16x32_bf16 v[104:107], v[60:63], a[88:91], v[104:107]
  v_cvt_pk_bf16_f32 v145, v178, v179
  v_mul_f32 v151, v151, v28
  v_mfma_f32_16x16x32_bf16 v[108:111], v[60:63], a[92:95], v[108:111]
  s_waitcnt vmcnt(12) lgkmcnt(0)
  s_barrier
  v_mfma_f32_16x16x32_bf16 v[80:83], v[64:67], a[96:99], v[80:83]
  ds_read_b64_tr_b16 v[48:49], v15 offset:24576
  ds_read_b64_tr_b16 v[50:51], v15 offset:25600
  v_mfma_f32_16x16x32_bf16 v[84:87], v[64:67], a[100:103], v[84:87]
  ds_read_b64_tr_b16 v[52:53], v15 offset:26624
  s_add_u32 m0, s67, 98304
  v_mfma_f32_16x16x32_bf16 v[88:91], v[64:67], a[104:107], v[88:91]
  ds_read_b64_tr_b16 v[54:55], v15 offset:27648
  buffer_load_dwordx4 v6, s[32:35], s60 offen lds
  v_mfma_f32_16x16x32_bf16 v[92:95], v[64:67], a[108:111], v[92:95]
  ds_read_b64_tr_b16 v[56:57], v15 offset:28672
  v_mfma_f32_16x16x32_bf16 v[96:99], v[68:71], a[96:99], v[96:99]
  ds_read_b64_tr_b16 v[58:59], v15 offset:29696
  v_mfma_f32_16x16x32_bf16 v[100:103], v[68:71], a[100:103], v[100:103]
  ds_read_b64_tr_b16 v[60:61], v15 offset:30720
  v_mfma_f32_16x16x32_bf16 v[104:107], v[68:71], a[104:107], v[104:107]
  ds_read_b64_tr_b16 v[62:63], v15 offset:31744
  v_mfma_f32_16x16x32_bf16 v[108:111], v[68:71], a[108:111], v[108:111]
  ds_read_b128 a[32:35], v19 offset:40960
  buffer_load_dwordx4 v6, s[36:39], s61 offen offset:1024 lds
  v_mfma_f32_16x16x32_bf16 v[80:83], v[72:75], a[112:115], v[80:83]
  ds_read_b128 a[36:39], v19 offset:41984
  v_mfma_f32_16x16x32_bf16 v[84:87], v[72:75], a[116:119], v[84:87]
  ds_read_b128 a[40:43], v19 offset:43008
  v_mfma_f32_16x16x32_bf16 v[88:91], v[72:75], a[120:123], v[88:91]
  ds_read_b128 a[44:47], v19 offset:44032
  v_mfma_f32_16x16x32_bf16 v[92:95], v[72:75], a[124:127], v[92:95]
  s_add_u32 m0, s67, 90112
  v_mfma_f32_16x16x32_bf16 v[96:99], v[76:79], a[112:115], v[96:99]
  buffer_load_dwordx4 v6, s[32:35], s62 offen lds
  v_mfma_f32_16x16x32_bf16 v[100:103], v[76:79], a[116:119], v[100:103]
  v_exp_f32 v160, v160
  v_mfma_f32_16x16x32_bf16 v[104:107], v[76:79], a[120:123], v[104:107]
  v_exp_f32 v161, v161
  v_mfma_f32_16x16x32_bf16 v[108:111], v[76:79], a[124:127], v[108:111]
  v_fma_f32 v160, v160, v31, v31
  s_waitcnt lgkmcnt(0)
  v_mfma_f32_16x16x32_bf16 v[80:83], v[48:51], a[128:131], v[80:83]
  ds_read_b64_tr_b16 v[64:65], v15 offset:16384
  ds_read_b64_tr_b16 v[66:67], v15 offset:17408
  v_mfma_f32_16x16x32_bf16 v[84:87], v[48:51], a[132:135], v[84:87]
  ds_read_b64_tr_b16 v[68:69], v15 offset:18432
  buffer_load_dwordx4 v6, s[36:39], s63 offen offset:1024 lds
  v_mfma_f32_16x16x32_bf16 v[88:91], v[48:51], a[136:139], v[88:91]
  ds_read_b64_tr_b16 v[70:71], v15 offset:19456
  v_fma_f32 v161, v161, v31, v31
  v_mfma_f32_16x16x32_bf16 v[92:95], v[48:51], a[140:143], v[92:95]
  ds_read_b64_tr_b16 v[72:73], v15 offset:20480
  v_mfma_f32_16x16x32_bf16 v[96:99], v[52:55], a[128:131], v[96:99]
  ds_read_b64_tr_b16 v[74:75], v15 offset:21504
  v_mfma_f32_16x16x32_bf16 v[100:103], v[52:55], a[132:135], v[100:103]
  ds_read_b64_tr_b16 v[76:77], v15 offset:22528
  s_add_u32 m0, s67, 57344
  v_mfma_f32_16x16x32_bf16 v[104:107], v[52:55], a[136:139], v[104:107]
  ds_read_b64_tr_b16 v[78:79], v15 offset:23552
  v_add_u32 v6, 4294967168, v6
  v_mfma_f32_16x16x32_bf16 v[108:111], v[52:55], a[140:143], v[108:111]
  ds_read_b128 a[48:51], v19 offset:49152
  buffer_load_dwordx4 v6, s[32:35], s64 offen lds
  v_mfma_f32_16x16x32_bf16 v[80:83], v[56:59], a[144:147], v[80:83]
  ds_read_b128 a[52:55], v19 offset:50176
  v_mfma_f32_16x16x32_bf16 v[84:87], v[56:59], a[148:151], v[84:87]
  ds_read_b128 a[56:59], v19 offset:51200
  v_mfma_f32_16x16x32_bf16 v[88:91], v[56:59], a[152:155], v[88:91]
  ds_read_b128 a[60:63], v19 offset:52224
  v_mfma_f32_16x16x32_bf16 v[92:95], v[56:59], a[156:159], v[92:95]
  v_exp_f32 v162, v162
  v_mfma_f32_16x16x32_bf16 v[96:99], v[60:63], a[144:147], v[96:99]
  buffer_load_dwordx4 v6, s[36:39], s65 offen offset:1024 lds
  v_fma_f32 v162, v162, v31, v31
  v_mfma_f32_16x16x32_bf16 v[100:103], v[60:63], a[148:151], v[100:103]
  v_exp_f32 v163, v163
  v_mfma_f32_16x16x32_bf16 v[104:107], v[60:63], a[152:155], v[104:107]
  v_fma_f32 v163, v163, v31, v31
  v_mfma_f32_16x16x32_bf16 v[108:111], v[60:63], a[156:159], v[108:111]
  s_waitcnt lgkmcnt(0)
  v_mfma_f32_16x16x32_bf16 v[80:83], v[64:67], a[160:163], v[80:83]
  ds_read_b64_tr_b16 v[48:49], v17 offset:24576
  ds_read_b64_tr_b16 v[50:51], v17 offset:25600
  v_mfma_f32_16x16x32_bf16 v[84:87], v[64:67], a[164:167], v[84:87]
  ds_read_b64_tr_b16 v[52:53], v17 offset:26624
  s_add_u32 m0, s67, 40960
  v_mfma_f32_16x16x32_bf16 v[88:91], v[64:67], a[168:171], v[88:91]
  ds_read_b64_tr_b16 v[54:55], v17 offset:27648
  v_add_u32 v6, 128, v6
  v_mfma_f32_16x16x32_bf16 v[92:95], v[64:67], a[172:175], v[92:95]
  ds_read_b64_tr_b16 v[56:57], v17 offset:28672
  buffer_load_dwordx4 v6, s[32:35], s64 offen lds
  v_mfma_f32_16x16x32_bf16 v[96:99], v[68:71], a[160:163], v[96:99]
  ds_read_b64_tr_b16 v[58:59], v17 offset:29696
  v_mfma_f32_16x16x32_bf16 v[100:103], v[68:71], a[164:167], v[100:103]
  ds_read_b64_tr_b16 v[60:61], v17 offset:30720
  v_mfma_f32_16x16x32_bf16 v[104:107], v[68:71], a[168:171], v[104:107]
  ds_read_b64_tr_b16 v[62:63], v17 offset:31744
  v_mfma_f32_16x16x32_bf16 v[108:111], v[68:71], a[172:175], v[108:111]
  ds_read_b128 a[64:67], v19 offset:57344
  v_mfma_f32_16x16x32_bf16 v[80:83], v[72:75], a[176:179], v[80:83]
  ds_read_b128 a[68:71], v19 offset:58368
  buffer_load_dwordx4 v6, s[36:39], s65 offen offset:1024 lds
  v_mfma_f32_16x16x32_bf16 v[84:87], v[72:75], a[180:183], v[84:87]
  ds_read_b128 a[72:75], v19 offset:59392
  v_mfma_f32_16x16x32_bf16 v[88:91], v[72:75], a[184:187], v[88:91]
  ds_read_b128 a[76:79], v19 offset:60416
  v_mfma_f32_16x16x32_bf16 v[92:95], v[72:75], a[188:191], v[92:95]
  v_rcp_f32 v160, v160
  v_mfma_f32_16x16x32_bf16 v[96:99], v[76:79], a[176:179], v[96:99]
  s_add_u32 m0, s67, 32768
  v_add_u32 v6, 4294967168, v6
  v_mfma_f32_16x16x32_bf16 v[100:103], v[76:79], a[180:183], v[100:103]
  buffer_load_dwordx4 v6, s[32:35], s66 offen lds
  v_mul_f32 v192, v192, v160
  v_mfma_f32_16x16x32_bf16 v[104:107], v[76:79], a[184:187], v[104:107]
  v_rcp_f32 v161, v161
  v_mfma_f32_16x16x32_bf16 v[108:111], v[76:79], a[188:191], v[108:111]
  s_waitcnt vmcnt(15) lgkmcnt(0)
  s_barrier
  v_mfma_f32_16x16x32_bf16 v[80:83], v[48:51], a[192:195], v[80:83]
  ds_read_b64_tr_b16 v[64:65], v15 offset:49152
  ds_read_b64_tr_b16 v[66:67], v15 offset:50176
  v_mfma_f32_16x16x32_bf16 v[84:87], v[48:51], a[196:199], v[84:87]
  ds_read_b64_tr_b16 v[68:69], v15 offset:51200
  v_add_u32 v6, 128, v6
  v_mfma_f32_16x16x32_bf16 v[88:91], v[48:51], a[200:203], v[88:91]
  ds_read_b64_tr_b16 v[70:71], v15 offset:52224
  buffer_load_dwordx4 v6, s[36:39], s66 offen offset:1024 lds
  v_mfma_f32_16x16x32_bf16 v[92:95], v[48:51], a[204:207], v[92:95]
  ds_read_b64_tr_b16 v[72:73], v15 offset:53248
  v_mul_f32 v193, v193, v161
  v_mfma_f32_16x16x32_bf16 v[96:99], v[52:55], a[192:195], v[96:99]
  ds_read_b64_tr_b16 v[74:75], v15 offset:54272
  v_cvt_pk_bf16_f32 v146, v192, v193
  v_mfma_f32_16x16x32_bf16 v[100:103], v[52:55], a[196:199], v[100:103]
  ds_read_b64_tr_b16 v[76:77], v15 offset:55296
  v_mul_f32 v196, v164, v196
  v_mfma_f32_16x16x32_bf16 v[104:107], v[52:55], a[200:203], v[104:107]
  ds_read_b64_tr_b16 v[78:79], v15 offset:56320
  s_add_u32 m0, s67, 122880
  v_mfma_f32_16x16x32_bf16 v[108:111], v[52:55], a[204:207], v[108:111]
  ds_read_b128 a[80:83], v20 offset:0
  v_add_u32 v6, 128, v6
  v_mfma_f32_16x16x32_bf16 v[80:83], v[56:59], a[208:211], v[80:83]
  ds_read_b128 a[84:87], v20 offset:1024
  buffer_load_dwordx4 v6, s[32:35], s58 offen lds
  v_mfma_f32_16x16x32_bf16 v[84:87], v[56:59], a[212:215], v[84:87]
  ds_read_b128 a[88:91], v20 offset:2048
  v_mul_f32 v164, v164, v28
  v_mfma_f32_16x16x32_bf16 v[88:91], v[56:59], a[216:219], v[88:91]
  ds_read_b128 a[92:95], v20 offset:3072
  v_mul_f32 v197, v165, v197
  v_mfma_f32_16x16x32_bf16 v[92:95], v[56:59], a[220:223], v[92:95]
  v_rcp_f32 v162, v162
  v_mfma_f32_16x16x32_bf16 v[96:99], v[60:63], a[208:211], v[96:99]
  v_rcp_f32 v163, v163
  v_mfma_f32_16x16x32_bf16 v[100:103], v[60:63], a[212:215], v[100:103]
  buffer_load_dwordx4 v6, s[36:39], s59 offen offset:1024 lds
  v_mul_f32 v194, v194, v162
  v_mfma_f32_16x16x32_bf16 v[104:107], v[60:63], a[216:219], v[104:107]
  v_mul_f32 v195, v195, v163
  v_cvt_pk_bf16_f32 v147, v194, v195
  v_mfma_f32_16x16x32_bf16 v[108:111], v[60:63], a[220:223], v[108:111]
  v_mul_f32 v165, v165, v28
  s_waitcnt lgkmcnt(0)
  v_mfma_f32_16x16x32_bf16 v[80:83], v[64:67], a[224:227], v[80:83]
  ds_read_b64_tr_b16 v[48:49], v16 offset:16384
  v_mul_f32 v198, v166, v198
  v_mfma_f32_16x16x32_bf16 v[84:87], v[64:67], a[228:231], v[84:87]
  ds_read_b64_tr_b16 v[50:51], v16 offset:17408
  s_add_u32 m0, s67, 114688
  v_mfma_f32_16x16x32_bf16 v[88:91], v[64:67], a[232:235], v[88:91]
  ds_read_b64_tr_b16 v[52:53], v16 offset:18432
  buffer_load_dwordx4 v6, s[32:35], s60 offen lds
  v_mfma_f32_16x16x32_bf16 v[92:95], v[64:67], a[236:239], v[92:95]
  ds_read_b64_tr_b16 v[54:55], v16 offset:19456
  v_mul_f32 v166, v166, v28
  v_mfma_f32_16x16x32_bf16 v[96:99], v[68:71], a[224:227], v[96:99]
  ds_read_b64_tr_b16 v[56:57], v16 offset:20480
  v_mul_f32 v199, v167, v199
  v_mfma_f32_16x16x32_bf16 v[100:103], v[68:71], a[228:231], v[100:103]
  ds_read_b64_tr_b16 v[58:59], v16 offset:21504
  v_mul_f32 v167, v167, v28
  v_mfma_f32_16x16x32_bf16 v[104:107], v[68:71], a[232:235], v[104:107]
  ds_read_b64_tr_b16 v[60:61], v16 offset:22528
  v_mfma_f32_16x16x32_bf16 v[108:111], v[68:71], a[236:239], v[108:111]
  ds_read_b64_tr_b16 v[62:63], v16 offset:23552
  buffer_load_dwordx4 v6, s[36:39], s61 offen offset:1024 lds
  v_mfma_f32_16x16x32_bf16 v[80:83], v[72:75], a[240:243], v[80:83]
  ds_write_b128 v21, v[144:147] offset:49152
  v_mfma_f32_16x16x32_bf16 v[84:87], v[72:75], a[244:247], v[84:87]
  v_exp_f32 v148, v148
  v_mfma_f32_16x16x32_bf16 v[88:91], v[72:75], a[248:251], v[88:91]
  v_exp_f32 v149, v149
  v_mfma_f32_16x16x32_bf16 v[92:95], v[72:75], a[252:255], v[92:95]
  s_add_u32 m0, s67, 106496
  v_fma_f32 v148, v148, v32, v32
  v_mfma_f32_16x16x32_bf16 v[96:99], v[76:79], a[240:243], v[96:99]
  buffer_load_dwordx4 v6, s[32:35], s62 offen lds
  v_fma_f32 v149, v149, v32, v32
  v_mfma_f32_16x16x32_bf16 v[100:103], v[76:79], a[244:247], v[100:103]
  v_exp_f32 v150, v150
  v_mfma_f32_16x16x32_bf16 v[104:107], v[76:79], a[248:251], v[104:107]
  v_exp_f32 v151, v151
  v_mfma_f32_16x16x32_bf16 v[108:111], v[76:79], a[252:255], v[108:111]
  v_fma_f32 v150, v150, v32, v32
  s_waitcnt lgkmcnt(1)
  v_mfma_f32_16x16x32_bf16 v[80:83], v[48:51], v[208:211], v[80:83]
  ds_read_b64_tr_b16 v[64:65], v9 offset:8192
  v_fma_f32 v151, v151, v32, v32
  v_mfma_f32_16x16x32_bf16 v[84:87], v[48:51], v[212:215], v[84:87]
  ds_read_b64_tr_b16 v[66:67], v9 offset:12288
  buffer_load_dwordx4 v6, s[36:39], s63 offen offset:1024 lds
  v_mfma_f32_16x16x32_bf16 v[88:91], v[48:51], v[216:219], v[88:91]
  ds_read_b64_tr_b16 v[68:69], v10 offset:8192
  v_mfma_f32_16x16x32_bf16 v[92:95], v[48:51], v[220:223], v[92:95]
  ds_read_b64_tr_b16 v[70:71], v10 offset:12288
  v_mfma_f32_16x16x32_bf16 v[96:99], v[52:55], v[208:211], v[96:99]
  ds_read_b64_tr_b16 v[72:73], v9 offset:9216
  v_mfma_f32_16x16x32_bf16 v[100:103], v[52:55], v[212:215], v[100:103]
  ds_read_b64_tr_b16 v[74:75], v9 offset:13312
  s_add_u32 m0, s67, 24576
  v_mfma_f32_16x16x32_bf16 v[104:107], v[52:55], v[216:219], v[104:107]
  ds_read_b64_tr_b16 v[76:77], v10 offset:9216
  buffer_load_dwordx4 v6, s[32:35], s64 offen lds
  v_mfma_f32_16x16x32_bf16 v[108:111], v[52:55], v[220:223], v[108:111]
  ds_read_b64_tr_b16 v[78:79], v10 offset:13312
  v_mfma_f32_16x16x32_bf16 v[80:83], v[56:59], v[224:227], v[80:83]
  v_rcp_f32 v148, v148
  v_mfma_f32_16x16x32_bf16 v[84:87], v[56:59], v[228:231], v[84:87]
  v_rcp_f32 v149, v149
  v_mfma_f32_16x16x32_bf16 v[88:91], v[56:59], v[232:235], v[88:91]
  v_rcp_f32 v150, v150
  v_mfma_f32_16x16x32_bf16 v[92:95], v[56:59], v[236:239], v[92:95]
  buffer_load_dwordx4 v6, s[36:39], s65 offen offset:1024 lds
  v_mul_f32 v180, v180, v148
  v_mfma_f32_16x16x32_bf16 v[96:99], v[60:63], v[224:227], v[96:99]
  v_rcp_f32 v151, v151
  v_mfma_f32_16x16x32_bf16 v[100:103], v[60:63], v[228:231], v[100:103]
  v_mul_f32 v181, v181, v149
  v_mul_f32 v182, v182, v150
  v_mfma_f32_16x16x32_bf16 v[104:107], v[60:63], v[232:235], v[104:107]
  v_mul_f32 v183, v183, v151
  v_cvt_pk_bf16_f32 v148, v180, v181
  v_mfma_f32_16x16x32_bf16 v[108:111], v[60:63], v[236:239], v[108:111]
  s_waitcnt vmcnt(18) lgkmcnt(0)
  s_barrier
  v_mfma_f32_16x16x32_bf16 v[112:115], v[64:67], a[0:3], 0
  ds_read_b64_tr_b16 v[48:49], v11 offset:8192
  s_add_u32 m0, s67, 131072
  v_mfma_f32_16x16x32_bf16 v[116:119], v[64:67], a[4:7], 0
  ds_read_b64_tr_b16 v[50:51], v11 offset:12288
  buffer_load_dwordx4 v6, s[32:35], s66 offen lds
  v_mfma_f32_16x16x32_bf16 v[120:123], v[64:67], a[8:11], 0
  ds_read_b64_tr_b16 v[52:53], v12 offset:8192
  v_cvt_pk_bf16_f32 v149, v182, v183
  v_mfma_f32_16x16x32_bf16 v[124:127], v[64:67], a[12:15], 0
  ds_read_b64_tr_b16 v[54:55], v12 offset:12288
  v_mul_f32 v184, v152, v184
  v_mfma_f32_16x16x32_bf16 v[128:131], v[68:71], a[0:3], 0
  ds_read_b64_tr_b16 v[56:57], v11 offset:9216
  v_mul_f32 v152, v152, v29
  v_mfma_f32_16x16x32_bf16 v[132:135], v[68:71], a[4:7], 0
  ds_read_b64_tr_b16 v[58:59], v11 offset:13312
  v_add_u32 v6, 128, v6
  v_mfma_f32_16x16x32_bf16 v[136:139], v[68:71], a[8:11], 0
  ds_read_b64_tr_b16 v[60:61], v12 offset:9216
  buffer_load_dwordx4 v6, s[36:39], s58 offen offset:1024 lds
  v_mfma_f32_16x16x32_bf16 v[140:143], v[68:71], a[12:15], 0
  ds_read_b64_tr_b16 v[62:63], v12 offset:13312
  v_mul_f32 v185, v153, v185
  v_mfma_f32_16x16x32_bf16 v[112:115], v[72:75], a[16:19], v[112:115]
  v_exp_f32 v164, v164
  v_mfma_f32_16x16x32_bf16 v[116:119], v[72:75], a[20:23], v[116:119]
  v_exp_f32 v165, v165
  v_mfma_f32_16x16x32_bf16 v[120:123], v[72:75], a[24:27], v[120:123]
  s_add_u32 m0, s67, 81920
  v_fma_f32 v164, v164, v32, v32
  v_mfma_f32_16x16x32_bf16 v[124:127], v[72:75], a[28:31], v[124:127]
  buffer_load_dwordx4 v6, s[32:35], s59 offen lds
  v_fma_f32 v165, v165, v32, v32
  v_mfma_f32_16x16x32_bf16 v[128:131], v[76:79], a[16:19], v[128:131]
  v_exp_f32 v166, v166
  v_mfma_f32_16x16x32_bf16 v[132:135], v[76:79], a[20:23], v[132:135]
  v_exp_f32 v167, v167
  v_mfma_f32_16x16x32_bf16 v[136:139], v[76:79], a[24:27], v[136:139]
  v_fma_f32 v166, v166, v32, v32
  v_fma_f32 v167, v167, v32, v32
  v_mfma_f32_16x16x32_bf16 v[140:143], v[76:79], a[28:31], v[140:143]
  v_mul_f32 v153, v153, v29
  s_waitcnt lgkmcnt(0)
  v_mfma_f32_16x16x32_bf16 v[112:115], v[48:51], a[32:35], v[112:115]
  ds_read_b64_tr_b16 v[64:65], v11 offset:0
  buffer_load_dwordx4 v6, s[36:39], s60 offen offset:1024 lds
  v_mfma_f32_16x16x32_bf16 v[116:119], v[48:51], a[36:39], v[116:119]
  ds_read_b64_tr_b16 v[66:67], v11 offset:4096
  v_mul_f32 v186, v154, v186
  v_mfma_f32_16x16x32_bf16 v[120:123], v[48:51], a[40:43], v[120:123]
  ds_read_b64_tr_b16 v[68:69], v12 offset:0
  v_mul_f32 v154, v154, v29
  v_mfma_f32_16x16x32_bf16 v[124:127], v[48:51], a[44:47], v[124:127]
  ds_read_b64_tr_b16 v[70:71], v12 offset:4096
  v_mul_f32 v187, v155, v187
  v_mfma_f32_16x16x32_bf16 v[128:131], v[52:55], a[32:35], v[128:131]
  ds_read_b64_tr_b16 v[72:73], v11 offset:1024
  s_add_u32 m0, s67, 49152
  v_mfma_f32_16x16x32_bf16 v[132:135], v[52:55], a[36:39], v[132:135]
  ds_read_b64_tr_b16 v[74:75], v11 offset:5120
  buffer_load_dwordx4 v6, s[32:35], s61 offen lds
  v_mfma_f32_16x16x32_bf16 v[136:139], v[52:55], a[40:43], v[136:139]
  ds_read_b64_tr_b16 v[76:77], v12 offset:1024
  v_mul_f32 v155, v155, v29
  v_mfma_f32_16x16x32_bf16 v[140:143], v[52:55], a[44:47], v[140:143]
  ds_read_b64_tr_b16 v[78:79], v12 offset:5120
  v_mfma_f32_16x16x32_bf16 v[112:115], v[56:59], a[48:51], v[112:115]
  v_rcp_f32 v164, v164
  v_mfma_f32_16x16x32_bf16 v[116:119], v[56:59], a[52:55], v[116:119]
  v_rcp_f32 v165, v165
  v_mfma_f32_16x16x32_bf16 v[120:123], v[56:59], a[56:59], v[120:123]
  buffer_load_dwordx4 v6, s[36:39], s62 offen offset:1024 lds
  v_mul_f32 v196, v196, v164
  v_mfma_f32_16x16x32_bf16 v[124:127], v[56:59], a[60:63], v[124:127]
  v_rcp_f32 v166, v166
  v_mfma_f32_16x16x32_bf16 v[128:131], v[60:63], a[48:51], v[128:131]
  v_rcp_f32 v167, v167
  v_mfma_f32_16x16x32_bf16 v[132:135], v[60:63], a[52:55], v[132:135]
  v_mul_f32 v197, v197, v165
  v_mul_f32 v198, v198, v166
  v_mfma_f32_16x16x32_bf16 v[136:139], v[60:63], a[56:59], v[136:139]
  v_mul_f32 v199, v199, v167
  v_cvt_pk_bf16_f32 v150, v196, v197
  v_mfma_f32_16x16x32_bf16 v[140:143], v[60:63], a[60:63], v[140:143]
  v_cvt_pk_bf16_f32 v151, v198, v199
  s_waitcnt lgkmcnt(0)
  v_mfma_f32_16x16x32_bf16 v[112:115], v[64:67], a[64:67], v[112:115]
  ds_read_b64_tr_b16 v[48:49], v9 offset:0
  s_add_u32 m0, s67, 16384
  v_mfma_f32_16x16x32_bf16 v[116:119], v[64:67], a[68:71], v[116:119]
  ds_read_b64_tr_b16 v[50:51], v9 offset:4096
  buffer_load_dwordx4 v6, s[32:35], s63 offen lds
  v_mfma_f32_16x16x32_bf16 v[120:123], v[64:67], a[72:75], v[120:123]
  ds_read_b64_tr_b16 v[52:53], v10 offset:0
  v_mul_f32 v200, v168, v200
  v_mfma_f32_16x16x32_bf16 v[124:127], v[64:67], a[76:79], v[124:127]
  ds_read_b64_tr_b16 v[54:55], v10 offset:4096
  v_mul_f32 v168, v168, v29
  v_mfma_f32_16x16x32_bf16 v[128:131], v[68:71], a[64:67], v[128:131]
  ds_read_b64_tr_b16 v[56:57], v9 offset:1024
  v_mul_f32 v201, v169, v201
  v_mfma_f32_16x16x32_bf16 v[132:135], v[68:71], a[68:71], v[132:135]
  ds_read_b64_tr_b16 v[58:59], v9 offset:5120
  v_mul_f32 v169, v169, v29
  v_mfma_f32_16x16x32_bf16 v[136:139], v[68:71], a[72:75], v[136:139]
  ds_read_b64_tr_b16 v[60:61], v10 offset:1024
  buffer_load_dwordx4 v6, s[36:39], s64 offen offset:1024 lds
  v_mfma_f32_16x16x32_bf16 v[140:143], v[68:71], a[76:79], v[140:143]
  ds_read_b64_tr_b16 v[62:63], v10 offset:5120
  v_mul_f32 v202, v170, v202
  v_mfma_f32_16x16x32_bf16 v[112:115], v[72:75], a[80:83], v[112:115]
  ds_write_b128 v21, v[148:151] offset:50176
  v_mul_f32 v170, v170, v29
  v_mfma_f32_16x16x32_bf16 v[116:119], v[72:75], a[84:87], v[116:119]
  v_exp_f32 v152, v152
  v_mfma_f32_16x16x32_bf16 v[120:123], v[72:75], a[88:91], v[120:123]
  s_add_u32 m0, s67, 8192
  v_fma_f32 v152, v152, v33, v33
  v_mfma_f32_16x16x32_bf16 v[124:127], v[72:75], a[92:95], v[124:127]
  buffer_load_dwordx4 v6, s[32:35], s65 offen lds
  v_mul_f32 v203, v171, v203
  v_mfma_f32_16x16x32_bf16 v[128:131], v[76:79], a[80:83], v[128:131]
  v_exp_f32 v153, v153
  v_mfma_f32_16x16x32_bf16 v[132:135], v[76:79], a[84:87], v[132:135]
  v_exp_f32 v154, v154
  v_mfma_f32_16x16x32_bf16 v[136:139], v[76:79], a[88:91], v[136:139]
  v_exp_f32 v155, v155
  v_mfma_f32_16x16x32_bf16 v[140:143], v[76:79], a[92:95], v[140:143]
  s_waitcnt vmcnt(23) lgkmcnt(0)
  s_barrier
  v_mfma_f32_16x16x32_bf16 v[208:211], v[48:51], a[0:3], 0
  ds_read_b64_tr_b16 v[64:65], v11 offset:32768
  buffer_load_dwordx4 v6, s[36:39], s66 offen offset:1024 lds
  v_mfma_f32_16x16x32_bf16 v[212:215], v[48:51], a[4:7], 0
  ds_read_b64_tr_b16 v[66:67], v11 offset:36864
  v_fma_f32 v153, v153, v33, v33
  v_mfma_f32_16x16x32_bf16 v[216:219], v[48:51], a[8:11], 0
  ds_read_b64_tr_b16 v[68:69], v12 offset:32768
  v_fma_f32 v154, v154, v33, v33
  v_mfma_f32_16x16x32_bf16 v[220:223], v[48:51], a[12:15], 0
  ds_read_b64_tr_b16 v[70:71], v12 offset:36864
  v_fma_f32 v155, v155, v33, v33
  v_mfma_f32_16x16x32_bf16 v[224:227], v[52:55], a[0:3], 0
  ds_read_b64_tr_b16 v[72:73], v11 offset:33792
  s_add_u32 m0, s67, 73728
  v_mfma_f32_16x16x32_bf16 v[228:231], v[52:55], a[4:7], 0
  ds_read_b64_tr_b16 v[74:75], v11 offset:37888
  v_add_u32 v6, 128, v6
  v_mfma_f32_16x16x32_bf16 v[232:235], v[52:55], a[8:11], 0
  ds_read_b64_tr_b16 v[76:77], v12 offset:33792
  buffer_load_dwordx4 v6, s[32:35], s58 offen lds
  v_mfma_f32_16x16x32_bf16 v[236:239], v[52:55], a[12:15], 0
  ds_read_b64_tr_b16 v[78:79], v12 offset:37888
  v_mul_f32 v171, v171, v29
  v_mfma_f32_16x16x32_bf16 v[208:211], v[56:59], a[16:19], v[208:211]
  v_rcp_f32 v152, v152
  v_mfma_f32_16x16x32_bf16 v[212:215], v[56:59], a[20:23], v[212:215]
  v_rcp_f32 v153, v153
  v_mfma_f32_16x16x32_bf16 v[216:219], v[56:59], a[24:27], v[216:219]
  v_rcp_f32 v154, v154
  v_mfma_f32_16x16x32_bf16 v[220:223], v[56:59], a[28:31], v[220:223]
  buffer_load_dwordx4 v6, s[36:39], s59 offen offset:1024 lds
  v_mul_f32 v184, v184, v152
  v_mfma_f32_16x16x32_bf16 v[224:227], v[60:63], a[16:19], v[224:227]
  v_rcp_f32 v155, v155
  v_mfma_f32_16x16x32_bf16 v[228:231], v[60:63], a[20:23], v[228:231]
  v_mul_f32 v185, v185, v153
  v_mul_f32 v186, v186, v154
  v_mfma_f32_16x16x32_bf16 v[232:235], v[60:63], a[24:27], v[232:235]
  v_mul_f32 v187, v187, v155
  v_cvt_pk_bf16_f32 v152, v184, v185
  v_mfma_f32_16x16x32_bf16 v[236:239], v[60:63], a[28:31], v[236:239]
  v_cvt_pk_bf16_f32 v153, v186, v187
  s_waitcnt lgkmcnt(0)
  v_mfma_f32_16x16x32_bf16 v[208:211], v[64:67], a[32:35], v[208:211]
  ds_read_b64_tr_b16 v[48:49], v11 offset:24576
  s_add_u32 m0, s67, 65536
  v_mfma_f32_16x16x32_bf16 v[212:215], v[64:67], a[36:39], v[212:215]
  ds_read_b64_tr_b16 v[50:51], v11 offset:28672
  buffer_load_dwordx4 v6, s[32:35], s60 offen lds
  v_mfma_f32_16x16x32_bf16 v[216:219], v[64:67], a[40:43], v[216:219]
  ds_read_b64_tr_b16 v[52:53], v12 offset:24576
  v_mul_f32 v188, v156, v188
  v_mfma_f32_16x16x32_bf16 v[220:223], v[64:67], a[44:47], v[220:223]
  ds_read_b64_tr_b16 v[54:55], v12 offset:28672
  v_mul_f32 v156, v156, v30
  v_mfma_f32_16x16x32_bf16 v[224:227], v[68:71], a[32:35], v[224:227]
  ds_read_b64_tr_b16 v[56:57], v11 offset:25600
  v_mul_f32 v189, v157, v189
  v_mfma_f32_16x16x32_bf16 v[228:231], v[68:71], a[36:39], v[228:231]
  ds_read_b64_tr_b16 v[58:59], v11 offset:29696
  v_mul_f32 v157, v157, v30
  v_mfma_f32_16x16x32_bf16 v[232:235], v[68:71], a[40:43], v[232:235]
  ds_read_b64_tr_b16 v[60:61], v12 offset:25600
  buffer_load_dwordx4 v6, s[36:39], s61 offen offset:1024 lds
  v_mfma_f32_16x16x32_bf16 v[236:239], v[68:71], a[44:47], v[236:239]
  ds_read_b64_tr_b16 v[62:63], v12 offset:29696
  v_mul_f32 v190, v158, v190
  v_mfma_f32_16x16x32_bf16 v[208:211], v[72:75], a[48:51], v[208:211]
  v_exp_f32 v168, v168
  v_mfma_f32_16x16x32_bf16 v[212:215], v[72:75], a[52:55], v[212:215]
  v_exp_f32 v169, v169
  v_mfma_f32_16x16x32_bf16 v[216:219], v[72:75], a[56:59], v[216:219]
  s_add_u32 m0, s67, 0
  v_fma_f32 v168, v168, v33, v33
  v_mfma_f32_16x16x32_bf16 v[220:223], v[72:75], a[60:63], v[220:223]
  buffer_load_dwordx4 v6, s[32:35], s62 offen lds
  v_fma_f32 v169, v169, v33, v33
  v_mfma_f32_16x16x32_bf16 v[224:227], v[76:79], a[48:51], v[224:227]
  v_exp_f32 v170, v170
  v_mfma_f32_16x16x32_bf16 v[228:231], v[76:79], a[52:55], v[228:231]
  v_exp_f32 v171, v171
  v_mfma_f32_16x16x32_bf16 v[232:235], v[76:79], a[56:59], v[232:235]
  v_fma_f32 v170, v170, v33, v33
  v_fma_f32 v171, v171, v33, v33
  v_mfma_f32_16x16x32_bf16 v[236:239], v[76:79], a[60:63], v[236:239]
  v_rcp_f32 v168, v168
  v_rcp_f32 v169, v169
  v_rcp_f32 v170, v170
  v_rcp_f32 v171, v171
  v_mul_f32 v200, v200, v168
  v_mul_f32 v201, v201, v169
  v_mul_f32 v202, v202, v170
  v_mul_f32 v203, v203, v171
  v_cvt_pk_bf16_f32 v154, v200, v201
  v_cvt_pk_bf16_f32 v155, v202, v203
  ds_write_b128 v21, v[152:155] offset:51200
  v_mul_f32 v158, v158, v30
  v_mul_f32 v191, v159, v191
  v_mul_f32 v159, v159, v30
  v_exp_f32 v156, v156
  v_exp_f32 v157, v157
  v_exp_f32 v158, v158
  v_exp_f32 v159, v159
  v_fma_f32 v156, v156, v34, v34
  v_fma_f32 v157, v157, v34, v34
  v_fma_f32 v158, v158, v34, v34
  v_fma_f32 v159, v159, v34, v34
  v_rcp_f32 v156, v156
  v_rcp_f32 v157, v157
  v_rcp_f32 v158, v158
  v_rcp_f32 v159, v159
  v_mul_f32 v188, v188, v156
  v_mul_f32 v189, v189, v157
  v_mul_f32 v190, v190, v158
  v_mul_f32 v191, v191, v159
  v_cvt_pk_bf16_f32 v156, v188, v189
  v_cvt_pk_bf16_f32 v157, v190, v191
  v_mul_f32 v204, v172, v204
  v_mul_f32 v172, v172, v30
  v_mul_f32 v205, v173, v205
  v_mul_f32 v173, v173, v30
  v_mul_f32 v206, v174, v206
  v_mul_f32 v174, v174, v30
  v_mul_f32 v207, v175, v207
  v_mul_f32 v175, v175, v30
  v_exp_f32 v172, v172
  v_exp_f32 v173, v173
  v_exp_f32 v174, v174
  v_exp_f32 v175, v175
  v_fma_f32 v172, v172, v34, v34
  v_fma_f32 v173, v173, v34, v34
  v_fma_f32 v174, v174, v34, v34
  v_fma_f32 v175, v175, v34, v34
  v_rcp_f32 v172, v172
  v_rcp_f32 v173, v173
  v_rcp_f32 v174, v174
  v_rcp_f32 v175, v175
  v_mul_f32 v204, v204, v172
  v_mul_f32 v205, v205, v173
  v_mul_f32 v206, v206, v174
  v_mul_f32 v207, v207, v175
  v_cvt_pk_bf16_f32 v158, v204, v205
  v_cvt_pk_bf16_f32 v159, v206, v207
  ds_write_b128 v21, v[156:159] offset:52224
  s_waitcnt vmcnt(25) lgkmcnt(0)
  s_barrier
  v_mfma_f32_16x16x32_bf16 v[208:211], v[48:51], a[64:67], v[208:211]
  ds_read_b128 a[112:115], v20 offset:16384
  ds_read_b128 a[116:119], v20 offset:17408
  v_mfma_f32_16x16x32_bf16 v[212:215], v[48:51], a[68:71], v[212:215]
  ds_read_b128 a[120:123], v20 offset:18432
  ds_read_b128 a[124:127], v20 offset:19456
  v_mfma_f32_16x16x32_bf16 v[216:219], v[48:51], a[72:75], v[216:219]
  ds_read_b128 a[96:99], v20 offset:8192
  ds_read_b128 a[100:103], v20 offset:9216
  v_mfma_f32_16x16x32_bf16 v[220:223], v[48:51], a[76:79], v[220:223]
  ds_read_b128 a[104:107], v20 offset:10240
  ds_read_b128 a[108:111], v20 offset:11264
  v_mfma_f32_16x16x32_bf16 v[224:227], v[52:55], a[64:67], v[224:227]
  ds_read_b64_tr_b16 v[64:65], v9 offset:57344
  ds_read_b64_tr_b16 v[66:67], v9 offset:61440
  v_mfma_f32_16x16x32_bf16 v[228:231], v[52:55], a[68:71], v[228:231]
  ds_read_b64_tr_b16 v[68:69], v10 offset:57344
  buffer_load_dwordx4 v6, s[36:39], s63 offen offset:1024 lds
  v_mfma_f32_16x16x32_bf16 v[232:235], v[52:55], a[72:75], v[232:235]
  ds_read_b64_tr_b16 v[70:71], v10 offset:61440
  v_mul_f32 v96, v80, v96
  v_mfma_f32_16x16x32_bf16 v[236:239], v[52:55], a[76:79], v[236:239]
  ds_read_b64_tr_b16 v[72:73], v9 offset:58368
  v_mul_f32 v80, v80, v27
  v_mfma_f32_16x16x32_bf16 v[208:211], v[56:59], a[80:83], v[208:211]
  ds_read_b64_tr_b16 v[74:75], v9 offset:62464
  v_mul_f32 v97, v81, v97
  v_mfma_f32_16x16x32_bf16 v[212:215], v[56:59], a[84:87], v[212:215]
  ds_read_b64_tr_b16 v[76:77], v10 offset:58368
  s_add_u32 m0, s67, 98304
  v_mfma_f32_16x16x32_bf16 v[216:219], v[56:59], a[88:91], v[216:219]
  ds_read_b64_tr_b16 v[78:79], v10 offset:62464
  buffer_load_dwordx4 v6, s[32:35], s64 offen lds
  v_mfma_f32_16x16x32_bf16 v[220:223], v[56:59], a[92:95], v[220:223]
  v_mul_f32 v81, v81, v27
  v_mul_f32 v98, v82, v98
  v_mfma_f32_16x16x32_bf16 v[224:227], v[60:63], a[80:83], v[224:227]
  v_mul_f32 v82, v82, v27
  v_mul_f32 v99, v83, v99
  v_mfma_f32_16x16x32_bf16 v[228:231], v[60:63], a[84:87], v[228:231]
  v_mul_f32 v83, v83, v27
  v_mul_f32 v100, v84, v100
  v_mfma_f32_16x16x32_bf16 v[232:235], v[60:63], a[88:91], v[232:235]
  v_exp_f32 v80, v80
  v_mfma_f32_16x16x32_bf16 v[236:239], v[60:63], a[92:95], v[236:239]
  buffer_load_dwordx4 v6, s[36:39], s65 offen offset:1024 lds
  s_waitcnt lgkmcnt(0)
  v_mfma_f32_16x16x32_bf16 v[112:115], v[64:67], a[96:99], v[112:115]
  ds_read_b64_tr_b16 v[48:49], v9 offset:40960
  v_fma_f32 v80, v80, v31, v31
  v_mfma_f32_16x16x32_bf16 v[116:119], v[64:67], a[100:103], v[116:119]
  ds_read_b64_tr_b16 v[50:51], v9 offset:45056
  v_mul_f32 v84, v84, v28
  v_mfma_f32_16x16x32_bf16 v[120:123], v[64:67], a[104:107], v[120:123]
  ds_read_b64_tr_b16 v[52:53], v10 offset:40960
  v_mul_f32 v101, v85, v101
  v_mfma_f32_16x16x32_bf16 v[124:127], v[64:67], a[108:111], v[124:127]
  ds_read_b64_tr_b16 v[54:55], v10 offset:45056
  s_add_u32 m0, s67, 90112
  v_mfma_f32_16x16x32_bf16 v[128:131], v[68:71], a[96:99], v[128:131]
  ds_read_b64_tr_b16 v[56:57], v9 offset:41984
  buffer_load_dwordx4 v6, s[32:35], s66 offen lds
  v_mfma_f32_16x16x32_bf16 v[132:135], v[68:71], a[100:103], v[132:135]
  ds_read_b64_tr_b16 v[58:59], v9 offset:46080
  v_mul_f32 v85, v85, v28
  v_mfma_f32_16x16x32_bf16 v[136:139], v[68:71], a[104:107], v[136:139]
  ds_read_b64_tr_b16 v[60:61], v10 offset:41984
  v_mul_f32 v102, v86, v102
  v_mfma_f32_16x16x32_bf16 v[140:143], v[68:71], a[108:111], v[140:143]
  ds_read_b64_tr_b16 v[62:63], v10 offset:46080
  v_mul_f32 v86, v86, v28
  v_mfma_f32_16x16x32_bf16 v[112:115], v[72:75], a[112:115], v[112:115]
  v_add_u32 v6, 128, v6
  v_mul_f32 v103, v87, v103
  v_mfma_f32_16x16x32_bf16 v[116:119], v[72:75], a[116:119], v[116:119]
  buffer_load_dwordx4 v6, s[36:39], s58 offen offset:1024 lds
  v_mul_f32 v87, v87, v28
  v_mfma_f32_16x16x32_bf16 v[120:123], v[72:75], a[120:123], v[120:123]
  v_exp_f32 v81, v81
  v_mfma_f32_16x16x32_bf16 v[124:127], v[72:75], a[124:127], v[124:127]
  v_exp_f32 v82, v82
  v_mfma_f32_16x16x32_bf16 v[128:131], v[76:79], a[112:115], v[128:131]
  v_exp_f32 v83, v83
  v_mfma_f32_16x16x32_bf16 v[132:135], v[76:79], a[116:119], v[132:135]
  v_fma_f32 v81, v81, v31, v31
  v_fma_f32 v82, v82, v31, v31
  v_mfma_f32_16x16x32_bf16 v[136:139], v[76:79], a[120:123], v[136:139]
  v_fma_f32 v83, v83, v31, v31
  v_mfma_f32_16x16x32_bf16 v[140:143], v[76:79], a[124:127], v[140:143]
  v_rcp_f32 v80, v80
  v_rcp_f32 v81, v81
  v_rcp_f32 v82, v82
  v_rcp_f32 v83, v83
  v_mul_f32 v96, v96, v80
  v_mul_f32 v97, v97, v81
  v_mul_f32 v98, v98, v82
  v_mul_f32 v99, v99, v83
  v_cvt_pk_bf16_f32 v80, v96, v97
  v_cvt_pk_bf16_f32 v81, v98, v99
  ds_write_b64 v22, v[80:81] offset:0
  v_exp_f32 v84, v84
  v_exp_f32 v85, v85
  v_exp_f32 v86, v86
  v_exp_f32 v87, v87
  v_fma_f32 v84, v84, v32, v32
  v_fma_f32 v85, v85, v32, v32
  v_fma_f32 v86, v86, v32, v32
  v_fma_f32 v87, v87, v32, v32
  v_rcp_f32 v84, v84
  v_rcp_f32 v85, v85
  v_rcp_f32 v86, v86
  v_rcp_f32 v87, v87
  v_mul_f32 v100, v100, v84
  v_mul_f32 v101, v101, v85
  v_mul_f32 v102, v102, v86
  v_mul_f32 v103, v103, v87
  v_cvt_pk_bf16_f32 v84, v100, v101
  v_cvt_pk_bf16_f32 v85, v102, v103
  ds_write_b64 v22, v[84:85] offset:1024
  v_mul_f32 v104, v88, v104
  v_mul_f32 v88, v88, v29
  v_mul_f32 v105, v89, v105
  v_mul_f32 v89, v89, v29
  v_mul_f32 v106, v90, v106
  v_mul_f32 v90, v90, v29
  v_mul_f32 v107, v91, v107
  v_mul_f32 v91, v91, v29
  v_exp_f32 v88, v88
  v_exp_f32 v89, v89
  v_exp_f32 v90, v90
  v_exp_f32 v91, v91
  v_fma_f32 v88, v88, v33, v33
  v_fma_f32 v89, v89, v33, v33
  v_fma_f32 v90, v90, v33, v33
  v_fma_f32 v91, v91, v33, v33
  v_rcp_f32 v88, v88
  v_rcp_f32 v89, v89
  v_rcp_f32 v90, v90
  v_rcp_f32 v91, v91
  v_mul_f32 v104, v104, v88
  v_mul_f32 v105, v105, v89
  v_mul_f32 v106, v106, v90
  v_mul_f32 v107, v107, v91
  v_cvt_pk_bf16_f32 v88, v104, v105
  v_cvt_pk_bf16_f32 v89, v106, v107
  ds_write_b64 v22, v[88:89] offset:2048
  v_mul_f32 v108, v92, v108
  v_mul_f32 v92, v92, v30
  v_mul_f32 v109, v93, v109
  v_mul_f32 v93, v93, v30
  v_mul_f32 v110, v94, v110
  v_mul_f32 v94, v94, v30
  v_mul_f32 v111, v95, v111
  v_mul_f32 v95, v95, v30
  v_exp_f32 v92, v92
  v_exp_f32 v93, v93
  v_exp_f32 v94, v94
  v_exp_f32 v95, v95
  v_fma_f32 v92, v92, v34, v34
  v_fma_f32 v93, v93, v34, v34
  v_fma_f32 v94, v94, v34, v34
  v_fma_f32 v95, v95, v34, v34
  v_rcp_f32 v92, v92
  v_rcp_f32 v93, v93
  v_rcp_f32 v94, v94
  v_rcp_f32 v95, v95
  v_mul_f32 v108, v108, v92
  v_mul_f32 v109, v109, v93
  v_mul_f32 v110, v110, v94
  v_mul_f32 v111, v111, v95
  v_cvt_pk_bf16_f32 v92, v108, v109
  v_cvt_pk_bf16_f32 v93, v110, v111
  ds_write_b64 v22, v[92:93] offset:3072
  s_waitcnt vmcnt(26) lgkmcnt(0)
  s_barrier
  v_mfma_f32_16x16x32_bf16 v[208:211], v[48:51], a[96:99], v[208:211]
  ds_read_b128 a[128:131], v20 offset:24576
  ds_read_b128 a[132:135], v20 offset:25600
  v_mfma_f32_16x16x32_bf16 v[212:215], v[48:51], a[100:103], v[212:215]
  ds_read_b128 a[136:139], v20 offset:26624
  s_add_u32 m0, s67, 147456
  v_mfma_f32_16x16x32_bf16 v[216:219], v[48:51], a[104:107], v[216:219]
  ds_read_b128 a[140:143], v20 offset:27648
  buffer_load_dwordx4 v6, s[32:35], s59 offen lds
  v_mfma_f32_16x16x32_bf16 v[220:223], v[48:51], a[108:111], v[220:223]
  ds_read_b64_tr_b16 v[64:65], v9 offset:32768
  v_mfma_f32_16x16x32_bf16 v[224:227], v[52:55], a[96:99], v[224:227]
  ds_read_b64_tr_b16 v[66:67], v9 offset:36864
  v_mfma_f32_16x16x32_bf16 v[228:231], v[52:55], a[100:103], v[228:231]
  ds_read_b64_tr_b16 v[68:69], v10 offset:32768
  v_mfma_f32_16x16x32_bf16 v[232:235], v[52:55], a[104:107], v[232:235]
  ds_read_b64_tr_b16 v[70:71], v10 offset:36864
  v_mfma_f32_16x16x32_bf16 v[236:239], v[52:55], a[108:111], v[236:239]
  ds_read_b64_tr_b16 v[72:73], v9 offset:33792
  buffer_load_dwordx4 v6, s[36:39], s60 offen offset:1024 lds
  v_mfma_f32_16x16x32_bf16 v[208:211], v[56:59], a[112:115], v[208:211]
  ds_read_b64_tr_b16 v[74:75], v9 offset:37888
  v_mfma_f32_16x16x32_bf16 v[212:215], v[56:59], a[116:119], v[212:215]
  ds_read_b64_tr_b16 v[76:77], v10 offset:33792
  v_mfma_f32_16x16x32_bf16 v[216:219], v[56:59], a[120:123], v[216:219]
  ds_read_b64_tr_b16 v[78:79], v10 offset:37888
  v_mfma_f32_16x16x32_bf16 v[220:223], v[56:59], a[124:127], v[220:223]
  s_add_u32 m0, s67, 139264
  v_mfma_f32_16x16x32_bf16 v[224:227], v[60:63], a[112:115], v[224:227]
  buffer_load_dwordx4 v6, s[32:35], s61 offen lds
  v_mfma_f32_16x16x32_bf16 v[228:231], v[60:63], a[116:119], v[228:231]
  v_mfma_f32_16x16x32_bf16 v[232:235], v[60:63], a[120:123], v[232:235]
  v_mfma_f32_16x16x32_bf16 v[236:239], v[60:63], a[124:127], v[236:239]
  s_waitcnt lgkmcnt(0)
  v_mfma_f32_16x16x32_bf16 v[112:115], v[64:67], a[128:131], v[112:115]
  ds_read_b64_tr_b16 v[48:49], v11 offset:57344
  v_mfma_f32_16x16x32_bf16 v[116:119], v[64:67], a[132:135], v[116:119]
  ds_read_b64_tr_b16 v[50:51], v11 offset:61440
  buffer_load_dwordx4 v6, s[36:39], s62 offen offset:1024 lds
  v_mfma_f32_16x16x32_bf16 v[120:123], v[64:67], a[136:139], v[120:123]
  ds_read_b64_tr_b16 v[52:53], v12 offset:57344
  v_mfma_f32_16x16x32_bf16 v[124:127], v[64:67], a[140:143], v[124:127]
  ds_read_b64_tr_b16 v[54:55], v12 offset:61440
  v_mfma_f32_16x16x32_bf16 v[128:131], v[68:71], a[128:131], v[128:131]
  ds_read_b64_tr_b16 v[56:57], v11 offset:58368
  v_mfma_f32_16x16x32_bf16 v[132:135], v[68:71], a[132:135], v[132:135]
  ds_read_b64_tr_b16 v[58:59], v11 offset:62464
  s_add_u32 m0, s67, 57344
  v_mfma_f32_16x16x32_bf16 v[136:139], v[68:71], a[136:139], v[136:139]
  ds_read_b64_tr_b16 v[60:61], v12 offset:58368
  buffer_load_dwordx4 v6, s[32:35], s63 offen lds
  v_mfma_f32_16x16x32_bf16 v[140:143], v[68:71], a[140:143], v[140:143]
  ds_read_b64_tr_b16 v[62:63], v12 offset:62464
  v_cvt_pk_bf16_f32 v112, v112, v113
  v_mfma_f32_16x16x32_bf16 v[208:211], v[72:75], a[128:131], v[208:211]
  v_cvt_pk_bf16_f32 v113, v114, v115
  v_cvt_pk_bf16_f32 v114, v128, v129
  v_mfma_f32_16x16x32_bf16 v[212:215], v[72:75], a[132:135], v[212:215]
  v_cvt_pk_bf16_f32 v115, v130, v131
  v_cvt_pk_bf16_f32 v116, v116, v117
  v_mfma_f32_16x16x32_bf16 v[216:219], v[72:75], a[136:139], v[216:219]
  v_cvt_pk_bf16_f32 v117, v118, v119
  v_cvt_pk_bf16_f32 v118, v132, v133
  v_mfma_f32_16x16x32_bf16 v[220:223], v[72:75], a[140:143], v[220:223]
  buffer_load_dwordx4 v6, s[36:39], s64 offen offset:1024 lds
  v_cvt_pk_bf16_f32 v119, v134, v135
  v_mfma_f32_16x16x32_bf16 v[224:227], v[76:79], a[128:131], v[224:227]
  v_cvt_pk_bf16_f32 v120, v120, v121
  v_cvt_pk_bf16_f32 v121, v122, v123
  v_mfma_f32_16x16x32_bf16 v[228:231], v[76:79], a[132:135], v[228:231]
  v_cvt_pk_bf16_f32 v122, v136, v137
  v_cvt_pk_bf16_f32 v123, v138, v139
  v_mfma_f32_16x16x32_bf16 v[232:235], v[76:79], a[136:139], v[232:235]
  v_cvt_pk_bf16_f32 v124, v124, v125
  v_cvt_pk_bf16_f32 v125, v126, v127
  v_mfma_f32_16x16x32_bf16 v[236:239], v[76:79], a[140:143], v[236:239]
  s_waitcnt vmcnt(26) lgkmcnt(0)
  s_barrier
  v_mfma_f32_16x16x32_bf16 v[144:147], v[48:51], a[0:3], 0
  ds_read_b64_tr_b16 v[64:65], v11 offset:49152
  s_add_u32 m0, s67, 155648
  v_mfma_f32_16x16x32_bf16 v[148:151], v[48:51], a[4:7], 0
  ds_read_b64_tr_b16 v[66:67], v11 offset:53248
  buffer_load_dwordx4 v6, s[32:35], s65 offen lds
  v_mfma_f32_16x16x32_bf16 v[152:155], v[48:51], a[8:11], 0
  ds_read_b64_tr_b16 v[68:69], v12 offset:49152
  v_cvt_pk_bf16_f32 v126, v140, v141
  v_mfma_f32_16x16x32_bf16 v[156:159], v[48:51], a[12:15], 0
  ds_read_b64_tr_b16 v[70:71], v12 offset:53248
  v_cvt_pk_bf16_f32 v127, v142, v143
  v_mfma_f32_16x16x32_bf16 v[160:163], v[52:55], a[0:3], 0
  ds_read_b64_tr_b16 v[72:73], v11 offset:50176
  v_cvt_pk_bf16_f32 v208, v208, v209
  v_mfma_f32_16x16x32_bf16 v[164:167], v[52:55], a[4:7], 0
  ds_read_b64_tr_b16 v[74:75], v11 offset:54272
  v_cvt_pk_bf16_f32 v209, v210, v211
  v_mfma_f32_16x16x32_bf16 v[168:171], v[52:55], a[8:11], 0
  ds_read_b64_tr_b16 v[76:77], v12 offset:50176
  buffer_load_dwordx4 v6, s[36:39], s66 offen offset:1024 lds
  v_mfma_f32_16x16x32_bf16 v[172:175], v[52:55], a[12:15], 0
  ds_read_b64_tr_b16 v[78:79], v12 offset:54272
  v_cvt_pk_bf16_f32 v210, v224, v225
  v_mfma_f32_16x16x32_bf16 v[144:147], v[56:59], a[16:19], v[144:147]
  v_cvt_pk_bf16_f32 v211, v226, v227
  v_cvt_pk_bf16_f32 v212, v212, v213
  v_mfma_f32_16x16x32_bf16 v[148:151], v[56:59], a[20:23], v[148:151]
  v_cvt_pk_bf16_f32 v213, v214, v215
  v_cvt_pk_bf16_f32 v214, v228, v229
  v_mfma_f32_16x16x32_bf16 v[152:155], v[56:59], a[24:27], v[152:155]
  s_add_u32 m0, s67, 122880
  v_add_u32 v6, 128, v6
  v_mfma_f32_16x16x32_bf16 v[156:159], v[56:59], a[28:31], v[156:159]
  buffer_load_dwordx4 v6, s[32:35], s58 offen lds
  v_cvt_pk_bf16_f32 v215, v230, v231
  v_mfma_f32_16x16x32_bf16 v[160:163], v[60:63], a[16:19], v[160:163]
  v_cvt_pk_bf16_f32 v216, v216, v217
  v_cvt_pk_bf16_f32 v217, v218, v219
  v_mfma_f32_16x16x32_bf16 v[164:167], v[60:63], a[20:23], v[164:167]
  v_cvt_pk_bf16_f32 v218, v232, v233
  v_cvt_pk_bf16_f32 v219, v234, v235
  v_mfma_f32_16x16x32_bf16 v[168:171], v[60:63], a[24:27], v[168:171]
  v_cvt_pk_bf16_f32 v220, v220, v221
  v_cvt_pk_bf16_f32 v221, v222, v223
  v_mfma_f32_16x16x32_bf16 v[172:175], v[60:63], a[28:31], v[172:175]
  v_cvt_pk_bf16_f32 v222, v236, v237
  s_waitcnt lgkmcnt(0)
  v_mfma_f32_16x16x32_bf16 v[144:147], v[64:67], a[32:35], v[144:147]
  ds_read_b64_tr_b16 v[48:49], v11 offset:40960
  buffer_load_dwordx4 v6, s[36:39], s59 offen offset:1024 lds
  v_mfma_f32_16x16x32_bf16 v[148:151], v[64:67], a[36:39], v[148:151]
  ds_read_b64_tr_b16 v[50:51], v11 offset:45056
  v_cvt_pk_bf16_f32 v223, v238, v239
  v_mfma_f32_16x16x32_bf16 v[152:155], v[64:67], a[40:43], v[152:155]
  ds_read_b64_tr_b16 v[52:53], v12 offset:40960
  v_mfma_f32_16x16x32_bf16 v[156:159], v[64:67], a[44:47], v[156:159]
  ds_read_b64_tr_b16 v[54:55], v12 offset:45056
  v_mfma_f32_16x16x32_bf16 v[160:163], v[68:71], a[32:35], v[160:163]
  ds_read_b64_tr_b16 v[56:57], v11 offset:41984
  s_add_u32 m0, s67, 40960
  v_mfma_f32_16x16x32_bf16 v[164:167], v[68:71], a[36:39], v[164:167]
  ds_read_b64_tr_b16 v[58:59], v11 offset:46080
  buffer_load_dwordx4 v6, s[32:35], s60 offen lds
  v_mfma_f32_16x16x32_bf16 v[168:171], v[68:71], a[40:43], v[168:171]
  ds_read_b64_tr_b16 v[60:61], v12 offset:41984
  v_mfma_f32_16x16x32_bf16 v[172:175], v[68:71], a[44:47], v[172:175]
  ds_read_b64_tr_b16 v[62:63], v12 offset:46080
  v_mfma_f32_16x16x32_bf16 v[144:147], v[72:75], a[48:51], v[144:147]
  v_mfma_f32_16x16x32_bf16 v[148:151], v[72:75], a[52:55], v[148:151]
  v_mfma_f32_16x16x32_bf16 v[152:155], v[72:75], a[56:59], v[152:155]
  buffer_load_dwordx4 v6, s[36:39], s61 offen offset:1024 lds
  v_mfma_f32_16x16x32_bf16 v[156:159], v[72:75], a[60:63], v[156:159]
  v_mfma_f32_16x16x32_bf16 v[160:163], v[76:79], a[48:51], v[160:163]
  v_mfma_f32_16x16x32_bf16 v[164:167], v[76:79], a[52:55], v[164:167]
  v_mfma_f32_16x16x32_bf16 v[168:171], v[76:79], a[56:59], v[168:171]
  v_mfma_f32_16x16x32_bf16 v[172:175], v[76:79], a[60:63], v[172:175]
  buffer_store_dwordx4 v[112:115], v23, s[16:19], s70 offen  sc1
  s_waitcnt lgkmcnt(0)
  v_mfma_f32_16x16x32_bf16 v[144:147], v[48:51], a[64:67], v[144:147]
  ds_read_b64_tr_b16 v[64:65], v9 offset:24576
  v_mfma_f32_16x16x32_bf16 v[148:151], v[48:51], a[68:71], v[148:151]
  ds_read_b64_tr_b16 v[66:67], v9 offset:28672
  v_mfma_f32_16x16x32_bf16 v[152:155], v[48:51], a[72:75], v[152:155]
  ds_read_b64_tr_b16 v[68:69], v10 offset:24576
  v_mfma_f32_16x16x32_bf16 v[156:159], v[48:51], a[76:79], v[156:159]
  ds_read_b64_tr_b16 v[70:71], v10 offset:28672
  s_add_u32 m0, s67, 32768
  v_mfma_f32_16x16x32_bf16 v[160:163], v[52:55], a[64:67], v[160:163]
  ds_read_b64_tr_b16 v[72:73], v9 offset:25600
  buffer_load_dwordx4 v6, s[32:35], s62 offen lds
  v_mfma_f32_16x16x32_bf16 v[164:167], v[52:55], a[68:71], v[164:167]
  ds_read_b64_tr_b16 v[74:75], v9 offset:29696
  v_mfma_f32_16x16x32_bf16 v[168:171], v[52:55], a[72:75], v[168:171]
  ds_read_b64_tr_b16 v[76:77], v10 offset:25600
  v_mfma_f32_16x16x32_bf16 v[172:175], v[52:55], a[76:79], v[172:175]
  ds_read_b64_tr_b16 v[78:79], v10 offset:29696
  v_mfma_f32_16x16x32_bf16 v[144:147], v[56:59], a[80:83], v[144:147]
  v_mfma_f32_16x16x32_bf16 v[148:151], v[56:59], a[84:87], v[148:151]
  buffer_load_dwordx4 v6, s[36:39], s63 offen offset:1024 lds
  v_mfma_f32_16x16x32_bf16 v[152:155], v[56:59], a[88:91], v[152:155]
  v_mfma_f32_16x16x32_bf16 v[156:159], v[56:59], a[92:95], v[156:159]
  v_mfma_f32_16x16x32_bf16 v[160:163], v[60:63], a[80:83], v[160:163]
  v_mfma_f32_16x16x32_bf16 v[164:167], v[60:63], a[84:87], v[164:167]
  v_mfma_f32_16x16x32_bf16 v[168:171], v[60:63], a[88:91], v[168:171]
  buffer_store_dwordx4 v[116:119], v24, s[16:19], s70 offen  sc1
  v_mfma_f32_16x16x32_bf16 v[172:175], v[60:63], a[92:95], v[172:175]
  s_waitcnt vmcnt(30) lgkmcnt(0)
  s_barrier
  v_mfma_f32_16x16x32_bf16 v[144:147], v[64:67], a[96:99], v[144:147]
  ds_read_b64_tr_b16 v[48:49], v13 offset:0
  v_mfma_f32_16x16x32_bf16 v[148:151], v[64:67], a[100:103], v[148:151]
  ds_read_b64_tr_b16 v[50:51], v13 offset:4096
  v_mfma_f32_16x16x32_bf16 v[152:155], v[64:67], a[104:107], v[152:155]
  ds_read_b64_tr_b16 v[52:53], v14 offset:0
  s_add_u32 m0, s67, 114688
  v_mfma_f32_16x16x32_bf16 v[156:159], v[64:67], a[108:111], v[156:159]
  ds_read_b64_tr_b16 v[54:55], v14 offset:4096
  buffer_load_dwordx4 v6, s[32:35], s64 offen lds
  v_mfma_f32_16x16x32_bf16 v[160:163], v[68:71], a[96:99], v[160:163]
  ds_read_b64_tr_b16 v[56:57], v13 offset:1024
  v_mfma_f32_16x16x32_bf16 v[164:167], v[68:71], a[100:103], v[164:167]
  ds_read_b64_tr_b16 v[58:59], v13 offset:5120
  v_mfma_f32_16x16x32_bf16 v[168:171], v[68:71], a[104:107], v[168:171]
  ds_read_b64_tr_b16 v[60:61], v14 offset:1024
  v_mfma_f32_16x16x32_bf16 v[172:175], v[68:71], a[108:111], v[172:175]
  ds_read_b64_tr_b16 v[62:63], v14 offset:5120
  v_mfma_f32_16x16x32_bf16 v[144:147], v[72:75], a[112:115], v[144:147]
  buffer_load_dwordx4 v6, s[36:39], s65 offen offset:1024 lds
  v_mfma_f32_16x16x32_bf16 v[148:151], v[72:75], a[116:119], v[148:151]
  v_mfma_f32_16x16x32_bf16 v[152:155], v[72:75], a[120:123], v[152:155]
  v_mfma_f32_16x16x32_bf16 v[156:159], v[72:75], a[124:127], v[156:159]
  v_mfma_f32_16x16x32_bf16 v[160:163], v[76:79], a[112:115], v[160:163]
  s_add_u32 m0, s67, 106496
  v_mfma_f32_16x16x32_bf16 v[164:167], v[76:79], a[116:119], v[164:167]
  buffer_load_dwordx4 v6, s[32:35], s66 offen lds
  v_mfma_f32_16x16x32_bf16 v[168:171], v[76:79], a[120:123], v[168:171]
  v_mfma_f32_16x16x32_bf16 v[172:175], v[76:79], a[124:127], v[172:175]
  buffer_store_dwordx4 v[120:123], v25, s[16:19], s70 offen  sc1
  buffer_store_dwordx4 v[124:127], v26, s[16:19], s70 offen  sc1
  s_waitcnt lgkmcnt(0)
  v_mfma_f32_16x16x32_bf16 v[144:147], v[48:51], a[128:131], v[144:147]
  ds_read_b64_tr_b16 v[64:65], v11 offset:16384
  s_add_u32 s70, s70, 2048
  v_mfma_f32_16x16x32_bf16 v[148:151], v[48:51], a[132:135], v[148:151]
  ds_read_b64_tr_b16 v[66:67], v11 offset:20480
  v_add_u32 v6, 128, v6
  v_mfma_f32_16x16x32_bf16 v[152:155], v[48:51], a[136:139], v[152:155]
  ds_read_b64_tr_b16 v[68:69], v12 offset:16384
  buffer_load_dwordx4 v6, s[36:39], s58 offen offset:1024 lds
  v_mfma_f32_16x16x32_bf16 v[156:159], v[48:51], a[140:143], v[156:159]
  ds_read_b64_tr_b16 v[70:71], v12 offset:20480
  v_mfma_f32_16x16x32_bf16 v[160:163], v[52:55], a[128:131], v[160:163]
  ds_read_b64_tr_b16 v[72:73], v11 offset:17408
  v_mfma_f32_16x16x32_bf16 v[164:167], v[52:55], a[132:135], v[164:167]
  ds_read_b64_tr_b16 v[74:75], v11 offset:21504
  v_mfma_f32_16x16x32_bf16 v[168:171], v[52:55], a[136:139], v[168:171]
  ds_read_b64_tr_b16 v[76:77], v12 offset:17408
  s_add_u32 m0, s67, 24576
  v_mfma_f32_16x16x32_bf16 v[172:175], v[52:55], a[140:143], v[172:175]
  ds_read_b64_tr_b16 v[78:79], v12 offset:21504
  buffer_load_dwordx4 v6, s[32:35], s59 offen lds
  v_mfma_f32_16x16x32_bf16 v[112:115], v[56:59], a[0:3], 0
  v_cvt_pk_bf16_f32 v144, v144, v145
  v_cvt_pk_bf16_f32 v145, v146, v147
  v_mfma_f32_16x16x32_bf16 v[116:119], v[56:59], a[4:7], 0
  v_cvt_pk_bf16_f32 v146, v160, v161
  v_cvt_pk_bf16_f32 v147, v162, v163
  v_mfma_f32_16x16x32_bf16 v[120:123], v[56:59], a[8:11], 0
  v_cvt_pk_bf16_f32 v148, v148, v149
  v_cvt_pk_bf16_f32 v149, v150, v151
  v_mfma_f32_16x16x32_bf16 v[124:127], v[56:59], a[12:15], 0
  v_cvt_pk_bf16_f32 v150, v164, v165
  v_cvt_pk_bf16_f32 v151, v166, v167
  v_mfma_f32_16x16x32_bf16 v[128:131], v[60:63], a[0:3], 0
  buffer_load_dwordx4 v6, s[36:39], s60 offen offset:1024 lds
  v_cvt_pk_bf16_f32 v152, v152, v153
  v_mfma_f32_16x16x32_bf16 v[132:135], v[60:63], a[4:7], 0
  v_cvt_pk_bf16_f32 v153, v154, v155
  v_cvt_pk_bf16_f32 v154, v168, v169
  v_mfma_f32_16x16x32_bf16 v[136:139], v[60:63], a[8:11], 0
  v_cvt_pk_bf16_f32 v155, v170, v171
  v_cvt_pk_bf16_f32 v156, v156, v157
  v_mfma_f32_16x16x32_bf16 v[140:143], v[60:63], a[12:15], 0
  v_cvt_pk_bf16_f32 v157, v158, v159
  s_waitcnt lgkmcnt(0)
  v_mfma_f32_16x16x32_bf16 v[112:115], v[64:67], a[16:19], v[112:115]
  ds_read_b64_tr_b16 v[48:49], v9 offset:49152
  v_cvt_pk_bf16_f32 v158, v172, v173
  v_mfma_f32_16x16x32_bf16 v[116:119], v[64:67], a[20:23], v[116:119]
  ds_read_b64_tr_b16 v[50:51], v9 offset:53248
  buffer_store_dwordx4 v[208:211], v23, s[16:19], s70 offen  sc1
  v_mfma_f32_16x16x32_bf16 v[120:123], v[64:67], a[24:27], v[120:123]
  ds_read_b64_tr_b16 v[52:53], v10 offset:49152
  v_cvt_pk_bf16_f32 v159, v174, v175
  v_mfma_f32_16x16x32_bf16 v[124:127], v[64:67], a[28:31], v[124:127]
  ds_read_b64_tr_b16 v[54:55], v10 offset:53248
  v_mfma_f32_16x16x32_bf16 v[128:131], v[68:71], a[16:19], v[128:131]
  ds_read_b64_tr_b16 v[56:57], v9 offset:50176
  v_mfma_f32_16x16x32_bf16 v[132:135], v[68:71], a[20:23], v[132:135]
  ds_read_b64_tr_b16 v[58:59], v9 offset:54272
  v_mfma_f32_16x16x32_bf16 v[136:139], v[68:71], a[24:27], v[136:139]
  ds_read_b64_tr_b16 v[60:61], v10 offset:50176
  buffer_store_dwordx4 v[212:215], v24, s[16:19], s70 offen  sc1
  v_mfma_f32_16x16x32_bf16 v[140:143], v[68:71], a[28:31], v[140:143]
  ds_read_b64_tr_b16 v[62:63], v10 offset:54272
  v_mfma_f32_16x16x32_bf16 v[112:115], v[72:75], a[32:35], v[112:115]
  v_mfma_f32_16x16x32_bf16 v[116:119], v[72:75], a[36:39], v[116:119]
  v_mfma_f32_16x16x32_bf16 v[120:123], v[72:75], a[40:43], v[120:123]
  v_mfma_f32_16x16x32_bf16 v[124:127], v[72:75], a[44:47], v[124:127]
  buffer_store_dwordx4 v[216:219], v25, s[16:19], s70 offen  sc1
  v_mfma_f32_16x16x32_bf16 v[128:131], v[76:79], a[32:35], v[128:131]
  v_mfma_f32_16x16x32_bf16 v[132:135], v[76:79], a[36:39], v[132:135]
  v_mfma_f32_16x16x32_bf16 v[136:139], v[76:79], a[40:43], v[136:139]
  v_mfma_f32_16x16x32_bf16 v[140:143], v[76:79], a[44:47], v[140:143]
  s_waitcnt vmcnt(35) lgkmcnt(0)
  s_barrier
  v_mfma_f32_16x16x32_bf16 v[112:115], v[48:51], a[48:51], v[112:115]
  ds_read_b64_tr_b16 v[64:65], v9 offset:16384
  s_add_u32 m0, s67, 131072
  v_mfma_f32_16x16x32_bf16 v[116:119], v[48:51], a[52:55], v[116:119]
  ds_read_b64_tr_b16 v[66:67], v9 offset:20480
  buffer_load_dwordx4 v6, s[32:35], s61 offen lds
  v_mfma_f32_16x16x32_bf16 v[120:123], v[48:51], a[56:59], v[120:123]
  ds_read_b64_tr_b16 v[68:69], v10 offset:16384
  v_mfma_f32_16x16x32_bf16 v[124:127], v[48:51], a[60:63], v[124:127]
  ds_read_b64_tr_b16 v[70:71], v10 offset:20480
  v_mfma_f32_16x16x32_bf16 v[128:131], v[52:55], a[48:51], v[128:131]
  ds_read_b64_tr_b16 v[72:73], v9 offset:17408
  v_mfma_f32_16x16x32_bf16 v[132:135], v[52:55], a[52:55], v[132:135]
  ds_read_b64_tr_b16 v[74:75], v9 offset:21504
  v_mfma_f32_16x16x32_bf16 v[136:139], v[52:55], a[56:59], v[136:139]
  ds_read_b64_tr_b16 v[76:77], v10 offset:17408
  buffer_load_dwordx4 v6, s[36:39], s62 offen offset:1024 lds
  v_mfma_f32_16x16x32_bf16 v[140:143], v[52:55], a[60:63], v[140:143]
  ds_read_b64_tr_b16 v[78:79], v10 offset:21504
  v_mfma_f32_16x16x32_bf16 v[112:115], v[56:59], a[64:67], v[112:115]
  v_mfma_f32_16x16x32_bf16 v[116:119], v[56:59], a[68:71], v[116:119]
  v_mfma_f32_16x16x32_bf16 v[120:123], v[56:59], a[72:75], v[120:123]
  s_add_u32 m0, s67, 81920
  v_mfma_f32_16x16x32_bf16 v[124:127], v[56:59], a[76:79], v[124:127]
  buffer_load_dwordx4 v6, s[32:35], s63 offen lds
  v_mfma_f32_16x16x32_bf16 v[128:131], v[60:63], a[64:67], v[128:131]
  v_mfma_f32_16x16x32_bf16 v[132:135], v[60:63], a[68:71], v[132:135]
  v_mfma_f32_16x16x32_bf16 v[136:139], v[60:63], a[72:75], v[136:139]
  v_mfma_f32_16x16x32_bf16 v[140:143], v[60:63], a[76:79], v[140:143]
  s_waitcnt lgkmcnt(0)
  v_mfma_f32_16x16x32_bf16 v[112:115], v[64:67], a[80:83], v[112:115]
  ds_read_b64_tr_b16 v[48:49], v9 offset:8192
  buffer_load_dwordx4 v6, s[36:39], s64 offen offset:1024 lds
  v_mfma_f32_16x16x32_bf16 v[116:119], v[64:67], a[84:87], v[116:119]
  ds_read_b64_tr_b16 v[50:51], v9 offset:12288
  v_mfma_f32_16x16x32_bf16 v[120:123], v[64:67], a[88:91], v[120:123]
  ds_read_b64_tr_b16 v[52:53], v10 offset:8192
  v_mfma_f32_16x16x32_bf16 v[124:127], v[64:67], a[92:95], v[124:127]
  ds_read_b64_tr_b16 v[54:55], v10 offset:12288
  v_mfma_f32_16x16x32_bf16 v[128:131], v[68:71], a[80:83], v[128:131]
  ds_read_b64_tr_b16 v[56:57], v9 offset:9216
  s_add_u32 m0, s67, 49152
  v_mfma_f32_16x16x32_bf16 v[132:135], v[68:71], a[84:87], v[132:135]
  ds_read_b64_tr_b16 v[58:59], v9 offset:13312
  buffer_load_dwordx4 v6, s[32:35], s65 offen lds
  v_mfma_f32_16x16x32_bf16 v[136:139], v[68:71], a[88:91], v[136:139]
  ds_read_b64_tr_b16 v[60:61], v10 offset:9216
  v_mfma_f32_16x16x32_bf16 v[140:143], v[68:71], a[92:95], v[140:143]
  ds_read_b64_tr_b16 v[62:63], v10 offset:13312
  v_mfma_f32_16x16x32_bf16 v[112:115], v[72:75], a[96:99], v[112:115]
  v_mfma_f32_16x16x32_bf16 v[116:119], v[72:75], a[100:103], v[116:119]
  v_mfma_f32_16x16x32_bf16 v[120:123], v[72:75], a[104:107], v[120:123]
  buffer_load_dwordx4 v6, s[36:39], s66 offen offset:1024 lds
  v_mfma_f32_16x16x32_bf16 v[124:127], v[72:75], a[108:111], v[124:127]
  v_mfma_f32_16x16x32_bf16 v[128:131], v[76:79], a[96:99], v[128:131]
  v_mfma_f32_16x16x32_bf16 v[132:135], v[76:79], a[100:103], v[132:135]
  v_mfma_f32_16x16x32_bf16 v[136:139], v[76:79], a[104:107], v[136:139]
  v_mfma_f32_16x16x32_bf16 v[140:143], v[76:79], a[108:111], v[140:143]
  buffer_store_dwordx4 v[220:223], v26, s[16:19], s70 offen  sc1
  s_waitcnt lgkmcnt(0)
  v_mfma_f32_16x16x32_bf16 v[112:115], v[48:51], a[112:115], v[112:115]
  ds_read_b64_tr_b16 v[64:65], v11 offset:8192
  s_add_u32 s70, s70, 2048
  v_mfma_f32_16x16x32_bf16 v[116:119], v[48:51], a[116:119], v[116:119]
  ds_read_b64_tr_b16 v[66:67], v11 offset:12288
  v_mfma_f32_16x16x32_bf16 v[120:123], v[48:51], a[120:123], v[120:123]
  ds_read_b64_tr_b16 v[68:69], v12 offset:8192
  v_mfma_f32_16x16x32_bf16 v[124:127], v[48:51], a[124:127], v[124:127]
  ds_read_b64_tr_b16 v[70:71], v12 offset:12288
  v_mfma_f32_16x16x32_bf16 v[128:131], v[52:55], a[112:115], v[128:131]
  ds_read_b64_tr_b16 v[72:73], v11 offset:9216
  buffer_store_dwordx4 v[144:147], v23, s[16:19], s70 offen  sc1
  v_mfma_f32_16x16x32_bf16 v[132:135], v[52:55], a[116:119], v[132:135]
  ds_read_b64_tr_b16 v[74:75], v11 offset:13312
  v_mfma_f32_16x16x32_bf16 v[136:139], v[52:55], a[120:123], v[136:139]
  ds_read_b64_tr_b16 v[76:77], v12 offset:9216
  v_mfma_f32_16x16x32_bf16 v[140:143], v[52:55], a[124:127], v[140:143]
  ds_read_b64_tr_b16 v[78:79], v12 offset:13312
  v_mfma_f32_16x16x32_bf16 v[112:115], v[56:59], a[128:131], v[112:115]
  v_mfma_f32_16x16x32_bf16 v[116:119], v[56:59], a[132:135], v[116:119]
  buffer_store_dwordx4 v[148:151], v24, s[16:19], s70 offen  sc1
  v_mfma_f32_16x16x32_bf16 v[120:123], v[56:59], a[136:139], v[120:123]
  v_mfma_f32_16x16x32_bf16 v[124:127], v[56:59], a[140:143], v[124:127]
  v_mfma_f32_16x16x32_bf16 v[128:131], v[60:63], a[128:131], v[128:131]
  v_mfma_f32_16x16x32_bf16 v[132:135], v[60:63], a[132:135], v[132:135]
  v_mfma_f32_16x16x32_bf16 v[136:139], v[60:63], a[136:139], v[136:139]
  buffer_store_dwordx4 v[152:155], v25, s[16:19], s70 offen  sc1
  v_mfma_f32_16x16x32_bf16 v[140:143], v[60:63], a[140:143], v[140:143]
  s_waitcnt vmcnt(39) lgkmcnt(0)
  s_barrier
  v_mfma_f32_16x16x32_bf16 v[208:211], v[64:67], a[0:3], 0
  ds_read_b64_tr_b16 v[48:49], v11 offset:0
  v_cvt_pk_bf16_f32 v112, v112, v113
  v_mfma_f32_16x16x32_bf16 v[212:215], v[64:67], a[4:7], 0
  ds_read_b64_tr_b16 v[50:51], v11 offset:4096
  v_cvt_pk_bf16_f32 v113, v114, v115
  v_mfma_f32_16x16x32_bf16 v[216:219], v[64:67], a[8:11], 0
  ds_read_b64_tr_b16 v[52:53], v12 offset:0
  s_add_u32 m0, s67, 73728
  v_mfma_f32_16x16x32_bf16 v[220:223], v[64:67], a[12:15], 0
  ds_read_b64_tr_b16 v[54:55], v12 offset:4096
  v_add_u32 v6, 128, v6
  v_mfma_f32_16x16x32_bf16 v[224:227], v[68:71], a[0:3], 0
  ds_read_b64_tr_b16 v[56:57], v11 offset:1024
  buffer_load_dwordx4 v6, s[32:35], s58 offen lds
  v_mfma_f32_16x16x32_bf16 v[228:231], v[68:71], a[4:7], 0
  ds_read_b64_tr_b16 v[58:59], v11 offset:5120
  v_cvt_pk_bf16_f32 v114, v128, v129
  v_mfma_f32_16x16x32_bf16 v[232:235], v[68:71], a[8:11], 0
  ds_read_b64_tr_b16 v[60:61], v12 offset:1024
  v_cvt_pk_bf16_f32 v115, v130, v131
  v_mfma_f32_16x16x32_bf16 v[236:239], v[68:71], a[12:15], 0
  ds_read_b64_tr_b16 v[62:63], v12 offset:5120
  v_cvt_pk_bf16_f32 v116, v116, v117
  v_mfma_f32_16x16x32_bf16 v[208:211], v[72:75], a[16:19], v[208:211]
  v_cvt_pk_bf16_f32 v117, v118, v119
  v_cvt_pk_bf16_f32 v118, v132, v133
  v_mfma_f32_16x16x32_bf16 v[212:215], v[72:75], a[20:23], v[212:215]
  buffer_load_dwordx4 v6, s[36:39], s59 offen offset:1024 lds
  v_cvt_pk_bf16_f32 v119, v134, v135
  v_mfma_f32_16x16x32_bf16 v[216:219], v[72:75], a[24:27], v[216:219]
  v_cvt_pk_bf16_f32 v120, v120, v121
  v_cvt_pk_bf16_f32 v121, v122, v123
  v_mfma_f32_16x16x32_bf16 v[220:223], v[72:75], a[28:31], v[220:223]
  v_cvt_pk_bf16_f32 v122, v136, v137
  v_cvt_pk_bf16_f32 v123, v138, v139
  v_mfma_f32_16x16x32_bf16 v[224:227], v[76:79], a[16:19], v[224:227]
  v_cvt_pk_bf16_f32 v124, v124, v125
  v_cvt_pk_bf16_f32 v125, v126, v127
  v_mfma_f32_16x16x32_bf16 v[228:231], v[76:79], a[20:23], v[228:231]
  s_add_u32 m0, s67, 16384
  v_cvt_pk_bf16_f32 v126, v140, v141
  v_mfma_f32_16x16x32_bf16 v[232:235], v[76:79], a[24:27], v[232:235]
  buffer_load_dwordx4 v6, s[32:35], s60 offen lds
  v_cvt_pk_bf16_f32 v127, v142, v143
  v_mfma_f32_16x16x32_bf16 v[236:239], v[76:79], a[28:31], v[236:239]
  s_waitcnt lgkmcnt(0)
  v_mfma_f32_16x16x32_bf16 v[208:211], v[48:51], a[32:35], v[208:211]
  ds_read_b64_tr_b16 v[64:65], v9 offset:0
  v_mfma_f32_16x16x32_bf16 v[212:215], v[48:51], a[36:39], v[212:215]
  ds_read_b64_tr_b16 v[66:67], v9 offset:4096
  v_mfma_f32_16x16x32_bf16 v[216:219], v[48:51], a[40:43], v[216:219]
  ds_read_b64_tr_b16 v[68:69], v10 offset:0
  v_mfma_f32_16x16x32_bf16 v[220:223], v[48:51], a[44:47], v[220:223]
  ds_read_b64_tr_b16 v[70:71], v10 offset:4096
  buffer_load_dwordx4 v6, s[36:39], s61 offen offset:1024 lds
  v_mfma_f32_16x16x32_bf16 v[224:227], v[52:55], a[32:35], v[224:227]
  ds_read_b64_tr_b16 v[72:73], v9 offset:1024
  v_mfma_f32_16x16x32_bf16 v[228:231], v[52:55], a[36:39], v[228:231]
  ds_read_b64_tr_b16 v[74:75], v9 offset:5120
  v_mfma_f32_16x16x32_bf16 v[232:235], v[52:55], a[40:43], v[232:235]
  ds_read_b64_tr_b16 v[76:77], v10 offset:1024
  v_mfma_f32_16x16x32_bf16 v[236:239], v[52:55], a[44:47], v[236:239]
  ds_read_b64_tr_b16 v[78:79], v10 offset:5120
  s_add_u32 m0, s67, 8192
  v_mfma_f32_16x16x32_bf16 v[208:211], v[56:59], a[48:51], v[208:211]
  buffer_load_dwordx4 v6, s[32:35], s62 offen lds
  v_mfma_f32_16x16x32_bf16 v[212:215], v[56:59], a[52:55], v[212:215]
  v_mfma_f32_16x16x32_bf16 v[216:219], v[56:59], a[56:59], v[216:219]
  v_mfma_f32_16x16x32_bf16 v[220:223], v[56:59], a[60:63], v[220:223]
  v_mfma_f32_16x16x32_bf16 v[224:227], v[60:63], a[48:51], v[224:227]
  v_mfma_f32_16x16x32_bf16 v[228:231], v[60:63], a[52:55], v[228:231]
  buffer_load_dwordx4 v6, s[36:39], s63 offen offset:1024 lds
  v_mfma_f32_16x16x32_bf16 v[232:235], v[60:63], a[56:59], v[232:235]
  v_mfma_f32_16x16x32_bf16 v[236:239], v[60:63], a[60:63], v[236:239]
  s_waitcnt lgkmcnt(0)
  v_mfma_f32_16x16x32_bf16 v[208:211], v[64:67], a[64:67], v[208:211]
  ds_read_b64_tr_b16 v[48:49], v11 offset:32768
  v_mfma_f32_16x16x32_bf16 v[212:215], v[64:67], a[68:71], v[212:215]
  ds_read_b64_tr_b16 v[50:51], v11 offset:36864
  v_mfma_f32_16x16x32_bf16 v[216:219], v[64:67], a[72:75], v[216:219]
  ds_read_b64_tr_b16 v[52:53], v12 offset:32768
  buffer_store_dwordx4 v[156:159], v26, s[16:19], s70 offen  sc1
  v_mfma_f32_16x16x32_bf16 v[220:223], v[64:67], a[76:79], v[220:223]
  ds_read_b64_tr_b16 v[54:55], v12 offset:36864
  s_add_u32 s70, s70, 2048
  v_mfma_f32_16x16x32_bf16 v[224:227], v[68:71], a[64:67], v[224:227]
  ds_read_b64_tr_b16 v[56:57], v11 offset:33792
  v_mfma_f32_16x16x32_bf16 v[228:231], v[68:71], a[68:71], v[228:231]
  ds_read_b64_tr_b16 v[58:59], v11 offset:37888
  v_mfma_f32_16x16x32_bf16 v[232:235], v[68:71], a[72:75], v[232:235]
  ds_read_b64_tr_b16 v[60:61], v12 offset:33792
  v_mfma_f32_16x16x32_bf16 v[236:239], v[68:71], a[76:79], v[236:239]
  ds_read_b64_tr_b16 v[62:63], v12 offset:37888
  buffer_store_dwordx4 v[112:115], v23, s[16:19], s70 offen  sc1
  v_mfma_f32_16x16x32_bf16 v[208:211], v[72:75], a[80:83], v[208:211]
  v_mfma_f32_16x16x32_bf16 v[212:215], v[72:75], a[84:87], v[212:215]
  v_mfma_f32_16x16x32_bf16 v[216:219], v[72:75], a[88:91], v[216:219]
  v_mfma_f32_16x16x32_bf16 v[220:223], v[72:75], a[92:95], v[220:223]
  v_mfma_f32_16x16x32_bf16 v[224:227], v[76:79], a[80:83], v[224:227]
  buffer_store_dwordx4 v[116:119], v24, s[16:19], s70 offen  sc1
  v_mfma_f32_16x16x32_bf16 v[228:231], v[76:79], a[84:87], v[228:231]
  v_mfma_f32_16x16x32_bf16 v[232:235], v[76:79], a[88:91], v[232:235]
  v_mfma_f32_16x16x32_bf16 v[236:239], v[76:79], a[92:95], v[236:239]
  s_waitcnt vmcnt(42) lgkmcnt(0)
  s_barrier
  v_mfma_f32_16x16x32_bf16 v[208:211], v[48:51], a[96:99], v[208:211]
  ds_read_b64_tr_b16 v[64:65], v11 offset:24576
  s_add_u32 m0, s67, 98304
  v_mfma_f32_16x16x32_bf16 v[212:215], v[48:51], a[100:103], v[212:215]
  ds_read_b64_tr_b16 v[66:67], v11 offset:28672
  buffer_load_dwordx4 v6, s[32:35], s64 offen lds
  v_mfma_f32_16x16x32_bf16 v[216:219], v[48:51], a[104:107], v[216:219]
  ds_read_b64_tr_b16 v[68:69], v12 offset:24576
  v_mfma_f32_16x16x32_bf16 v[220:223], v[48:51], a[108:111], v[220:223]
  ds_read_b64_tr_b16 v[70:71], v12 offset:28672
  v_mfma_f32_16x16x32_bf16 v[224:227], v[52:55], a[96:99], v[224:227]
  ds_read_b64_tr_b16 v[72:73], v11 offset:25600
  v_mfma_f32_16x16x32_bf16 v[228:231], v[52:55], a[100:103], v[228:231]
  ds_read_b64_tr_b16 v[74:75], v11 offset:29696
  v_mfma_f32_16x16x32_bf16 v[232:235], v[52:55], a[104:107], v[232:235]
  ds_read_b64_tr_b16 v[76:77], v12 offset:25600
  buffer_load_dwordx4 v6, s[36:39], s65 offen offset:1024 lds
  v_mfma_f32_16x16x32_bf16 v[236:239], v[52:55], a[108:111], v[236:239]
  ds_read_b64_tr_b16 v[78:79], v12 offset:29696
  v_mfma_f32_16x16x32_bf16 v[208:211], v[56:59], a[112:115], v[208:211]
  v_mfma_f32_16x16x32_bf16 v[212:215], v[56:59], a[116:119], v[212:215]
  v_mfma_f32_16x16x32_bf16 v[216:219], v[56:59], a[120:123], v[216:219]
  s_add_u32 m0, s67, 65536
  v_mfma_f32_16x16x32_bf16 v[220:223], v[56:59], a[124:127], v[220:223]
  buffer_load_dwordx4 v6, s[32:35], s66 offen lds
  v_mfma_f32_16x16x32_bf16 v[224:227], v[60:63], a[112:115], v[224:227]
  v_mfma_f32_16x16x32_bf16 v[228:231], v[60:63], a[116:119], v[228:231]
  v_mfma_f32_16x16x32_bf16 v[232:235], v[60:63], a[120:123], v[232:235]
  v_mfma_f32_16x16x32_bf16 v[236:239], v[60:63], a[124:127], v[236:239]
  s_waitcnt lgkmcnt(0)
  v_mfma_f32_16x16x32_bf16 v[208:211], v[64:67], a[128:131], v[208:211]
  ds_read_b64_tr_b16 v[48:49], v13 offset:16384
  buffer_store_dwordx4 v[120:123], v25, s[16:19], s70 offen  sc1
  v_mfma_f32_16x16x32_bf16 v[212:215], v[64:67], a[132:135], v[212:215]
  ds_read_b64_tr_b16 v[50:51], v13 offset:20480
  v_mfma_f32_16x16x32_bf16 v[216:219], v[64:67], a[136:139], v[216:219]
  ds_read_b64_tr_b16 v[52:53], v14 offset:16384
  v_mfma_f32_16x16x32_bf16 v[220:223], v[64:67], a[140:143], v[220:223]
  ds_read_b64_tr_b16 v[54:55], v14 offset:20480
  v_mfma_f32_16x16x32_bf16 v[224:227], v[68:71], a[128:131], v[224:227]
  ds_read_b64_tr_b16 v[56:57], v13 offset:17408
  v_mfma_f32_16x16x32_bf16 v[228:231], v[68:71], a[132:135], v[228:231]
  ds_read_b64_tr_b16 v[58:59], v13 offset:21504
  buffer_store_dwordx4 v[124:127], v26, s[16:19], s70 offen  sc1
  v_mfma_f32_16x16x32_bf16 v[232:235], v[68:71], a[136:139], v[232:235]
  ds_read_b64_tr_b16 v[60:61], v14 offset:17408
  v_mfma_f32_16x16x32_bf16 v[236:239], v[68:71], a[140:143], v[236:239]
  ds_read_b64_tr_b16 v[62:63], v14 offset:21504
  s_add_u32 s70, s70, 2048
  v_mfma_f32_16x16x32_bf16 v[144:147], v[72:75], a[0:3], 0
  v_cvt_pk_bf16_f32 v208, v208, v209
  v_cvt_pk_bf16_f32 v209, v210, v211
  v_mfma_f32_16x16x32_bf16 v[148:151], v[72:75], a[4:7], 0
  v_cvt_pk_bf16_f32 v210, v224, v225
  v_cvt_pk_bf16_f32 v211, v226, v227
  v_mfma_f32_16x16x32_bf16 v[152:155], v[72:75], a[8:11], 0
  buffer_store_dwordx4 v[208:211], v23, s[16:19], s70 offen  sc1
  v_cvt_pk_bf16_f32 v212, v212, v213
  v_mfma_f32_16x16x32_bf16 v[156:159], v[72:75], a[12:15], 0
  v_cvt_pk_bf16_f32 v213, v214, v215
  v_cvt_pk_bf16_f32 v214, v228, v229
  v_mfma_f32_16x16x32_bf16 v[160:163], v[76:79], a[0:3], 0
  v_cvt_pk_bf16_f32 v215, v230, v231
  v_cvt_pk_bf16_f32 v216, v216, v217
  v_mfma_f32_16x16x32_bf16 v[164:167], v[76:79], a[4:7], 0
  v_cvt_pk_bf16_f32 v217, v218, v219
  v_cvt_pk_bf16_f32 v218, v232, v233
  v_mfma_f32_16x16x32_bf16 v[168:171], v[76:79], a[8:11], 0
  v_cvt_pk_bf16_f32 v219, v234, v235
  v_cvt_pk_bf16_f32 v220, v220, v221
  v_mfma_f32_16x16x32_bf16 v[172:175], v[76:79], a[12:15], 0
  buffer_store_dwordx4 v[212:215], v24, s[16:19], s70 offen  sc1
  s_waitcnt lgkmcnt(0)
  v_mfma_f32_16x16x32_bf16 v[144:147], v[48:51], a[16:19], v[144:147]
  ds_read_b64_tr_b16 v[64:65], v13 offset:8192
  v_cvt_pk_bf16_f32 v221, v222, v223
  v_mfma_f32_16x16x32_bf16 v[148:151], v[48:51], a[20:23], v[148:151]
  ds_read_b64_tr_b16 v[66:67], v13 offset:12288
  v_cvt_pk_bf16_f32 v222, v236, v237
  v_mfma_f32_16x16x32_bf16 v[152:155], v[48:51], a[24:27], v[152:155]
  ds_read_b64_tr_b16 v[68:69], v14 offset:8192
  v_cvt_pk_bf16_f32 v223, v238, v239
  v_mfma_f32_16x16x32_bf16 v[156:159], v[48:51], a[28:31], v[156:159]
  ds_read_b64_tr_b16 v[70:71], v14 offset:12288
  v_mfma_f32_16x16x32_bf16 v[160:163], v[52:55], a[16:19], v[160:163]
  ds_read_b64_tr_b16 v[72:73], v13 offset:9216
  buffer_store_dwordx4 v[216:219], v25, s[16:19], s70 offen  sc1
  v_mfma_f32_16x16x32_bf16 v[164:167], v[52:55], a[20:23], v[164:167]
  ds_read_b64_tr_b16 v[74:75], v13 offset:13312
  v_mfma_f32_16x16x32_bf16 v[168:171], v[52:55], a[24:27], v[168:171]
  ds_read_b64_tr_b16 v[76:77], v14 offset:9216
  v_mfma_f32_16x16x32_bf16 v[172:175], v[52:55], a[28:31], v[172:175]
  ds_read_b64_tr_b16 v[78:79], v14 offset:13312
  v_mfma_f32_16x16x32_bf16 v[144:147], v[56:59], a[32:35], v[144:147]
  v_mfma_f32_16x16x32_bf16 v[148:151], v[56:59], a[36:39], v[148:151]
  buffer_store_dwordx4 v[220:223], v26, s[16:19], s70 offen  sc1
  v_mfma_f32_16x16x32_bf16 v[152:155], v[56:59], a[40:43], v[152:155]
  v_mfma_f32_16x16x32_bf16 v[156:159], v[56:59], a[44:47], v[156:159]
  v_mfma_f32_16x16x32_bf16 v[160:163], v[60:63], a[32:35], v[160:163]
  v_mfma_f32_16x16x32_bf16 v[164:167], v[60:63], a[36:39], v[164:167]
  v_mfma_f32_16x16x32_bf16 v[168:171], v[60:63], a[40:43], v[168:171]
  v_mfma_f32_16x16x32_bf16 v[172:175], v[60:63], a[44:47], v[172:175]
  s_waitcnt vmcnt(45) lgkmcnt(0)
  s_barrier
  v_mfma_f32_16x16x32_bf16 v[144:147], v[64:67], a[48:51], v[144:147]
  ds_read_b64_tr_b16 v[48:49], v9 offset:57344
  v_mfma_f32_16x16x32_bf16 v[148:151], v[64:67], a[52:55], v[148:151]
  ds_read_b64_tr_b16 v[50:51], v9 offset:61440
  v_mfma_f32_16x16x32_bf16 v[152:155], v[64:67], a[56:59], v[152:155]
  ds_read_b64_tr_b16 v[52:53], v10 offset:57344
  v_mfma_f32_16x16x32_bf16 v[156:159], v[64:67], a[60:63], v[156:159]
  ds_read_b64_tr_b16 v[54:55], v10 offset:61440
  v_mfma_f32_16x16x32_bf16 v[160:163], v[68:71], a[48:51], v[160:163]
  ds_read_b64_tr_b16 v[56:57], v9 offset:58368
  v_mfma_f32_16x16x32_bf16 v[164:167], v[68:71], a[52:55], v[164:167]
  ds_read_b64_tr_b16 v[58:59], v9 offset:62464
  v_mfma_f32_16x16x32_bf16 v[168:171], v[68:71], a[56:59], v[168:171]
  ds_read_b64_tr_b16 v[60:61], v10 offset:58368
  v_mfma_f32_16x16x32_bf16 v[172:175], v[68:71], a[60:63], v[172:175]
  ds_read_b64_tr_b16 v[62:63], v10 offset:62464
  v_mfma_f32_16x16x32_bf16 v[144:147], v[72:75], a[64:67], v[144:147]
  v_mfma_f32_16x16x32_bf16 v[148:151], v[72:75], a[68:71], v[148:151]
  v_mfma_f32_16x16x32_bf16 v[152:155], v[72:75], a[72:75], v[152:155]
  v_mfma_f32_16x16x32_bf16 v[156:159], v[72:75], a[76:79], v[156:159]
  v_mfma_f32_16x16x32_bf16 v[160:163], v[76:79], a[64:67], v[160:163]
  v_mfma_f32_16x16x32_bf16 v[164:167], v[76:79], a[68:71], v[164:167]
  v_mfma_f32_16x16x32_bf16 v[168:171], v[76:79], a[72:75], v[168:171]
  v_mfma_f32_16x16x32_bf16 v[172:175], v[76:79], a[76:79], v[172:175]
  s_waitcnt lgkmcnt(0)
  v_mfma_f32_16x16x32_bf16 v[144:147], v[48:51], a[80:83], v[144:147]
  ds_read_b64_tr_b16 v[64:65], v13 offset:24576
  v_mfma_f32_16x16x32_bf16 v[148:151], v[48:51], a[84:87], v[148:151]
  ds_read_b64_tr_b16 v[66:67], v13 offset:28672
  v_mfma_f32_16x16x32_bf16 v[152:155], v[48:51], a[88:91], v[152:155]
  ds_read_b64_tr_b16 v[68:69], v14 offset:24576
  v_mfma_f32_16x16x32_bf16 v[156:159], v[48:51], a[92:95], v[156:159]
  ds_read_b64_tr_b16 v[70:71], v14 offset:28672
  v_mfma_f32_16x16x32_bf16 v[160:163], v[52:55], a[80:83], v[160:163]
  ds_read_b64_tr_b16 v[72:73], v13 offset:25600
  v_mfma_f32_16x16x32_bf16 v[164:167], v[52:55], a[84:87], v[164:167]
  ds_read_b64_tr_b16 v[74:75], v13 offset:29696
  v_mfma_f32_16x16x32_bf16 v[168:171], v[52:55], a[88:91], v[168:171]
  ds_read_b64_tr_b16 v[76:77], v14 offset:25600
  v_mfma_f32_16x16x32_bf16 v[172:175], v[52:55], a[92:95], v[172:175]
  ds_read_b64_tr_b16 v[78:79], v14 offset:29696
  v_mfma_f32_16x16x32_bf16 v[144:147], v[56:59], a[96:99], v[144:147]
  v_mfma_f32_16x16x32_bf16 v[148:151], v[56:59], a[100:103], v[148:151]
  v_mfma_f32_16x16x32_bf16 v[152:155], v[56:59], a[104:107], v[152:155]
  v_mfma_f32_16x16x32_bf16 v[156:159], v[56:59], a[108:111], v[156:159]
  v_mfma_f32_16x16x32_bf16 v[160:163], v[60:63], a[96:99], v[160:163]
  v_mfma_f32_16x16x32_bf16 v[164:167], v[60:63], a[100:103], v[164:167]
  v_mfma_f32_16x16x32_bf16 v[168:171], v[60:63], a[104:107], v[168:171]
  v_mfma_f32_16x16x32_bf16 v[172:175], v[60:63], a[108:111], v[172:175]
  s_waitcnt lgkmcnt(0)
  v_mfma_f32_16x16x32_bf16 v[144:147], v[64:67], a[112:115], v[144:147]
  ds_read_b64_tr_b16 v[48:49], v11 offset:57344
  v_mfma_f32_16x16x32_bf16 v[148:151], v[64:67], a[116:119], v[148:151]
  ds_read_b64_tr_b16 v[50:51], v11 offset:61440
  v_mfma_f32_16x16x32_bf16 v[152:155], v[64:67], a[120:123], v[152:155]
  ds_read_b64_tr_b16 v[52:53], v12 offset:57344
  v_mfma_f32_16x16x32_bf16 v[156:159], v[64:67], a[124:127], v[156:159]
  ds_read_b64_tr_b16 v[54:55], v12 offset:61440
  v_mfma_f32_16x16x32_bf16 v[160:163], v[68:71], a[112:115], v[160:163]
  ds_read_b64_tr_b16 v[56:57], v11 offset:58368
  v_mfma_f32_16x16x32_bf16 v[164:167], v[68:71], a[116:119], v[164:167]
  ds_read_b64_tr_b16 v[58:59], v11 offset:62464
  v_mfma_f32_16x16x32_bf16 v[168:171], v[68:71], a[120:123], v[168:171]
  ds_read_b64_tr_b16 v[60:61], v12 offset:58368
  v_mfma_f32_16x16x32_bf16 v[172:175], v[68:71], a[124:127], v[172:175]
  ds_read_b64_tr_b16 v[62:63], v12 offset:62464
  v_mfma_f32_16x16x32_bf16 v[144:147], v[72:75], a[128:131], v[144:147]
  v_mfma_f32_16x16x32_bf16 v[148:151], v[72:75], a[132:135], v[148:151]
  v_mfma_f32_16x16x32_bf16 v[152:155], v[72:75], a[136:139], v[152:155]
  v_mfma_f32_16x16x32_bf16 v[156:159], v[72:75], a[140:143], v[156:159]
  v_mfma_f32_16x16x32_bf16 v[160:163], v[76:79], a[128:131], v[160:163]
  v_mfma_f32_16x16x32_bf16 v[164:167], v[76:79], a[132:135], v[164:167]
  v_mfma_f32_16x16x32_bf16 v[168:171], v[76:79], a[136:139], v[168:171]
  v_mfma_f32_16x16x32_bf16 v[172:175], v[76:79], a[140:143], v[172:175]
  s_waitcnt vmcnt(37) lgkmcnt(0)
  s_barrier
  v_mfma_f32_16x16x32_bf16 v[112:115], v[48:51], a[0:3], 0
  ds_read_b64_tr_b16 v[64:65], v9 offset:40960
  s_add_u32 s70, s70, 2048
  v_mfma_f32_16x16x32_bf16 v[116:119], v[48:51], a[4:7], 0
  ds_read_b64_tr_b16 v[66:67], v9 offset:45056
  v_cvt_pk_bf16_f32 v144, v144, v145
  v_mfma_f32_16x16x32_bf16 v[120:123], v[48:51], a[8:11], 0
  ds_read_b64_tr_b16 v[68:69], v10 offset:40960
  v_cvt_pk_bf16_f32 v145, v146, v147
  v_mfma_f32_16x16x32_bf16 v[124:127], v[48:51], a[12:15], 0
  ds_read_b64_tr_b16 v[70:71], v10 offset:45056
  v_cvt_pk_bf16_f32 v146, v160, v161
  v_mfma_f32_16x16x32_bf16 v[128:131], v[52:55], a[0:3], 0
  ds_read_b64_tr_b16 v[72:73], v9 offset:41984
  v_cvt_pk_bf16_f32 v147, v162, v163
  v_mfma_f32_16x16x32_bf16 v[132:135], v[52:55], a[4:7], 0
  ds_read_b64_tr_b16 v[74:75], v9 offset:46080
  buffer_store_dwordx4 v[144:147], v23, s[16:19], s70 offen  sc1
  v_mfma_f32_16x16x32_bf16 v[136:139], v[52:55], a[8:11], 0
  ds_read_b64_tr_b16 v[76:77], v10 offset:41984
  v_cvt_pk_bf16_f32 v148, v148, v149
  v_mfma_f32_16x16x32_bf16 v[140:143], v[52:55], a[12:15], 0
  ds_read_b64_tr_b16 v[78:79], v10 offset:46080
  v_cvt_pk_bf16_f32 v149, v150, v151
  v_mfma_f32_16x16x32_bf16 v[112:115], v[56:59], a[16:19], v[112:115]
  v_cvt_pk_bf16_f32 v150, v164, v165
  v_cvt_pk_bf16_f32 v151, v166, v167
  v_mfma_f32_16x16x32_bf16 v[116:119], v[56:59], a[20:23], v[116:119]
  v_cvt_pk_bf16_f32 v152, v152, v153
  v_cvt_pk_bf16_f32 v153, v154, v155
  v_mfma_f32_16x16x32_bf16 v[120:123], v[56:59], a[24:27], v[120:123]
  buffer_store_dwordx4 v[148:151], v24, s[16:19], s70 offen  sc1
  v_cvt_pk_bf16_f32 v154, v168, v169
  v_mfma_f32_16x16x32_bf16 v[124:127], v[56:59], a[28:31], v[124:127]
  v_cvt_pk_bf16_f32 v155, v170, v171
  v_cvt_pk_bf16_f32 v156, v156, v157
  v_mfma_f32_16x16x32_bf16 v[128:131], v[60:63], a[16:19], v[128:131]
  v_cvt_pk_bf16_f32 v157, v158, v159
  v_cvt_pk_bf16_f32 v158, v172, v173
  v_mfma_f32_16x16x32_bf16 v[132:135], v[60:63], a[20:23], v[132:135]
  v_cvt_pk_bf16_f32 v159, v174, v175
  v_mfma_f32_16x16x32_bf16 v[136:139], v[60:63], a[24:27], v[136:139]
  v_mfma_f32_16x16x32_bf16 v[140:143], v[60:63], a[28:31], v[140:143]
  buffer_store_dwordx4 v[152:155], v25, s[16:19], s70 offen  sc1
  s_waitcnt lgkmcnt(0)
  v_mfma_f32_16x16x32_bf16 v[112:115], v[64:67], a[32:35], v[112:115]
  ds_read_b64_tr_b16 v[48:49], v9 offset:32768
  v_mfma_f32_16x16x32_bf16 v[116:119], v[64:67], a[36:39], v[116:119]
  ds_read_b64_tr_b16 v[50:51], v9 offset:36864
  v_mfma_f32_16x16x32_bf16 v[120:123], v[64:67], a[40:43], v[120:123]
  ds_read_b64_tr_b16 v[52:53], v10 offset:32768
  v_mfma_f32_16x16x32_bf16 v[124:127], v[64:67], a[44:47], v[124:127]
  ds_read_b64_tr_b16 v[54:55], v10 offset:36864
  v_mfma_f32_16x16x32_bf16 v[128:131], v[68:71], a[32:35], v[128:131]
  ds_read_b64_tr_b16 v[56:57], v9 offset:33792
  buffer_store_dwordx4 v[156:159], v26, s[16:19], s70 offen  sc1
  v_mfma_f32_16x16x32_bf16 v[132:135], v[68:71], a[36:39], v[132:135]
  ds_read_b64_tr_b16 v[58:59], v9 offset:37888
  v_mfma_f32_16x16x32_bf16 v[136:139], v[68:71], a[40:43], v[136:139]
  ds_read_b64_tr_b16 v[60:61], v10 offset:33792
  v_mfma_f32_16x16x32_bf16 v[140:143], v[68:71], a[44:47], v[140:143]
  ds_read_b64_tr_b16 v[62:63], v10 offset:37888
  v_mfma_f32_16x16x32_bf16 v[112:115], v[72:75], a[48:51], v[112:115]
  v_mfma_f32_16x16x32_bf16 v[116:119], v[72:75], a[52:55], v[116:119]
  v_mfma_f32_16x16x32_bf16 v[120:123], v[72:75], a[56:59], v[120:123]
  v_mfma_f32_16x16x32_bf16 v[124:127], v[72:75], a[60:63], v[124:127]
  v_mfma_f32_16x16x32_bf16 v[128:131], v[76:79], a[48:51], v[128:131]
  v_mfma_f32_16x16x32_bf16 v[132:135], v[76:79], a[52:55], v[132:135]
  v_mfma_f32_16x16x32_bf16 v[136:139], v[76:79], a[56:59], v[136:139]
  v_mfma_f32_16x16x32_bf16 v[140:143], v[76:79], a[60:63], v[140:143]
  s_waitcnt lgkmcnt(0)
  v_mfma_f32_16x16x32_bf16 v[112:115], v[48:51], a[64:67], v[112:115]
  ds_read_b64_tr_b16 v[64:65], v11 offset:49152
  v_mfma_f32_16x16x32_bf16 v[116:119], v[48:51], a[68:71], v[116:119]
  ds_read_b64_tr_b16 v[66:67], v11 offset:53248
  v_mfma_f32_16x16x32_bf16 v[120:123], v[48:51], a[72:75], v[120:123]
  ds_read_b64_tr_b16 v[68:69], v12 offset:49152
  v_mfma_f32_16x16x32_bf16 v[124:127], v[48:51], a[76:79], v[124:127]
  ds_read_b64_tr_b16 v[70:71], v12 offset:53248
  v_mfma_f32_16x16x32_bf16 v[128:131], v[52:55], a[64:67], v[128:131]
  ds_read_b64_tr_b16 v[72:73], v11 offset:50176
  v_mfma_f32_16x16x32_bf16 v[132:135], v[52:55], a[68:71], v[132:135]
  ds_read_b64_tr_b16 v[74:75], v11 offset:54272
  v_mfma_f32_16x16x32_bf16 v[136:139], v[52:55], a[72:75], v[136:139]
  ds_read_b64_tr_b16 v[76:77], v12 offset:50176
  v_mfma_f32_16x16x32_bf16 v[140:143], v[52:55], a[76:79], v[140:143]
  ds_read_b64_tr_b16 v[78:79], v12 offset:54272
  v_mfma_f32_16x16x32_bf16 v[112:115], v[56:59], a[80:83], v[112:115]
  v_mfma_f32_16x16x32_bf16 v[116:119], v[56:59], a[84:87], v[116:119]
  v_mfma_f32_16x16x32_bf16 v[120:123], v[56:59], a[88:91], v[120:123]
  v_mfma_f32_16x16x32_bf16 v[124:127], v[56:59], a[92:95], v[124:127]
  v_mfma_f32_16x16x32_bf16 v[128:131], v[60:63], a[80:83], v[128:131]
  v_mfma_f32_16x16x32_bf16 v[132:135], v[60:63], a[84:87], v[132:135]
  v_mfma_f32_16x16x32_bf16 v[136:139], v[60:63], a[88:91], v[136:139]
  v_mfma_f32_16x16x32_bf16 v[140:143], v[60:63], a[92:95], v[140:143]
  s_waitcnt vmcnt(30) lgkmcnt(0)
  s_barrier
  v_mfma_f32_16x16x32_bf16 v[112:115], v[64:67], a[96:99], v[112:115]
  ds_read_b64_tr_b16 v[48:49], v11 offset:40960
  v_mfma_f32_16x16x32_bf16 v[116:119], v[64:67], a[100:103], v[116:119]
  ds_read_b64_tr_b16 v[50:51], v11 offset:45056
  v_mfma_f32_16x16x32_bf16 v[120:123], v[64:67], a[104:107], v[120:123]
  ds_read_b64_tr_b16 v[52:53], v12 offset:40960
  v_mfma_f32_16x16x32_bf16 v[124:127], v[64:67], a[108:111], v[124:127]
  ds_read_b64_tr_b16 v[54:55], v12 offset:45056
  v_mfma_f32_16x16x32_bf16 v[128:131], v[68:71], a[96:99], v[128:131]
  ds_read_b64_tr_b16 v[56:57], v11 offset:41984
  v_mfma_f32_16x16x32_bf16 v[132:135], v[68:71], a[100:103], v[132:135]
  ds_read_b64_tr_b16 v[58:59], v11 offset:46080
  v_mfma_f32_16x16x32_bf16 v[136:139], v[68:71], a[104:107], v[136:139]
  ds_read_b64_tr_b16 v[60:61], v12 offset:41984
  v_mfma_f32_16x16x32_bf16 v[140:143], v[68:71], a[108:111], v[140:143]
  ds_read_b64_tr_b16 v[62:63], v12 offset:46080
  v_mfma_f32_16x16x32_bf16 v[112:115], v[72:75], a[112:115], v[112:115]
  v_mfma_f32_16x16x32_bf16 v[116:119], v[72:75], a[116:119], v[116:119]
  v_mfma_f32_16x16x32_bf16 v[120:123], v[72:75], a[120:123], v[120:123]
  v_mfma_f32_16x16x32_bf16 v[124:127], v[72:75], a[124:127], v[124:127]
  v_mfma_f32_16x16x32_bf16 v[128:131], v[76:79], a[112:115], v[128:131]
  v_mfma_f32_16x16x32_bf16 v[132:135], v[76:79], a[116:119], v[132:135]
  v_mfma_f32_16x16x32_bf16 v[136:139], v[76:79], a[120:123], v[136:139]
  v_mfma_f32_16x16x32_bf16 v[140:143], v[76:79], a[124:127], v[140:143]
  s_waitcnt lgkmcnt(0)
  v_mfma_f32_16x16x32_bf16 v[112:115], v[48:51], a[128:131], v[112:115]
  ds_read_b64_tr_b16 v[64:65], v9 offset:24576
  v_mfma_f32_16x16x32_bf16 v[116:119], v[48:51], a[132:135], v[116:119]
  ds_read_b64_tr_b16 v[66:67], v9 offset:28672
  v_mfma_f32_16x16x32_bf16 v[120:123], v[48:51], a[136:139], v[120:123]
  ds_read_b64_tr_b16 v[68:69], v10 offset:24576
  v_mfma_f32_16x16x32_bf16 v[124:127], v[48:51], a[140:143], v[124:127]
  ds_read_b64_tr_b16 v[70:71], v10 offset:28672
  v_mfma_f32_16x16x32_bf16 v[128:131], v[52:55], a[128:131], v[128:131]
  ds_read_b64_tr_b16 v[72:73], v9 offset:25600
  v_mfma_f32_16x16x32_bf16 v[132:135], v[52:55], a[132:135], v[132:135]
  ds_read_b64_tr_b16 v[74:75], v9 offset:29696
  v_mfma_f32_16x16x32_bf16 v[136:139], v[52:55], a[136:139], v[136:139]
  ds_read_b64_tr_b16 v[76:77], v10 offset:25600
  v_mfma_f32_16x16x32_bf16 v[140:143], v[52:55], a[140:143], v[140:143]
  ds_read_b64_tr_b16 v[78:79], v10 offset:29696
  s_add_u32 s70, s70, 2048
  v_mfma_f32_16x16x32_bf16 v[208:211], v[56:59], a[0:3], 0
  v_cvt_pk_bf16_f32 v112, v112, v113
  v_cvt_pk_bf16_f32 v113, v114, v115
  v_mfma_f32_16x16x32_bf16 v[212:215], v[56:59], a[4:7], 0
  v_cvt_pk_bf16_f32 v114, v128, v129
  v_cvt_pk_bf16_f32 v115, v130, v131
  v_mfma_f32_16x16x32_bf16 v[216:219], v[56:59], a[8:11], 0
  buffer_store_dwordx4 v[112:115], v23, s[16:19], s70 offen  sc1
  v_cvt_pk_bf16_f32 v116, v116, v117
  v_mfma_f32_16x16x32_bf16 v[220:223], v[56:59], a[12:15], 0
  v_cvt_pk_bf16_f32 v117, v118, v119
  v_cvt_pk_bf16_f32 v118, v132, v133
  v_mfma_f32_16x16x32_bf16 v[224:227], v[60:63], a[0:3], 0
  v_cvt_pk_bf16_f32 v119, v134, v135
  v_cvt_pk_bf16_f32 v120, v120, v121
  v_mfma_f32_16x16x32_bf16 v[228:231], v[60:63], a[4:7], 0
  v_cvt_pk_bf16_f32 v121, v122, v123
  v_cvt_pk_bf16_f32 v122, v136, v137
  v_mfma_f32_16x16x32_bf16 v[232:235], v[60:63], a[8:11], 0
  v_cvt_pk_bf16_f32 v123, v138, v139
  v_cvt_pk_bf16_f32 v124, v124, v125
  v_mfma_f32_16x16x32_bf16 v[236:239], v[60:63], a[12:15], 0
  buffer_store_dwordx4 v[116:119], v24, s[16:19], s70 offen  sc1
  s_waitcnt lgkmcnt(0)
  v_mfma_f32_16x16x32_bf16 v[208:211], v[64:67], a[16:19], v[208:211]
  ds_read_b64_tr_b16 v[48:49], v13 offset:0
  v_cvt_pk_bf16_f32 v125, v126, v127
  v_mfma_f32_16x16x32_bf16 v[212:215], v[64:67], a[20:23], v[212:215]
  ds_read_b64_tr_b16 v[50:51], v13 offset:4096
  v_cvt_pk_bf16_f32 v126, v140, v141
  v_mfma_f32_16x16x32_bf16 v[216:219], v[64:67], a[24:27], v[216:219]
  ds_read_b64_tr_b16 v[52:53], v14 offset:0
  v_cvt_pk_bf16_f32 v127, v142, v143
  v_mfma_f32_16x16x32_bf16 v[220:223], v[64:67], a[28:31], v[220:223]
  ds_read_b64_tr_b16 v[54:55], v14 offset:4096
  v_mfma_f32_16x16x32_bf16 v[224:227], v[68:71], a[16:19], v[224:227]
  ds_read_b64_tr_b16 v[56:57], v13 offset:1024
  buffer_store_dwordx4 v[120:123], v25, s[16:19], s70 offen  sc1
  v_mfma_f32_16x16x32_bf16 v[228:231], v[68:71], a[20:23], v[228:231]
  ds_read_b64_tr_b16 v[58:59], v13 offset:5120
  v_mfma_f32_16x16x32_bf16 v[232:235], v[68:71], a[24:27], v[232:235]
  ds_read_b64_tr_b16 v[60:61], v14 offset:1024
  v_mfma_f32_16x16x32_bf16 v[236:239], v[68:71], a[28:31], v[236:239]
  ds_read_b64_tr_b16 v[62:63], v14 offset:5120
  v_mfma_f32_16x16x32_bf16 v[208:211], v[72:75], a[32:35], v[208:211]
  v_mfma_f32_16x16x32_bf16 v[212:215], v[72:75], a[36:39], v[212:215]
  buffer_store_dwordx4 v[124:127], v26, s[16:19], s70 offen  sc1
  v_mfma_f32_16x16x32_bf16 v[216:219], v[72:75], a[40:43], v[216:219]
  v_mfma_f32_16x16x32_bf16 v[220:223], v[72:75], a[44:47], v[220:223]
  v_mfma_f32_16x16x32_bf16 v[224:227], v[76:79], a[32:35], v[224:227]
  v_mfma_f32_16x16x32_bf16 v[228:231], v[76:79], a[36:39], v[228:231]
  v_mfma_f32_16x16x32_bf16 v[232:235], v[76:79], a[40:43], v[232:235]
  v_mfma_f32_16x16x32_bf16 v[236:239], v[76:79], a[44:47], v[236:239]
  s_waitcnt vmcnt(24) lgkmcnt(0)
  s_barrier
  v_mfma_f32_16x16x32_bf16 v[208:211], v[48:51], a[48:51], v[208:211]
  ds_read_b64_tr_b16 v[64:65], v11 offset:16384
  v_mfma_f32_16x16x32_bf16 v[212:215], v[48:51], a[52:55], v[212:215]
  ds_read_b64_tr_b16 v[66:67], v11 offset:20480
  v_mfma_f32_16x16x32_bf16 v[216:219], v[48:51], a[56:59], v[216:219]
  ds_read_b64_tr_b16 v[68:69], v12 offset:16384
  v_mfma_f32_16x16x32_bf16 v[220:223], v[48:51], a[60:63], v[220:223]
  ds_read_b64_tr_b16 v[70:71], v12 offset:20480
  v_mfma_f32_16x16x32_bf16 v[224:227], v[52:55], a[48:51], v[224:227]
  ds_read_b64_tr_b16 v[72:73], v11 offset:17408
  v_mfma_f32_16x16x32_bf16 v[228:231], v[52:55], a[52:55], v[228:231]
  ds_read_b64_tr_b16 v[74:75], v11 offset:21504
  v_mfma_f32_16x16x32_bf16 v[232:235], v[52:55], a[56:59], v[232:235]
  ds_read_b64_tr_b16 v[76:77], v12 offset:17408
  v_mfma_f32_16x16x32_bf16 v[236:239], v[52:55], a[60:63], v[236:239]
  ds_read_b64_tr_b16 v[78:79], v12 offset:21504
  v_mfma_f32_16x16x32_bf16 v[208:211], v[56:59], a[64:67], v[208:211]
  v_mfma_f32_16x16x32_bf16 v[212:215], v[56:59], a[68:71], v[212:215]
  v_mfma_f32_16x16x32_bf16 v[216:219], v[56:59], a[72:75], v[216:219]
  v_mfma_f32_16x16x32_bf16 v[220:223], v[56:59], a[76:79], v[220:223]
  v_mfma_f32_16x16x32_bf16 v[224:227], v[60:63], a[64:67], v[224:227]
  v_mfma_f32_16x16x32_bf16 v[228:231], v[60:63], a[68:71], v[228:231]
  v_mfma_f32_16x16x32_bf16 v[232:235], v[60:63], a[72:75], v[232:235]
  v_mfma_f32_16x16x32_bf16 v[236:239], v[60:63], a[76:79], v[236:239]
  s_waitcnt lgkmcnt(0)
  v_mfma_f32_16x16x32_bf16 v[208:211], v[64:67], a[80:83], v[208:211]
  ds_read_b64_tr_b16 v[48:49], v9 offset:49152
  v_mfma_f32_16x16x32_bf16 v[212:215], v[64:67], a[84:87], v[212:215]
  ds_read_b64_tr_b16 v[50:51], v9 offset:53248
  v_mfma_f32_16x16x32_bf16 v[216:219], v[64:67], a[88:91], v[216:219]
  ds_read_b64_tr_b16 v[52:53], v10 offset:49152
  v_mfma_f32_16x16x32_bf16 v[220:223], v[64:67], a[92:95], v[220:223]
  ds_read_b64_tr_b16 v[54:55], v10 offset:53248
  v_mfma_f32_16x16x32_bf16 v[224:227], v[68:71], a[80:83], v[224:227]
  ds_read_b64_tr_b16 v[56:57], v9 offset:50176
  v_mfma_f32_16x16x32_bf16 v[228:231], v[68:71], a[84:87], v[228:231]
  ds_read_b64_tr_b16 v[58:59], v9 offset:54272
  v_mfma_f32_16x16x32_bf16 v[232:235], v[68:71], a[88:91], v[232:235]
  ds_read_b64_tr_b16 v[60:61], v10 offset:50176
  v_mfma_f32_16x16x32_bf16 v[236:239], v[68:71], a[92:95], v[236:239]
  ds_read_b64_tr_b16 v[62:63], v10 offset:54272
  v_mfma_f32_16x16x32_bf16 v[208:211], v[72:75], a[96:99], v[208:211]
  v_mfma_f32_16x16x32_bf16 v[212:215], v[72:75], a[100:103], v[212:215]
  v_mfma_f32_16x16x32_bf16 v[216:219], v[72:75], a[104:107], v[216:219]
  v_mfma_f32_16x16x32_bf16 v[220:223], v[72:75], a[108:111], v[220:223]
  v_mfma_f32_16x16x32_bf16 v[224:227], v[76:79], a[96:99], v[224:227]
  v_mfma_f32_16x16x32_bf16 v[228:231], v[76:79], a[100:103], v[228:231]
  v_mfma_f32_16x16x32_bf16 v[232:235], v[76:79], a[104:107], v[232:235]
  v_mfma_f32_16x16x32_bf16 v[236:239], v[76:79], a[108:111], v[236:239]
  s_waitcnt lgkmcnt(0)
  v_mfma_f32_16x16x32_bf16 v[208:211], v[48:51], a[112:115], v[208:211]
  ds_read_b64_tr_b16 v[64:65], v11 offset:8192
  v_mfma_f32_16x16x32_bf16 v[212:215], v[48:51], a[116:119], v[212:215]
  ds_read_b64_tr_b16 v[66:67], v11 offset:12288
  v_mfma_f32_16x16x32_bf16 v[216:219], v[48:51], a[120:123], v[216:219]
  ds_read_b64_tr_b16 v[68:69], v12 offset:8192
  v_mfma_f32_16x16x32_bf16 v[220:223], v[48:51], a[124:127], v[220:223]
  ds_read_b64_tr_b16 v[70:71], v12 offset:12288
  v_mfma_f32_16x16x32_bf16 v[224:227], v[52:55], a[112:115], v[224:227]
  ds_read_b64_tr_b16 v[72:73], v11 offset:9216
  v_mfma_f32_16x16x32_bf16 v[228:231], v[52:55], a[116:119], v[228:231]
  ds_read_b64_tr_b16 v[74:75], v11 offset:13312
  v_mfma_f32_16x16x32_bf16 v[232:235], v[52:55], a[120:123], v[232:235]
  ds_read_b64_tr_b16 v[76:77], v12 offset:9216
  v_mfma_f32_16x16x32_bf16 v[236:239], v[52:55], a[124:127], v[236:239]
  ds_read_b64_tr_b16 v[78:79], v12 offset:13312
  v_mfma_f32_16x16x32_bf16 v[208:211], v[56:59], a[128:131], v[208:211]
  v_mfma_f32_16x16x32_bf16 v[212:215], v[56:59], a[132:135], v[212:215]
  v_mfma_f32_16x16x32_bf16 v[216:219], v[56:59], a[136:139], v[216:219]
  v_mfma_f32_16x16x32_bf16 v[220:223], v[56:59], a[140:143], v[220:223]
  v_mfma_f32_16x16x32_bf16 v[224:227], v[60:63], a[128:131], v[224:227]
  v_mfma_f32_16x16x32_bf16 v[228:231], v[60:63], a[132:135], v[228:231]
  v_mfma_f32_16x16x32_bf16 v[232:235], v[60:63], a[136:139], v[232:235]
  v_mfma_f32_16x16x32_bf16 v[236:239], v[60:63], a[140:143], v[236:239]
  s_waitcnt vmcnt(15) lgkmcnt(0)
  s_barrier
  v_mfma_f32_16x16x32_bf16 v[144:147], v[64:67], a[0:3], 0
  ds_read_b64_tr_b16 v[48:49], v9 offset:16384
  s_add_u32 s70, s70, 2048
  v_mfma_f32_16x16x32_bf16 v[148:151], v[64:67], a[4:7], 0
  ds_read_b64_tr_b16 v[50:51], v9 offset:20480
  v_cvt_pk_bf16_f32 v208, v208, v209
  v_mfma_f32_16x16x32_bf16 v[152:155], v[64:67], a[8:11], 0
  ds_read_b64_tr_b16 v[52:53], v10 offset:16384
  v_cvt_pk_bf16_f32 v209, v210, v211
  v_mfma_f32_16x16x32_bf16 v[156:159], v[64:67], a[12:15], 0
  ds_read_b64_tr_b16 v[54:55], v10 offset:20480
  v_cvt_pk_bf16_f32 v210, v224, v225
  v_mfma_f32_16x16x32_bf16 v[160:163], v[68:71], a[0:3], 0
  ds_read_b64_tr_b16 v[56:57], v9 offset:17408
  v_cvt_pk_bf16_f32 v211, v226, v227
  v_mfma_f32_16x16x32_bf16 v[164:167], v[68:71], a[4:7], 0
  ds_read_b64_tr_b16 v[58:59], v9 offset:21504
  buffer_store_dwordx4 v[208:211], v23, s[16:19], s70 offen  sc1
  v_mfma_f32_16x16x32_bf16 v[168:171], v[68:71], a[8:11], 0
  ds_read_b64_tr_b16 v[60:61], v10 offset:17408
  v_cvt_pk_bf16_f32 v212, v212, v213
  v_mfma_f32_16x16x32_bf16 v[172:175], v[68:71], a[12:15], 0
  ds_read_b64_tr_b16 v[62:63], v10 offset:21504
  v_cvt_pk_bf16_f32 v213, v214, v215
  v_mfma_f32_16x16x32_bf16 v[144:147], v[72:75], a[16:19], v[144:147]
  v_cvt_pk_bf16_f32 v214, v228, v229
  v_cvt_pk_bf16_f32 v215, v230, v231
  v_mfma_f32_16x16x32_bf16 v[148:151], v[72:75], a[20:23], v[148:151]
  v_cvt_pk_bf16_f32 v216, v216, v217
  v_cvt_pk_bf16_f32 v217, v218, v219
  v_mfma_f32_16x16x32_bf16 v[152:155], v[72:75], a[24:27], v[152:155]
  buffer_store_dwordx4 v[212:215], v24, s[16:19], s70 offen  sc1
  v_cvt_pk_bf16_f32 v218, v232, v233
  v_mfma_f32_16x16x32_bf16 v[156:159], v[72:75], a[28:31], v[156:159]
  v_cvt_pk_bf16_f32 v219, v234, v235
  v_cvt_pk_bf16_f32 v220, v220, v221
  v_mfma_f32_16x16x32_bf16 v[160:163], v[76:79], a[16:19], v[160:163]
  v_cvt_pk_bf16_f32 v221, v222, v223
  v_cvt_pk_bf16_f32 v222, v236, v237
  v_mfma_f32_16x16x32_bf16 v[164:167], v[76:79], a[20:23], v[164:167]
  v_cvt_pk_bf16_f32 v223, v238, v239
  v_mfma_f32_16x16x32_bf16 v[168:171], v[76:79], a[24:27], v[168:171]
  v_mfma_f32_16x16x32_bf16 v[172:175], v[76:79], a[28:31], v[172:175]
  buffer_store_dwordx4 v[216:219], v25, s[16:19], s70 offen  sc1
  s_waitcnt lgkmcnt(0)
  v_mfma_f32_16x16x32_bf16 v[144:147], v[48:51], a[32:35], v[144:147]
  ds_read_b64_tr_b16 v[64:65], v9 offset:8192
  v_mfma_f32_16x16x32_bf16 v[148:151], v[48:51], a[36:39], v[148:151]
  ds_read_b64_tr_b16 v[66:67], v9 offset:12288
  v_mfma_f32_16x16x32_bf16 v[152:155], v[48:51], a[40:43], v[152:155]
  ds_read_b64_tr_b16 v[68:69], v10 offset:8192
  v_mfma_f32_16x16x32_bf16 v[156:159], v[48:51], a[44:47], v[156:159]
  ds_read_b64_tr_b16 v[70:71], v10 offset:12288
  v_mfma_f32_16x16x32_bf16 v[160:163], v[52:55], a[32:35], v[160:163]
  ds_read_b64_tr_b16 v[72:73], v9 offset:9216
  buffer_store_dwordx4 v[220:223], v26, s[16:19], s70 offen  sc1
  v_mfma_f32_16x16x32_bf16 v[164:167], v[52:55], a[36:39], v[164:167]
  ds_read_b64_tr_b16 v[74:75], v9 offset:13312
  v_mfma_f32_16x16x32_bf16 v[168:171], v[52:55], a[40:43], v[168:171]
  ds_read_b64_tr_b16 v[76:77], v10 offset:9216
  v_mfma_f32_16x16x32_bf16 v[172:175], v[52:55], a[44:47], v[172:175]
  ds_read_b64_tr_b16 v[78:79], v10 offset:13312
  v_mfma_f32_16x16x32_bf16 v[144:147], v[56:59], a[48:51], v[144:147]
  v_mfma_f32_16x16x32_bf16 v[148:151], v[56:59], a[52:55], v[148:151]
  v_mfma_f32_16x16x32_bf16 v[152:155], v[56:59], a[56:59], v[152:155]
  v_mfma_f32_16x16x32_bf16 v[156:159], v[56:59], a[60:63], v[156:159]
  v_mfma_f32_16x16x32_bf16 v[160:163], v[60:63], a[48:51], v[160:163]
  v_mfma_f32_16x16x32_bf16 v[164:167], v[60:63], a[52:55], v[164:167]
  v_mfma_f32_16x16x32_bf16 v[168:171], v[60:63], a[56:59], v[168:171]
  v_mfma_f32_16x16x32_bf16 v[172:175], v[60:63], a[60:63], v[172:175]
  s_waitcnt lgkmcnt(0)
  v_mfma_f32_16x16x32_bf16 v[144:147], v[64:67], a[64:67], v[144:147]
  ds_read_b64_tr_b16 v[48:49], v11 offset:32768
  v_mfma_f32_16x16x32_bf16 v[148:151], v[64:67], a[68:71], v[148:151]
  ds_read_b64_tr_b16 v[50:51], v11 offset:36864
  v_mfma_f32_16x16x32_bf16 v[152:155], v[64:67], a[72:75], v[152:155]
  ds_read_b64_tr_b16 v[52:53], v12 offset:32768
  v_mfma_f32_16x16x32_bf16 v[156:159], v[64:67], a[76:79], v[156:159]
  ds_read_b64_tr_b16 v[54:55], v12 offset:36864
  v_mfma_f32_16x16x32_bf16 v[160:163], v[68:71], a[64:67], v[160:163]
  ds_read_b64_tr_b16 v[56:57], v11 offset:33792
  v_mfma_f32_16x16x32_bf16 v[164:167], v[68:71], a[68:71], v[164:167]
  ds_read_b64_tr_b16 v[58:59], v11 offset:37888
  v_mfma_f32_16x16x32_bf16 v[168:171], v[68:71], a[72:75], v[168:171]
  ds_read_b64_tr_b16 v[60:61], v12 offset:33792
  v_mfma_f32_16x16x32_bf16 v[172:175], v[68:71], a[76:79], v[172:175]
  ds_read_b64_tr_b16 v[62:63], v12 offset:37888
  v_mfma_f32_16x16x32_bf16 v[144:147], v[72:75], a[80:83], v[144:147]
  v_mfma_f32_16x16x32_bf16 v[148:151], v[72:75], a[84:87], v[148:151]
  v_mfma_f32_16x16x32_bf16 v[152:155], v[72:75], a[88:91], v[152:155]
  v_mfma_f32_16x16x32_bf16 v[156:159], v[72:75], a[92:95], v[156:159]
  v_mfma_f32_16x16x32_bf16 v[160:163], v[76:79], a[80:83], v[160:163]
  v_mfma_f32_16x16x32_bf16 v[164:167], v[76:79], a[84:87], v[164:167]
  v_mfma_f32_16x16x32_bf16 v[168:171], v[76:79], a[88:91], v[168:171]
  v_mfma_f32_16x16x32_bf16 v[172:175], v[76:79], a[92:95], v[172:175]
  s_waitcnt vmcnt(18) lgkmcnt(0)
  s_barrier
  v_mfma_f32_16x16x32_bf16 v[144:147], v[48:51], a[96:99], v[144:147]
  ds_read_b64_tr_b16 v[64:65], v11 offset:0
  v_mfma_f32_16x16x32_bf16 v[148:151], v[48:51], a[100:103], v[148:151]
  ds_read_b64_tr_b16 v[66:67], v11 offset:4096
  v_mfma_f32_16x16x32_bf16 v[152:155], v[48:51], a[104:107], v[152:155]
  ds_read_b64_tr_b16 v[68:69], v12 offset:0
  v_mfma_f32_16x16x32_bf16 v[156:159], v[48:51], a[108:111], v[156:159]
  ds_read_b64_tr_b16 v[70:71], v12 offset:4096
  v_mfma_f32_16x16x32_bf16 v[160:163], v[52:55], a[96:99], v[160:163]
  v_mfma_f32_16x16x32_bf16 v[164:167], v[52:55], a[100:103], v[164:167]
  v_mfma_f32_16x16x32_bf16 v[168:171], v[52:55], a[104:107], v[168:171]
  v_mfma_f32_16x16x32_bf16 v[172:175], v[52:55], a[108:111], v[172:175]
  v_mfma_f32_16x16x32_bf16 v[144:147], v[56:59], a[112:115], v[144:147]
  v_mfma_f32_16x16x32_bf16 v[148:151], v[56:59], a[116:119], v[148:151]
  v_mfma_f32_16x16x32_bf16 v[152:155], v[56:59], a[120:123], v[152:155]
  v_mfma_f32_16x16x32_bf16 v[156:159], v[56:59], a[124:127], v[156:159]
  v_mfma_f32_16x16x32_bf16 v[160:163], v[60:63], a[112:115], v[160:163]
  v_mfma_f32_16x16x32_bf16 v[164:167], v[60:63], a[116:119], v[164:167]
  v_mfma_f32_16x16x32_bf16 v[168:171], v[60:63], a[120:123], v[168:171]
  v_mfma_f32_16x16x32_bf16 v[172:175], v[60:63], a[124:127], v[172:175]
  s_waitcnt lgkmcnt(0)
  v_mfma_f32_16x16x32_bf16 v[144:147], v[64:67], a[128:131], v[144:147]
  v_mfma_f32_16x16x32_bf16 v[148:151], v[64:67], a[132:135], v[148:151]
  v_mfma_f32_16x16x32_bf16 v[152:155], v[64:67], a[136:139], v[152:155]
  v_mfma_f32_16x16x32_bf16 v[156:159], v[64:67], a[140:143], v[156:159]
  v_mfma_f32_16x16x32_bf16 v[160:163], v[68:71], a[128:131], v[160:163]
  v_mfma_f32_16x16x32_bf16 v[164:167], v[68:71], a[132:135], v[164:167]
  v_mfma_f32_16x16x32_bf16 v[168:171], v[68:71], a[136:139], v[168:171]
  v_mfma_f32_16x16x32_bf16 v[172:175], v[68:71], a[140:143], v[172:175]
  s_add_u32 s70, s70, 2048
  v_cvt_pk_bf16_f32 v144, v144, v145
  v_cvt_pk_bf16_f32 v145, v146, v147
  s_nop 1
  v_cvt_pk_bf16_f32 v146, v160, v161
  v_cvt_pk_bf16_f32 v147, v162, v163
  buffer_store_dwordx4 v[144:147], v23, s[16:19], s70 offen  sc1
  v_cvt_pk_bf16_f32 v148, v148, v149
  v_cvt_pk_bf16_f32 v149, v150, v151
  v_cvt_pk_bf16_f32 v150, v164, v165
  v_cvt_pk_bf16_f32 v151, v166, v167
  buffer_store_dwordx4 v[148:151], v24, s[16:19], s70 offen  sc1
  v_cvt_pk_bf16_f32 v152, v152, v153
  v_cvt_pk_bf16_f32 v153, v154, v155
  v_cvt_pk_bf16_f32 v154, v168, v169
  v_cvt_pk_bf16_f32 v155, v170, v171
  buffer_store_dwordx4 v[152:155], v25, s[16:19], s70 offen  sc1
  v_cvt_pk_bf16_f32 v156, v156, v157
  v_cvt_pk_bf16_f32 v157, v158, v159
  v_cvt_pk_bf16_f32 v158, v172, v173
  v_cvt_pk_bf16_f32 v159, v174, v175
  buffer_store_dwordx4 v[156:159], v26, s[16:19], s70 offen  sc1
ffn_end:
  s_endpgm
ffn_kernel_codeend:
.section .rodata,"a"
.p2align 6
.amdhsa_kernel ffn_kernel
  .amdhsa_next_free_vgpr 512
  .amdhsa_next_free_sgpr 102
  .amdhsa_accum_offset 256
  .amdhsa_group_segment_fixed_size 0
  .amdhsa_kernarg_size 88
  .amdhsa_user_sgpr_count 2
  .amdhsa_user_sgpr_kernarg_segment_ptr 1
  .amdhsa_system_sgpr_workgroup_id_x 1
.end_amdhsa_kernel
.text
.globl red_kernel
.p2align 8
.type red_kernel,@function
red_kernel:
  s_cmp_ge_u32 s2, 256
  s_cbranch_scc1 red_end
  s_load_dwordx2 s[12:13], s[0:1], 80
  s_load_dwordx2 s[4:5], s[0:1], 64
  v_and_b32 v1, 63, v0
  v_lshrrev_b32 v2, 6, v0
  s_nop 0
  v_readfirstlane_b32 s3, v2
  v_and_b32 v3, 7, v1
  v_bfe_u32 v4, v1, 3, 1
  v_lshrrev_b32 v5, 4, v1
  v_lshlrev_b32 v6, 4, v3
  v_lshl_add_u32 v6, v4, 10, v6
  v_lshl_add_u32 v6, v5, 8, v6
  s_lshr_b32 s6, s2, 1
  s_mul_i32 s6, s6, 18
  s_lshl_b32 s7, s3, 1
  s_add_u32 s6, s6, s7
  s_lshl_b32 s6, s6, 10
  s_and_b32 s7, s2, 1
  s_lshl_b32 s7, s7, 7
  s_add_u32 s6, s6, s7
  s_add_u32 s7, s6, 17825792
  s_add_u32 s6, s6, 20971520
  s_waitcnt lgkmcnt(0)
  s_mov_b32 s16, s12
  s_mov_b32 s17, s13
  s_mov_b32 s18, 268435456
  s_mov_b32 s19, 0x20000
  buffer_load_dwordx4 v[16:19], v6, s[16:19], s6 offen
  s_add_u32 s6, s6, 2359296
  buffer_load_dwordx4 v[20:23], v6, s[16:19], s6 offen
  s_add_u32 s6, s6, 2359296
  buffer_load_dwordx4 v[24:27], v6, s[16:19], s6 offen
  s_add_u32 s6, s6, 2359296
  buffer_load_dwordx4 v[28:31], v6, s[16:19], s6 offen
  s_add_u32 s6, s6, 2359296
  buffer_load_dwordx4 v[32:35], v6, s[16:19], s6 offen
  s_add_u32 s6, s6, 2359296
  buffer_load_dwordx4 v[36:39], v6, s[16:19], s6 offen
  s_add_u32 s6, s6, 2359296
  buffer_load_dwordx4 v[40:43], v6, s[16:19], s6 offen
  s_add_u32 s6, s6, 2359296
  buffer_load_dwordx4 v[44:47], v6, s[16:19], s6 offen
  s_add_u32 s6, s6, 2359296
  buffer_load_dwordx4 v[48:51], v6, s[16:19], s6 offen
  s_add_u32 s6, s6, 2359296
  buffer_load_dwordx4 v[52:55], v6, s[16:19], s6 offen
  s_add_u32 s6, s6, 2359296
  buffer_load_dwordx4 v[56:59], v6, s[16:19], s6 offen
  s_add_u32 s6, s6, 2359296
  buffer_load_dwordx4 v[60:63], v6, s[16:19], s6 offen
  s_add_u32 s6, s6, 2359296
  buffer_load_dwordx4 v[64:67], v6, s[16:19], s6 offen
  s_add_u32 s6, s6, 2359296
  buffer_load_dwordx4 v[68:71], v6, s[16:19], s6 offen
  s_add_u32 s6, s6, 2359296
  buffer_load_dwordx4 v[72:75], v6, s[16:19], s6 offen
  s_add_u32 s6, s6, 2359296
  buffer_load_dwordx4 v[76:79], v6, s[16:19], s6 offen
  s_add_u32 s6, s6, 2359296
  buffer_load_dwordx4 v[80:83], v6, s[16:19], s7 offen
  v_and_b32 v7, 15, v1
  v_lshrrev_b32 v8, 2, v7
  v_lshlrev_b32 v8, 1, v8
  v_and_b32 v9, 3, v7
  v_and_b32 v10, 1, v9
  v_lshlrev_b32 v10, 4, v10
  v_mov_b32 v11, 0x3f80
  v_lshlrev_b32 v10, v10, v11
  v_lshrrev_b32 v9, 1, v9
  v_add_u32 v11, 0, v8
  v_and_b32 v12, 3, v11
  v_lshrrev_b32 v11, 2, v11
  v_lshl_add_u32 v11, v11, 1, v9
  v_cmp_eq_u32 vcc, v12, v5
  s_nop 1
  v_cndmask_b32 v12, 0, v10, vcc
  v_cmp_eq_u32 vcc, 0, v11
  s_nop 1
  v_cndmask_b32 v84, 0, v12, vcc
  v_cmp_eq_u32 vcc, 1, v11
  s_nop 1
  v_cndmask_b32 v85, 0, v12, vcc
  v_cmp_eq_u32 vcc, 2, v11
  s_nop 1
  v_cndmask_b32 v86, 0, v12, vcc
  v_cmp_eq_u32 vcc, 3, v11
  s_nop 1
  v_cndmask_b32 v87, 0, v12, vcc
  v_add_u32 v11, 1, v8
  v_and_b32 v12, 3, v11
  v_lshrrev_b32 v11, 2, v11
  v_lshl_add_u32 v11, v11, 1, v9
  v_cmp_eq_u32 vcc, v12, v5
  s_nop 1
  v_cndmask_b32 v12, 0, v10, vcc
  v_cmp_eq_u32 vcc, 0, v11
  s_nop 1
  v_cndmask_b32 v88, 0, v12, vcc
  v_cmp_eq_u32 vcc, 1, v11
  s_nop 1
  v_cndmask_b32 v89, 0, v12, vcc
  v_cmp_eq_u32 vcc, 2, v11
  s_nop 1
  v_cndmask_b32 v90, 0, v12, vcc
  v_cmp_eq_u32 vcc, 3, v11
  s_nop 1
  v_cndmask_b32 v91, 0, v12, vcc
  s_mov_b32 s20, s4
  s_mov_b32 s21, s5
  s_mov_b32 s22, 2359296
  s_mov_b32 s23, 0x20000
  v_mul_u32_u24 v7, 1152, v3
  v_lshl_add_u32 v7, v4, 6, v7
  v_lshl_add_u32 v7, v5, 4, v7
  s_mul_i32 s8, s2, 9216
  s_lshl_b32 s9, s3, 7
  s_add_u32 s8, s8, s9
  s_waitcnt vmcnt(16)
  v_mfma_f32_16x16x32_bf16 v[8:11], v[84:87], v[16:19], 0
  v_mfma_f32_16x16x32_bf16 v[12:15], v[88:91], v[16:19], 0
  s_waitcnt vmcnt(15)
  v_mfma_f32_16x16x32_bf16 v[8:11], v[84:87], v[20:23], v[8:11]
  v_mfma_f32_16x16x32_bf16 v[12:15], v[88:91], v[20:23], v[12:15]
  s_waitcnt vmcnt(14)
  v_mfma_f32_16x16x32_bf16 v[8:11], v[84:87], v[24:27], v[8:11]
  v_mfma_f32_16x16x32_bf16 v[12:15], v[88:91], v[24:27], v[12:15]
  s_waitcnt vmcnt(13)
  v_mfma_f32_16x16x32_bf16 v[8:11], v[84:87], v[28:31], v[8:11]
  v_mfma_f32_16x16x32_bf16 v[12:15], v[88:91], v[28:31], v[12:15]
  s_waitcnt vmcnt(12)
  v_mfma_f32_16x16x32_bf16 v[8:11], v[84:87], v[32:35], v[8:11]
  v_mfma_f32_16x16x32_bf16 v[12:15], v[88:91], v[32:35], v[12:15]
  s_waitcnt vmcnt(11)
  v_mfma_f32_16x16x32_bf16 v[8:11], v[84:87], v[36:39], v[8:11]
  v_mfma_f32_16x16x32_bf16 v[12:15], v[88:91], v[36:39], v[12:15]
  s_waitcnt vmcnt(10)
  v_mfma_f32_16x16x32_bf16 v[8:11], v[84:87], v[40:43], v[8:11]
  v_mfma_f32_16x16x32_bf16 v[12:15], v[88:91], v[40:43], v[12:15]
  s_waitcnt vmcnt(9)
  v_mfma_f32_16x16x32_bf16 v[8:11], v[84:87], v[44:47], v[8:11]
  v_mfma_f32_16x16x32_bf16 v[12:15], v[88:91], v[44:47], v[12:15]
  s_waitcnt vmcnt(8)
  v_mfma_f32_16x16x32_bf16 v[8:11], v[84:87], v[48:51], v[8:11]
  v_mfma_f32_16x16x32_bf16 v[12:15], v[88:91], v[48:51], v[12:15]
  s_waitcnt vmcnt(7)
  v_mfma_f32_16x16x32_bf16 v[8:11], v[84:87], v[52:55], v[8:11]
  v_mfma_f32_16x16x32_bf16 v[12:15], v[88:91], v[52:55], v[12:15]
  s_waitcnt vmcnt(6)
  v_mfma_f32_16x16x32_bf16 v[8:11], v[84:87], v[56:59], v[8:11]
  v_mfma_f32_16x16x32_bf16 v[12:15], v[88:91], v[56:59], v[12:15]
  s_waitcnt vmcnt(5)
  v_mfma_f32_16x16x32_bf16 v[8:11], v[84:87], v[60:63], v[8:11]
  v_mfma_f32_16x16x32_bf16 v[12:15], v[88:91], v[60:63], v[12:15]
  s_waitcnt vmcnt(4)
  v_mfma_f32_16x16x32_bf16 v[8:11], v[84:87], v[64:67], v[8:11]
  v_mfma_f32_16x16x32_bf16 v[12:15], v[88:91], v[64:67], v[12:15]
  s_waitcnt vmcnt(3)
  v_mfma_f32_16x16x32_bf16 v[8:11], v[84:87], v[68:71], v[8:11]
  v_mfma_f32_16x16x32_bf16 v[12:15], v[88:91], v[68:71], v[12:15]
  s_waitcnt vmcnt(2)
  v_mfma_f32_16x16x32_bf16 v[8:11], v[84:87], v[72:75], v[8:11]
  v_mfma_f32_16x16x32_bf16 v[12:15], v[88:91], v[72:75], v[12:15]
  s_waitcnt vmcnt(1)
  v_mfma_f32_16x16x32_bf16 v[8:11], v[84:87], v[76:79], v[8:11]
  v_mfma_f32_16x16x32_bf16 v[12:15], v[88:91], v[76:79], v[12:15]
  s_waitcnt vmcnt(0)
  v_mfma_f32_16x16x32_bf16 v[8:11], v[84:87], v[80:83], v[8:11]
  v_mfma_f32_16x16x32_bf16 v[12:15], v[88:91], v[80:83], v[12:15]
  s_nop 6
  v_cvt_pk_bf16_f32 v16, v8, v9
  v_cvt_pk_bf16_f32 v17, v10, v11
  v_cvt_pk_bf16_f32 v18, v12, v13
  v_cvt_pk_bf16_f32 v19, v14, v15
  buffer_store_dwordx4 v[16:19], v7, s[20:23], s8 offen
red_end:
  s_endpgm
red_kernel_codeend:
.section .rodata,"a"
.p2align 6
.amdhsa_kernel red_kernel
  .amdhsa_next_free_vgpr 96
  .amdhsa_next_free_sgpr 102
  .amdhsa_accum_offset 96
  .amdhsa_group_segment_fixed_size 0
  .amdhsa_kernarg_size 88
  .amdhsa_user_sgpr_count 2
  .amdhsa_user_sgpr_kernarg_segment_ptr 1
  .amdhsa_system_sgpr_workgroup_id_x 1
.end_amdhsa_kernel
.text
```
